```python
import torch

def _softmax(x, axis=-1):
    return torch.softmax(x, dim=axis)
def _gelu(x):
    return torch.nn.functional.gelu(x, approximate="tanh")
def _silu(x):
    return torch.nn.functional.silu(x)
def _sigmoid(x):
    return torch.sigmoid(x)
def _layernorm(x, axis=-1, eps=1e-5):
    m = x.mean(dim=axis, keepdim=True)
    v = x.var(dim=axis, keepdim=True, unbiased=False)
    return (x - m) / torch.sqrt(v + eps)
def _scatter_add(tgt, idx, src, axis=0):
    return tgt.clone().index_add_(axis, idx, src)
def _segment_sum(src, seg, n):
    out = torch.zeros((n,) + src.shape[1:], dtype=src.dtype)
    return out.index_add_(0, seg, src)
def _pad(x, pw):
    flat = tuple(v for pair in reversed(pw) for v in pair)
    return torch.nn.functional.pad(x, flat)

kernel_name = 'sequential_preLN__sliding_local_dilated__geglu_ffn__prompt'

def setup_inputs():

    _w = (lambda a: (lambda t: t.to(torch.bfloat16) if t.is_floating_point() else t)(torch.as_tensor(a)))
    def _A_setup():
        B, S, D = 1, 2048, 512
        return {
            "x": _w((lambda *s: torch.randn(*s, dtype=torch.bfloat16) * 0.05)(B, S, D)),
            "wqkv": _w((lambda *s: torch.randn(*s, dtype=torch.bfloat16) * 0.05)(D, 3 * D)),
            "wo": _w((lambda *s: torch.randn(*s, dtype=torch.bfloat16) * 0.05)(D, D)),
        }
    _A_in = _A_setup()

    def _B_setup():
        B, S, D, F = 1, 2048, 512, 1792
        return {
            "x": _w((lambda *s: torch.randn(*s, dtype=torch.bfloat16) * 0.05)(B, S, D)),
            "w_gate": _w((lambda *s: torch.randn(*s, dtype=torch.bfloat16) * 0.05)(D, F)),
            "w_up": _w((lambda *s: torch.randn(*s, dtype=torch.bfloat16) * 0.05)(D, F)),
            "w_down": _w((lambda *s: torch.randn(*s, dtype=torch.bfloat16) * 0.05)(F, D)),
        }
    _B_in = _B_setup()

    return {
        "A_x": _A_in["x"],
        "A_wqkv": _A_in["wqkv"],
        "A_wo": _A_in["wo"],
        "B_x": _B_in["x"],
        "B_w_gate": _B_in["w_gate"],
        "B_w_up": _B_in["w_up"],
        "B_w_down": _B_in["w_down"],
    }

def reference(A_x, A_wqkv, A_wo, B_x, B_w_gate, B_w_up, B_w_down):
    def _A_ref(x, wqkv, wo):
        B, S, D = x.shape
        H = 32; Dh = D // H
        W, dil = 8, 2
        qkv = (lambda x, *d: x.permute(*d))((x @ wqkv).reshape(B, S, 3, H, Dh), 2, 0, 3, 1, 4)
        q, k, v = qkv[0], qkv[1], qkv[2]
        scale = Dh ** -0.5
        pos = torch.arange(S)
        off = torch.arange(W) * dil
        idx = pos[:, None] - off[None, :]
        mask = idx >= 0
        idx_c = torch.where(mask, idx, 0).reshape(-1)
        kg = k[:, :, idx_c, :].reshape(B, H, S, W, Dh)
        vg = v[:, :, idx_c, :].reshape(B, H, S, W, Dh)
        logits = torch.einsum("bhsd,bhswd->bhsw", q, kg) * scale
        logits = torch.where(mask[None, None, :, :], logits, -1e9)
        attn = _softmax(logits, axis=-1)
        o = torch.einsum("bhsw,bhswd->bhsd", attn, vg)
        return (lambda x, *d: x.permute(*d))(o, 0, 2, 1, 3).reshape(B, S, D) @ wo

    def _B_ref(x, w_gate, w_up, w_down):
        return (_gelu(x @ w_gate) * (x @ w_up)) @ w_down

    x = A_x
    h = x + _A_ref(_layernorm(x, axis=-1), A_wqkv, A_wo)
    h2 = h + _B_ref(_layernorm(h, axis=-1), B_w_gate, B_w_up, B_w_down)
    return h2
```

```asm
; @launch grid=(256,1,1) block=(512,1,1) lds=163840
.amdgcn_target "amdgcn-amd-amdhsa--gfx950"
.text
.globl sequential_preLN__sliding_local_dilated__geglu_ffn__prompt_kernel
.p2align 8
.type sequential_preLN__sliding_local_dilated__geglu_ffn__prompt_kernel,@function
sequential_preLN__sliding_local_dilated__geglu_ffn__prompt_kernel:
    s_load_dwordx16 s[64:79], s[0:1], 0
    s_load_dwordx4 s[80:83], s[0:1], 64
    s_cmp_ge_u32 s2, 256
    s_cbranch_scc1 L_end_sequential_preLN__sliding_local_dilated__geglu_ffn__prompt_kernel
    s_and_b32 s24, s2, 7
    s_lshr_b32 s25, s2, 3
    v_lshrrev_b32 v7, 6, v0
    v_and_b32 v4, 63, v0
    v_readfirstlane_b32 s26, v7
    v_lshlrev_b32 v1, 4, v4
    v_lshrrev_b32 v5, 4, v4
    v_and_b32 v6, 15, v4
    s_memrealtime s[90:91]
    s_and_b32 s27, s26, 3
    s_lshr_b32 s28, s25, 3
    s_and_b32 s93, s25, 7
    s_lshr_b32 s29, s24, 1
    s_lshl_b32 s29, s29, 2
    s_add_u32 s29, s29, s28
    s_and_b32 s43, s24, 1
    s_lshl_b32 s43, s43, 3
    s_add_u32 s43, s43, s93
    v_lshlrev_b32 v7, 2, v4
    v_add_u32 v7, 163584, v7
    v_mov_b32 v8, 0
    ds_write_b32 v7, v8
    s_cmp_ge_u32 s26, 4
    s_cbranch_scc1 L_sequential_preLN__sliding_local_dilated__geglu_ffn__prompt_kernel_helper
    s_setprio 2
    s_lshl_b32 s35, s26, 12
    s_add_u32 s35, s35, 16384
    v_and_b32 v7, 7, v6
    v_xor_b32 v7, v7, v5
    v_lshlrev_b32 v8, 7, v6
    v_lshl_add_u32 v8, v7, 4, v8
    v_add_u32 v20, s35, v8
    v_xor_b32 v21, 64, v20
    v_add_u32 v7, 0, v5
    v_xor_b32 v7, v7, v6
    v_lshlrev_b32 v8, 10, v6
    v_lshl_add_u32 v8, v7, 4, v8
    v_add_u32 v22, 0, v8
    v_add_u32 v7, 4, v5
    v_xor_b32 v7, v7, v6
    v_lshlrev_b32 v8, 10, v6
    v_lshl_add_u32 v8, v7, 4, v8
    v_add_u32 v23, 0, v8
    v_add_u32 v7, 8, v5
    v_xor_b32 v7, v7, v6
    v_lshlrev_b32 v8, 10, v6
    v_lshl_add_u32 v8, v7, 4, v8
    v_add_u32 v24, 0, v8
    v_add_u32 v7, 12, v5
    v_xor_b32 v7, v7, v6
    v_lshlrev_b32 v8, 10, v6
    v_lshl_add_u32 v8, v7, 4, v8
    v_add_u32 v25, 0, v8
    v_bfe_u32 v7, v4, 2, 2
    v_lshl_add_u32 v7, v5, 3, v7
    v_mul_u32_u24 v7, 192, v7
    v_and_b32 v8, 3, v4
    v_lshl_add_u32 v7, v8, 3, v7
    v_and_b32 v8, 1, v5
    v_add_u32 v12, 0, v8
    v_lshl_add_u32 v26, v12, 5, v7
    v_add_u32 v26, 32768, v26
    v_add_u32 v240, 57344, v26
    v_add_u32 v246, 114688, v26
    v_add_u32 v12, 1, v8
    v_lshl_add_u32 v27, v12, 5, v7
    v_add_u32 v27, 32768, v27
    v_add_u32 v241, 57344, v27
    v_add_u32 v247, 114688, v27
    v_add_u32 v12, 2, v8
    v_lshl_add_u32 v28, v12, 5, v7
    v_add_u32 v28, 32768, v28
    v_add_u32 v242, 57344, v28
    v_add_u32 v248, 114688, v28
    v_add_u32 v12, 3, v8
    v_lshl_add_u32 v29, v12, 5, v7
    v_add_u32 v29, 32768, v29
    v_add_u32 v243, 57344, v29
    v_add_u32 v249, 114688, v29
    v_add_u32 v12, 4, v8
    v_lshl_add_u32 v30, v12, 5, v7
    v_add_u32 v30, 32768, v30
    v_add_u32 v244, 57344, v30
    v_add_u32 v250, 114688, v30
    v_add_u32 v12, 5, v8
    v_mul_u32_u24 v13, 6, v8
    v_sub_u32 v12, v12, v13
    v_lshl_add_u32 v31, v12, 5, v7
    v_add_u32 v31, 32768, v31
    v_add_u32 v245, 57344, v31
    v_add_u32 v251, 114688, v31
    v_add_u32 v252, 57344, v20
    v_add_u32 v254, 114688, v20
    v_add_u32 v253, 57344, v21
    v_add_u32 v255, 114688, v21
    v_mov_b32 v32, 0
    v_mov_b32 v33, 0
    v_mov_b32 v34, 0
    v_mov_b32 v35, 0
    v_mov_b32 v36, 0
    v_mov_b32 v37, 0
    v_mov_b32 v38, 0
    v_mov_b32 v39, 0
    v_mov_b32 v40, 0
    v_mov_b32 v41, 0
    v_mov_b32 v42, 0
    v_mov_b32 v43, 0
    v_mov_b32 v44, 0
    v_mov_b32 v45, 0
    v_mov_b32 v46, 0
    v_mov_b32 v47, 0
    v_mov_b32 v48, 0
    v_mov_b32 v49, 0
    v_mov_b32 v50, 0
    v_mov_b32 v51, 0
    v_mov_b32 v52, 0
    v_mov_b32 v53, 0
    v_mov_b32 v54, 0
    v_mov_b32 v55, 0
    v_mov_b32 v56, 0
    v_mov_b32 v57, 0
    v_mov_b32 v58, 0
    v_mov_b32 v59, 0
    v_mov_b32 v60, 0
    v_mov_b32 v61, 0
    v_mov_b32 v62, 0
    v_mov_b32 v63, 0
    v_mov_b32 v64, 0
    v_mov_b32 v65, 0
    v_mov_b32 v66, 0
    v_mov_b32 v67, 0
    v_mov_b32 v68, 0
    v_mov_b32 v69, 0
    v_mov_b32 v70, 0
    v_mov_b32 v71, 0
    v_mov_b32 v72, 0
    v_mov_b32 v73, 0
    v_mov_b32 v74, 0
    v_mov_b32 v75, 0
    v_mov_b32 v76, 0
    v_mov_b32 v77, 0
    v_mov_b32 v78, 0
    v_mov_b32 v79, 0
    v_mov_b32 v80, 0
    v_mov_b32 v81, 0
    v_mov_b32 v82, 0
    v_mov_b32 v83, 0
    v_mov_b32 v84, 0
    v_mov_b32 v85, 0
    v_mov_b32 v86, 0
    v_mov_b32 v87, 0
    v_mov_b32 v88, 0
    v_mov_b32 v89, 0
    v_mov_b32 v90, 0
    v_mov_b32 v91, 0
    v_mov_b32 v92, 0
    v_mov_b32 v93, 0
    v_mov_b32 v94, 0
    v_mov_b32 v95, 0
    v_mov_b32 v96, 0
    v_mov_b32 v97, 0
    v_mov_b32 v98, 0
    v_mov_b32 v99, 0
    v_mov_b32 v100, 0
    v_mov_b32 v101, 0
    v_mov_b32 v102, 0
    v_mov_b32 v103, 0
    v_mov_b32 v104, 0x3f803f80
    v_mov_b32 v105, 0x3f803f80
    v_mov_b32 v106, 0x3f803f80
    v_mov_b32 v107, 0x3f803f80
    v_cmp_eq_u32 s[56:57], 0, v6
    v_and_b32 v7, 3, v6
    v_cmp_eq_u32 s[58:59], 1, v7
    v_cmp_eq_u32 s[60:61], 2, v7
    v_cmp_eq_u32 s[62:63], 3, v7
    v_lshrrev_b32 v8, 2, v6
    v_cmp_eq_u32 s[84:85], v8, v5
    v_lshlrev_b32 v14, 2, v5
    v_sub_u32 v14, v6, v14
    v_mov_b32 v15, 0xff800000
    v_subrev_u32 v16, 0, v14
    v_and_b32 v17, 0x80000001, v16
    v_cmp_eq_u32 vcc, 0, v17
    s_nop 1
    v_cndmask_b32 v228, v15, 0, vcc
    v_add_u32 v16, 1, v16
    v_and_b32 v17, 0x80000001, v16
    v_xor_b32 v17, 0x80000001, v17
    v_cmp_eq_u32 vcc, 0, v17
    s_nop 1
    v_cndmask_b32 v232, v15, 0, vcc
    v_subrev_u32 v16, 1, v14
    v_and_b32 v17, 0x80000001, v16
    v_cmp_eq_u32 vcc, 0, v17
    s_nop 1
    v_cndmask_b32 v229, v15, 0, vcc
    v_add_u32 v16, 1, v16
    v_and_b32 v17, 0x80000001, v16
    v_xor_b32 v17, 0x80000001, v17
    v_cmp_eq_u32 vcc, 0, v17
    s_nop 1
    v_cndmask_b32 v233, v15, 0, vcc
    v_subrev_u32 v16, 2, v14
    v_and_b32 v17, 0x80000001, v16
    v_cmp_eq_u32 vcc, 0, v17
    s_nop 1
    v_cndmask_b32 v230, v15, 0, vcc
    v_add_u32 v16, 1, v16
    v_and_b32 v17, 0x80000001, v16
    v_xor_b32 v17, 0x80000001, v17
    v_cmp_eq_u32 vcc, 0, v17
    s_nop 1
    v_cndmask_b32 v234, v15, 0, vcc
    v_subrev_u32 v16, 3, v14
    v_and_b32 v17, 0x80000001, v16
    v_cmp_eq_u32 vcc, 0, v17
    s_nop 1
    v_cndmask_b32 v231, v15, 0, vcc
    v_add_u32 v16, 1, v16
    v_and_b32 v17, 0x80000001, v16
    v_xor_b32 v17, 0x80000001, v17
    v_cmp_eq_u32 vcc, 0, v17
    s_nop 1
    v_cndmask_b32 v235, v15, 0, vcc
    s_cmp_eq_u32 s29, 0
    s_cselect_b32 s86, 0xff800000, 0
    v_add_f32 v236, s86, v232
    v_add_f32 v237, s86, v233
    v_add_f32 v238, s86, v234
    v_add_f32 v239, s86, v235
    s_mov_b32 s87, 0x3eb8aa3b
    v_mov_b32 v18, 163584
    v_mov_b32 v19, 1
    s_waitcnt lgkmcnt(0)
    s_mov_b32 s4, s82
    s_and_b32 s5, s83, 0xffff
    s_mov_b32 s6, 268435456
    s_mov_b32 s7, 0x00020000
    s_mov_b32 s8, s64
    s_and_b32 s9, s65, 0xffff
    s_mov_b32 s10, 2097152
    s_mov_b32 s11, 0x00020000
    s_barrier
    s_cmp_eq_u32 s26, 1
    s_cbranch_scc1 L_sequential_preLN__sliding_local_dilated__geglu_ffn__prompt_kernel_w1
    s_cmp_eq_u32 s26, 2
    s_cbranch_scc1 L_sequential_preLN__sliding_local_dilated__geglu_ffn__prompt_kernel_w2
    s_cmp_eq_u32 s26, 3
    s_cbranch_scc1 L_sequential_preLN__sliding_local_dilated__geglu_ffn__prompt_kernel_w3
L_sequential_preLN__sliding_local_dilated__geglu_ffn__prompt_kernel_cl0_0:
    ds_read_b32 v17, v18 offset:0
    s_waitcnt lgkmcnt(0)
    v_readfirstlane_b32 s40, v17
    s_nop 1
    s_cmp_lt_u32 s40, 4
    s_cbranch_scc1 L_sequential_preLN__sliding_local_dilated__geglu_ffn__prompt_kernel_cl0_0
L_sequential_preLN__sliding_local_dilated__geglu_ffn__prompt_kernel_cl0_0x:
    ds_read_b128 v[156:159], v20 offset:0
    ds_read_b128 v[160:163], v20 offset:2048
    ds_read_b64_tr_b16 v[108:109], v26 offset:0
    ds_read_b64_tr_b16 v[110:111], v26 offset:768
    ds_read_b64_tr_b16 v[112:113], v27 offset:0
    ds_read_b64_tr_b16 v[114:115], v27 offset:768
    ds_read_b64_tr_b16 v[116:117], v28 offset:0
    ds_read_b64_tr_b16 v[118:119], v28 offset:768
    ds_read_b64_tr_b16 v[120:121], v29 offset:0
    ds_read_b64_tr_b16 v[122:123], v29 offset:768
    ds_read_b64_tr_b16 v[124:125], v30 offset:0
    ds_read_b64_tr_b16 v[126:127], v30 offset:768
    ds_read_b64_tr_b16 v[128:129], v31 offset:0
    ds_read_b64_tr_b16 v[130:131], v31 offset:768
    ds_read_b128 v[164:167], v22 offset:0
    s_waitcnt lgkmcnt(0)
    v_mfma_f32_16x16x32_bf16 v[32:35], v[108:111], v[156:159], v[32:35]
    v_mfma_f32_16x16x32_bf16 v[40:43], v[112:115], v[156:159], v[40:43]
    v_mfma_f32_16x16x32_bf16 v[48:51], v[116:119], v[156:159], v[48:51]
    ds_read_b128 v[168:171], v21 offset:0
    ds_read_b128 v[172:175], v21 offset:2048
    v_mfma_f32_16x16x32_bf16 v[56:59], v[120:123], v[156:159], v[56:59]
    ds_read_b64_tr_b16 v[132:133], v26 offset:6144
    v_mfma_f32_16x16x32_bf16 v[64:67], v[156:159], v[124:127], v[64:67]
    ds_read_b64_tr_b16 v[134:135], v26 offset:6912
    ds_read_b64_tr_b16 v[136:137], v27 offset:6144
    v_mfma_f32_16x16x32_bf16 v[72:75], v[156:159], v[128:131], v[72:75]
    ds_read_b64_tr_b16 v[138:139], v27 offset:6912
    v_mfma_f32_16x16x32_bf16 v[80:83], v[104:107], v[156:159], v[80:83]
    ds_read_b64_tr_b16 v[140:141], v28 offset:6144
    ds_read_b64_tr_b16 v[142:143], v28 offset:6912
    v_mfma_f32_16x16x32_bf16 v[88:91], v[156:159], v[156:159], v[88:91]
    ds_read_b64_tr_b16 v[144:145], v29 offset:6144
    v_mfma_f32_16x16x32_bf16 v[36:39], v[108:111], v[160:163], v[36:39]
    ds_read_b64_tr_b16 v[146:147], v29 offset:6912
    ds_read_b64_tr_b16 v[148:149], v30 offset:6144
    v_mfma_f32_16x16x32_bf16 v[44:47], v[112:115], v[160:163], v[44:47]
    ds_read_b64_tr_b16 v[150:151], v30 offset:6912
    v_mfma_f32_16x16x32_bf16 v[52:55], v[116:119], v[160:163], v[52:55]
    ds_read_b64_tr_b16 v[152:153], v31 offset:6144
    ds_read_b64_tr_b16 v[154:155], v31 offset:6912
    v_mfma_f32_16x16x32_bf16 v[60:63], v[120:123], v[160:163], v[60:63]
    ds_read_b128 v[176:179], v23 offset:0
    v_mfma_f32_16x16x32_bf16 v[68:71], v[160:163], v[124:127], v[68:71]
    ds_read_b32 v17, v18 offset:4
    v_cndmask_b32 v164, v164, v104, s[56:57]
    v_mfma_f32_16x16x32_bf16 v[76:79], v[160:163], v[128:131], v[76:79]
    v_cndmask_b32 v165, v165, v104, s[56:57]
    v_mfma_f32_16x16x32_bf16 v[84:87], v[104:107], v[160:163], v[84:87]
    v_cndmask_b32 v166, v166, v104, s[56:57]
    v_mfma_f32_16x16x32_bf16 v[92:95], v[160:163], v[160:163], v[92:95]
    v_cndmask_b32 v167, v167, v104, s[56:57]
    s_nop 1
    v_mfma_f32_16x16x32_bf16 v[96:99], v[116:119], v[164:167], v[96:99]
    v_mfma_f32_16x16x32_bf16 v[100:103], v[108:111], v[164:167], v[100:103]
    s_waitcnt lgkmcnt(0)
    v_mfma_f32_16x16x32_bf16 v[32:35], v[132:135], v[168:171], v[32:35]
    v_mfma_f32_16x16x32_bf16 v[40:43], v[136:139], v[168:171], v[40:43]
    s_mov_b64 exec, 1
    ds_add_u32 v18, v19 offset:32
    s_mov_b64 exec, -1
    v_readfirstlane_b32 s40, v17
    s_nop 1
    s_cmp_ge_u32 s40, 4
    s_cbranch_scc1 L_sequential_preLN__sliding_local_dilated__geglu_ffn__prompt_kernel_cl0_1x
L_sequential_preLN__sliding_local_dilated__geglu_ffn__prompt_kernel_cl0_1:
    ds_read_b32 v17, v18 offset:4
    s_waitcnt lgkmcnt(0)
    v_readfirstlane_b32 s40, v17
    s_nop 1
    s_cmp_lt_u32 s40, 4
    s_cbranch_scc1 L_sequential_preLN__sliding_local_dilated__geglu_ffn__prompt_kernel_cl0_1
L_sequential_preLN__sliding_local_dilated__geglu_ffn__prompt_kernel_cl0_1x:
    v_mfma_f32_16x16x32_bf16 v[48:51], v[140:143], v[168:171], v[48:51]
    ds_read_b128 v[156:159], v20 offset:28672
    ds_read_b128 v[160:163], v20 offset:30720
    v_mfma_f32_16x16x32_bf16 v[56:59], v[144:147], v[168:171], v[56:59]
    ds_read_b64_tr_b16 v[108:109], v26 offset:28672
    v_mfma_f32_16x16x32_bf16 v[64:67], v[168:171], v[148:151], v[64:67]
    ds_read_b64_tr_b16 v[110:111], v26 offset:29440
    ds_read_b64_tr_b16 v[112:113], v27 offset:28672
    v_mfma_f32_16x16x32_bf16 v[72:75], v[168:171], v[152:155], v[72:75]
    ds_read_b64_tr_b16 v[114:115], v27 offset:29440
    v_mfma_f32_16x16x32_bf16 v[80:83], v[104:107], v[168:171], v[80:83]
    ds_read_b64_tr_b16 v[116:117], v28 offset:28672
    ds_read_b64_tr_b16 v[118:119], v28 offset:29440
    v_mfma_f32_16x16x32_bf16 v[88:91], v[168:171], v[168:171], v[88:91]
    ds_read_b64_tr_b16 v[120:121], v29 offset:28672
    v_mfma_f32_16x16x32_bf16 v[36:39], v[132:135], v[172:175], v[36:39]
    ds_read_b64_tr_b16 v[122:123], v29 offset:29440
    ds_read_b64_tr_b16 v[124:125], v30 offset:28672
    v_mfma_f32_16x16x32_bf16 v[44:47], v[136:139], v[172:175], v[44:47]
    ds_read_b64_tr_b16 v[126:127], v30 offset:29440
    v_mfma_f32_16x16x32_bf16 v[52:55], v[140:143], v[172:175], v[52:55]
    ds_read_b64_tr_b16 v[128:129], v31 offset:28672
    ds_read_b64_tr_b16 v[130:131], v31 offset:29440
    v_mfma_f32_16x16x32_bf16 v[60:63], v[144:147], v[172:175], v[60:63]
    ds_read_b128 v[164:167], v24 offset:0
    v_mfma_f32_16x16x32_bf16 v[68:71], v[172:175], v[148:151], v[68:71]
    v_cndmask_b32 v176, v176, v104, s[56:57]
    v_mfma_f32_16x16x32_bf16 v[76:79], v[172:175], v[152:155], v[76:79]
    v_cndmask_b32 v177, v177, v104, s[56:57]
    v_mfma_f32_16x16x32_bf16 v[84:87], v[104:107], v[172:175], v[84:87]
    v_cndmask_b32 v178, v178, v104, s[56:57]
    v_mfma_f32_16x16x32_bf16 v[92:95], v[172:175], v[172:175], v[92:95]
    v_cndmask_b32 v179, v179, v104, s[56:57]
    s_nop 1
    v_mfma_f32_16x16x32_bf16 v[96:99], v[140:143], v[176:179], v[96:99]
    v_mfma_f32_16x16x32_bf16 v[100:103], v[132:135], v[176:179], v[100:103]
    s_waitcnt lgkmcnt(0)
    v_mfma_f32_16x16x32_bf16 v[32:35], v[108:111], v[156:159], v[32:35]
    v_mfma_f32_16x16x32_bf16 v[40:43], v[112:115], v[156:159], v[40:43]
    v_mfma_f32_16x16x32_bf16 v[48:51], v[116:119], v[156:159], v[48:51]
    ds_read_b128 v[168:171], v21 offset:28672
    ds_read_b128 v[172:175], v21 offset:30720
    v_mfma_f32_16x16x32_bf16 v[56:59], v[120:123], v[156:159], v[56:59]
    ds_read_b64_tr_b16 v[132:133], v26 offset:34816
    v_mfma_f32_16x16x32_bf16 v[64:67], v[156:159], v[124:127], v[64:67]
    ds_read_b64_tr_b16 v[134:135], v26 offset:35584
    ds_read_b64_tr_b16 v[136:137], v27 offset:34816
    v_mfma_f32_16x16x32_bf16 v[72:75], v[156:159], v[128:131], v[72:75]
    ds_read_b64_tr_b16 v[138:139], v27 offset:35584
    v_mfma_f32_16x16x32_bf16 v[80:83], v[104:107], v[156:159], v[80:83]
    ds_read_b64_tr_b16 v[140:141], v28 offset:34816
    ds_read_b64_tr_b16 v[142:143], v28 offset:35584
    v_mfma_f32_16x16x32_bf16 v[88:91], v[156:159], v[156:159], v[88:91]
    ds_read_b64_tr_b16 v[144:145], v29 offset:34816
    v_mfma_f32_16x16x32_bf16 v[36:39], v[108:111], v[160:163], v[36:39]
    ds_read_b64_tr_b16 v[146:147], v29 offset:35584
    ds_read_b64_tr_b16 v[148:149], v30 offset:34816
    v_mfma_f32_16x16x32_bf16 v[44:47], v[112:115], v[160:163], v[44:47]
    ds_read_b64_tr_b16 v[150:151], v30 offset:35584
    v_mfma_f32_16x16x32_bf16 v[52:55], v[116:119], v[160:163], v[52:55]
    ds_read_b64_tr_b16 v[152:153], v31 offset:34816
    ds_read_b64_tr_b16 v[154:155], v31 offset:35584
    v_mfma_f32_16x16x32_bf16 v[60:63], v[120:123], v[160:163], v[60:63]
    ds_read_b128 v[176:179], v25 offset:0
    v_mfma_f32_16x16x32_bf16 v[68:71], v[160:163], v[124:127], v[68:71]
    ds_read_b32 v17, v18 offset:8
    v_cndmask_b32 v164, v164, v104, s[56:57]
    v_mfma_f32_16x16x32_bf16 v[76:79], v[160:163], v[128:131], v[76:79]
    v_cndmask_b32 v165, v165, v104, s[56:57]
    v_mfma_f32_16x16x32_bf16 v[84:87], v[104:107], v[160:163], v[84:87]
    v_cndmask_b32 v166, v166, v104, s[56:57]
    v_mfma_f32_16x16x32_bf16 v[92:95], v[160:163], v[160:163], v[92:95]
    v_cndmask_b32 v167, v167, v104, s[56:57]
    s_nop 1
    v_mfma_f32_16x16x32_bf16 v[96:99], v[116:119], v[164:167], v[96:99]
    v_mfma_f32_16x16x32_bf16 v[100:103], v[108:111], v[164:167], v[100:103]
    s_waitcnt lgkmcnt(0)
    v_mfma_f32_16x16x32_bf16 v[32:35], v[132:135], v[168:171], v[32:35]
    v_mfma_f32_16x16x32_bf16 v[40:43], v[136:139], v[168:171], v[40:43]
    s_mov_b64 exec, 1
    ds_add_u32 v18, v19 offset:36
    s_mov_b64 exec, -1
    v_readfirstlane_b32 s40, v17
    s_nop 1
    s_cmp_ge_u32 s40, 4
    s_cbranch_scc1 L_sequential_preLN__sliding_local_dilated__geglu_ffn__prompt_kernel_cl0_2x
L_sequential_preLN__sliding_local_dilated__geglu_ffn__prompt_kernel_cl0_2:
    ds_read_b32 v17, v18 offset:8
    s_waitcnt lgkmcnt(0)
    v_readfirstlane_b32 s40, v17
    s_nop 1
    s_cmp_lt_u32 s40, 4
    s_cbranch_scc1 L_sequential_preLN__sliding_local_dilated__geglu_ffn__prompt_kernel_cl0_2
L_sequential_preLN__sliding_local_dilated__geglu_ffn__prompt_kernel_cl0_2x:
    v_mfma_f32_16x16x32_bf16 v[48:51], v[140:143], v[168:171], v[48:51]
    ds_read_b128 v[156:159], v252 offset:0
    ds_read_b128 v[160:163], v252 offset:2048
    v_mfma_f32_16x16x32_bf16 v[56:59], v[144:147], v[168:171], v[56:59]
    ds_read_b64_tr_b16 v[108:109], v240 offset:0
    v_mfma_f32_16x16x32_bf16 v[64:67], v[168:171], v[148:151], v[64:67]
    ds_read_b64_tr_b16 v[110:111], v240 offset:768
    ds_read_b64_tr_b16 v[112:113], v241 offset:0
    v_mfma_f32_16x16x32_bf16 v[72:75], v[168:171], v[152:155], v[72:75]
    ds_read_b64_tr_b16 v[114:115], v241 offset:768
    v_mfma_f32_16x16x32_bf16 v[80:83], v[104:107], v[168:171], v[80:83]
    ds_read_b64_tr_b16 v[116:117], v242 offset:0
    ds_read_b64_tr_b16 v[118:119], v242 offset:768
    v_mfma_f32_16x16x32_bf16 v[88:91], v[168:171], v[168:171], v[88:91]
    ds_read_b64_tr_b16 v[120:121], v243 offset:0
    v_mfma_f32_16x16x32_bf16 v[36:39], v[132:135], v[172:175], v[36:39]
    ds_read_b64_tr_b16 v[122:123], v243 offset:768
    ds_read_b64_tr_b16 v[124:125], v244 offset:0
    v_mfma_f32_16x16x32_bf16 v[44:47], v[136:139], v[172:175], v[44:47]
    ds_read_b64_tr_b16 v[126:127], v244 offset:768
    v_mfma_f32_16x16x32_bf16 v[52:55], v[140:143], v[172:175], v[52:55]
    ds_read_b64_tr_b16 v[128:129], v245 offset:0
    ds_read_b64_tr_b16 v[130:131], v245 offset:768
    v_mfma_f32_16x16x32_bf16 v[60:63], v[144:147], v[172:175], v[60:63]
    ds_read_b128 v[164:167], v22 offset:256
    v_mfma_f32_16x16x32_bf16 v[68:71], v[172:175], v[148:151], v[68:71]
    v_cndmask_b32 v176, v176, v104, s[56:57]
    v_mfma_f32_16x16x32_bf16 v[76:79], v[172:175], v[152:155], v[76:79]
    v_cndmask_b32 v177, v177, v104, s[56:57]
    v_mfma_f32_16x16x32_bf16 v[84:87], v[104:107], v[172:175], v[84:87]
    v_cndmask_b32 v178, v178, v104, s[56:57]
    v_mfma_f32_16x16x32_bf16 v[92:95], v[172:175], v[172:175], v[92:95]
    v_cndmask_b32 v179, v179, v104, s[56:57]
    s_nop 1
    v_mfma_f32_16x16x32_bf16 v[96:99], v[140:143], v[176:179], v[96:99]
    v_mfma_f32_16x16x32_bf16 v[100:103], v[132:135], v[176:179], v[100:103]
    s_waitcnt lgkmcnt(0)
    v_mfma_f32_16x16x32_bf16 v[32:35], v[108:111], v[156:159], v[32:35]
    v_mfma_f32_16x16x32_bf16 v[40:43], v[112:115], v[156:159], v[40:43]
    v_mfma_f32_16x16x32_bf16 v[48:51], v[116:119], v[156:159], v[48:51]
    ds_read_b128 v[168:171], v253 offset:0
    ds_read_b128 v[172:175], v253 offset:2048
    v_mfma_f32_16x16x32_bf16 v[56:59], v[120:123], v[156:159], v[56:59]
    ds_read_b64_tr_b16 v[132:133], v240 offset:6144
    v_mfma_f32_16x16x32_bf16 v[64:67], v[156:159], v[124:127], v[64:67]
    ds_read_b64_tr_b16 v[134:135], v240 offset:6912
    ds_read_b64_tr_b16 v[136:137], v241 offset:6144
    v_mfma_f32_16x16x32_bf16 v[72:75], v[156:159], v[128:131], v[72:75]
    ds_read_b64_tr_b16 v[138:139], v241 offset:6912
    v_mfma_f32_16x16x32_bf16 v[80:83], v[104:107], v[156:159], v[80:83]
    ds_read_b64_tr_b16 v[140:141], v242 offset:6144
    ds_read_b64_tr_b16 v[142:143], v242 offset:6912
    v_mfma_f32_16x16x32_bf16 v[88:91], v[156:159], v[156:159], v[88:91]
    ds_read_b64_tr_b16 v[144:145], v243 offset:6144
    v_mfma_f32_16x16x32_bf16 v[36:39], v[108:111], v[160:163], v[36:39]
    ds_read_b64_tr_b16 v[146:147], v243 offset:6912
    ds_read_b64_tr_b16 v[148:149], v244 offset:6144
    v_mfma_f32_16x16x32_bf16 v[44:47], v[112:115], v[160:163], v[44:47]
    ds_read_b64_tr_b16 v[150:151], v244 offset:6912
    v_mfma_f32_16x16x32_bf16 v[52:55], v[116:119], v[160:163], v[52:55]
    ds_read_b64_tr_b16 v[152:153], v245 offset:6144
    ds_read_b64_tr_b16 v[154:155], v245 offset:6912
    v_mfma_f32_16x16x32_bf16 v[60:63], v[120:123], v[160:163], v[60:63]
    ds_read_b128 v[176:179], v23 offset:256
    v_mfma_f32_16x16x32_bf16 v[68:71], v[160:163], v[124:127], v[68:71]
    ds_read_b32 v17, v18 offset:12
    v_cndmask_b32 v164, v164, v104, s[56:57]
    v_mfma_f32_16x16x32_bf16 v[76:79], v[160:163], v[128:131], v[76:79]
    v_cndmask_b32 v165, v165, v104, s[56:57]
    v_mfma_f32_16x16x32_bf16 v[84:87], v[104:107], v[160:163], v[84:87]
    v_cndmask_b32 v166, v166, v104, s[56:57]
    v_mfma_f32_16x16x32_bf16 v[92:95], v[160:163], v[160:163], v[92:95]
    v_cndmask_b32 v167, v167, v104, s[56:57]
    s_nop 1
    v_mfma_f32_16x16x32_bf16 v[96:99], v[116:119], v[164:167], v[96:99]
    v_mfma_f32_16x16x32_bf16 v[100:103], v[108:111], v[164:167], v[100:103]
    s_waitcnt lgkmcnt(0)
    v_mfma_f32_16x16x32_bf16 v[32:35], v[132:135], v[168:171], v[32:35]
    v_mfma_f32_16x16x32_bf16 v[40:43], v[136:139], v[168:171], v[40:43]
    s_mov_b64 exec, 1
    ds_add_u32 v18, v19 offset:40
    s_mov_b64 exec, -1
    v_readfirstlane_b32 s40, v17
    s_nop 1
    s_cmp_ge_u32 s40, 4
    s_cbranch_scc1 L_sequential_preLN__sliding_local_dilated__geglu_ffn__prompt_kernel_cl0_3x
L_sequential_preLN__sliding_local_dilated__geglu_ffn__prompt_kernel_cl0_3:
    ds_read_b32 v17, v18 offset:12
    s_waitcnt lgkmcnt(0)
    v_readfirstlane_b32 s40, v17
    s_nop 1
    s_cmp_lt_u32 s40, 4
    s_cbranch_scc1 L_sequential_preLN__sliding_local_dilated__geglu_ffn__prompt_kernel_cl0_3
L_sequential_preLN__sliding_local_dilated__geglu_ffn__prompt_kernel_cl0_3x:
    v_mfma_f32_16x16x32_bf16 v[48:51], v[140:143], v[168:171], v[48:51]
    ds_read_b128 v[156:159], v252 offset:28672
    ds_read_b128 v[160:163], v252 offset:30720
    v_mfma_f32_16x16x32_bf16 v[56:59], v[144:147], v[168:171], v[56:59]
    ds_read_b64_tr_b16 v[108:109], v240 offset:28672
    v_mfma_f32_16x16x32_bf16 v[64:67], v[168:171], v[148:151], v[64:67]
    ds_read_b64_tr_b16 v[110:111], v240 offset:29440
    ds_read_b64_tr_b16 v[112:113], v241 offset:28672
    v_mfma_f32_16x16x32_bf16 v[72:75], v[168:171], v[152:155], v[72:75]
    ds_read_b64_tr_b16 v[114:115], v241 offset:29440
    v_mfma_f32_16x16x32_bf16 v[80:83], v[104:107], v[168:171], v[80:83]
    ds_read_b64_tr_b16 v[116:117], v242 offset:28672
    ds_read_b64_tr_b16 v[118:119], v242 offset:29440
    v_mfma_f32_16x16x32_bf16 v[88:91], v[168:171], v[168:171], v[88:91]
    ds_read_b64_tr_b16 v[120:121], v243 offset:28672
    v_mfma_f32_16x16x32_bf16 v[36:39], v[132:135], v[172:175], v[36:39]
    ds_read_b64_tr_b16 v[122:123], v243 offset:29440
    ds_read_b64_tr_b16 v[124:125], v244 offset:28672
    v_mfma_f32_16x16x32_bf16 v[44:47], v[136:139], v[172:175], v[44:47]
    ds_read_b64_tr_b16 v[126:127], v244 offset:29440
    v_mfma_f32_16x16x32_bf16 v[52:55], v[140:143], v[172:175], v[52:55]
    ds_read_b64_tr_b16 v[128:129], v245 offset:28672
    ds_read_b64_tr_b16 v[130:131], v245 offset:29440
    v_mfma_f32_16x16x32_bf16 v[60:63], v[144:147], v[172:175], v[60:63]
    ds_read_b128 v[164:167], v24 offset:256
    v_mfma_f32_16x16x32_bf16 v[68:71], v[172:175], v[148:151], v[68:71]
    v_cndmask_b32 v176, v176, v104, s[56:57]
    v_mfma_f32_16x16x32_bf16 v[76:79], v[172:175], v[152:155], v[76:79]
    v_cndmask_b32 v177, v177, v104, s[56:57]
    v_mfma_f32_16x16x32_bf16 v[84:87], v[104:107], v[172:175], v[84:87]
    v_cndmask_b32 v178, v178, v104, s[56:57]
    v_mfma_f32_16x16x32_bf16 v[92:95], v[172:175], v[172:175], v[92:95]
    v_cndmask_b32 v179, v179, v104, s[56:57]
    s_nop 1
    v_mfma_f32_16x16x32_bf16 v[96:99], v[140:143], v[176:179], v[96:99]
    v_mfma_f32_16x16x32_bf16 v[100:103], v[132:135], v[176:179], v[100:103]
    s_waitcnt lgkmcnt(0)
    v_mfma_f32_16x16x32_bf16 v[32:35], v[108:111], v[156:159], v[32:35]
    v_mfma_f32_16x16x32_bf16 v[40:43], v[112:115], v[156:159], v[40:43]
    v_mfma_f32_16x16x32_bf16 v[48:51], v[116:119], v[156:159], v[48:51]
    ds_read_b128 v[168:171], v253 offset:28672
    ds_read_b128 v[172:175], v253 offset:30720
    v_mfma_f32_16x16x32_bf16 v[56:59], v[120:123], v[156:159], v[56:59]
    ds_read_b64_tr_b16 v[132:133], v240 offset:34816
    v_mfma_f32_16x16x32_bf16 v[64:67], v[156:159], v[124:127], v[64:67]
    ds_read_b64_tr_b16 v[134:135], v240 offset:35584
    ds_read_b64_tr_b16 v[136:137], v241 offset:34816
    v_mfma_f32_16x16x32_bf16 v[72:75], v[156:159], v[128:131], v[72:75]
    ds_read_b64_tr_b16 v[138:139], v241 offset:35584
    v_mfma_f32_16x16x32_bf16 v[80:83], v[104:107], v[156:159], v[80:83]
    ds_read_b64_tr_b16 v[140:141], v242 offset:34816
    ds_read_b64_tr_b16 v[142:143], v242 offset:35584
    v_mfma_f32_16x16x32_bf16 v[88:91], v[156:159], v[156:159], v[88:91]
    ds_read_b64_tr_b16 v[144:145], v243 offset:34816
    v_mfma_f32_16x16x32_bf16 v[36:39], v[108:111], v[160:163], v[36:39]
    ds_read_b64_tr_b16 v[146:147], v243 offset:35584
    ds_read_b64_tr_b16 v[148:149], v244 offset:34816
    v_mfma_f32_16x16x32_bf16 v[44:47], v[112:115], v[160:163], v[44:47]
    ds_read_b64_tr_b16 v[150:151], v244 offset:35584
    v_mfma_f32_16x16x32_bf16 v[52:55], v[116:119], v[160:163], v[52:55]
    ds_read_b64_tr_b16 v[152:153], v245 offset:34816
    ds_read_b64_tr_b16 v[154:155], v245 offset:35584
    v_mfma_f32_16x16x32_bf16 v[60:63], v[120:123], v[160:163], v[60:63]
    ds_read_b128 v[176:179], v25 offset:256
    v_mfma_f32_16x16x32_bf16 v[68:71], v[160:163], v[124:127], v[68:71]
    ds_read_b32 v17, v18 offset:16
    v_cndmask_b32 v164, v164, v104, s[56:57]
    v_mfma_f32_16x16x32_bf16 v[76:79], v[160:163], v[128:131], v[76:79]
    v_cndmask_b32 v165, v165, v104, s[56:57]
    v_mfma_f32_16x16x32_bf16 v[84:87], v[104:107], v[160:163], v[84:87]
    v_cndmask_b32 v166, v166, v104, s[56:57]
    v_mfma_f32_16x16x32_bf16 v[92:95], v[160:163], v[160:163], v[92:95]
    v_cndmask_b32 v167, v167, v104, s[56:57]
    s_nop 1
    v_mfma_f32_16x16x32_bf16 v[96:99], v[116:119], v[164:167], v[96:99]
    v_mfma_f32_16x16x32_bf16 v[100:103], v[108:111], v[164:167], v[100:103]
    s_waitcnt lgkmcnt(0)
    v_mfma_f32_16x16x32_bf16 v[32:35], v[132:135], v[168:171], v[32:35]
    v_mfma_f32_16x16x32_bf16 v[40:43], v[136:139], v[168:171], v[40:43]
    v_readfirstlane_b32 s40, v17
    s_nop 1
    s_cmp_ge_u32 s40, 4
    s_cbranch_scc1 L_sequential_preLN__sliding_local_dilated__geglu_ffn__prompt_kernel_cl0_4x
L_sequential_preLN__sliding_local_dilated__geglu_ffn__prompt_kernel_cl0_4:
    ds_read_b32 v17, v18 offset:16
    s_waitcnt lgkmcnt(0)
    v_readfirstlane_b32 s40, v17
    s_nop 1
    s_cmp_lt_u32 s40, 4
    s_cbranch_scc1 L_sequential_preLN__sliding_local_dilated__geglu_ffn__prompt_kernel_cl0_4
L_sequential_preLN__sliding_local_dilated__geglu_ffn__prompt_kernel_cl0_4x:
    v_mfma_f32_16x16x32_bf16 v[48:51], v[140:143], v[168:171], v[48:51]
    ds_read_b128 v[156:159], v254 offset:0
    ds_read_b128 v[160:163], v254 offset:2048
    v_mfma_f32_16x16x32_bf16 v[56:59], v[144:147], v[168:171], v[56:59]
    ds_read_b64_tr_b16 v[108:109], v246 offset:0
    v_mfma_f32_16x16x32_bf16 v[64:67], v[168:171], v[148:151], v[64:67]
    ds_read_b64_tr_b16 v[110:111], v246 offset:768
    ds_read_b64_tr_b16 v[112:113], v247 offset:0
    v_mfma_f32_16x16x32_bf16 v[72:75], v[168:171], v[152:155], v[72:75]
    ds_read_b64_tr_b16 v[114:115], v247 offset:768
    v_mfma_f32_16x16x32_bf16 v[80:83], v[104:107], v[168:171], v[80:83]
    ds_read_b64_tr_b16 v[116:117], v248 offset:0
    ds_read_b64_tr_b16 v[118:119], v248 offset:768
    v_mfma_f32_16x16x32_bf16 v[88:91], v[168:171], v[168:171], v[88:91]
    ds_read_b64_tr_b16 v[120:121], v249 offset:0
    v_mfma_f32_16x16x32_bf16 v[36:39], v[132:135], v[172:175], v[36:39]
    ds_read_b64_tr_b16 v[122:123], v249 offset:768
    ds_read_b64_tr_b16 v[124:125], v250 offset:0
    v_mfma_f32_16x16x32_bf16 v[44:47], v[136:139], v[172:175], v[44:47]
    ds_read_b64_tr_b16 v[126:127], v250 offset:768
    v_mfma_f32_16x16x32_bf16 v[52:55], v[140:143], v[172:175], v[52:55]
    ds_read_b64_tr_b16 v[128:129], v251 offset:0
    ds_read_b64_tr_b16 v[130:131], v251 offset:768
    v_mfma_f32_16x16x32_bf16 v[60:63], v[144:147], v[172:175], v[60:63]
    ds_read_b128 v[164:167], v22 offset:512
    v_mfma_f32_16x16x32_bf16 v[68:71], v[172:175], v[148:151], v[68:71]
    v_cndmask_b32 v176, v176, v104, s[56:57]
    v_mfma_f32_16x16x32_bf16 v[76:79], v[172:175], v[152:155], v[76:79]
    v_cndmask_b32 v177, v177, v104, s[56:57]
    v_mfma_f32_16x16x32_bf16 v[84:87], v[104:107], v[172:175], v[84:87]
    v_cndmask_b32 v178, v178, v104, s[56:57]
    v_mfma_f32_16x16x32_bf16 v[92:95], v[172:175], v[172:175], v[92:95]
    v_cndmask_b32 v179, v179, v104, s[56:57]
    s_nop 1
    v_mfma_f32_16x16x32_bf16 v[96:99], v[140:143], v[176:179], v[96:99]
    v_mfma_f32_16x16x32_bf16 v[100:103], v[132:135], v[176:179], v[100:103]
    s_waitcnt lgkmcnt(0)
    v_mfma_f32_16x16x32_bf16 v[32:35], v[108:111], v[156:159], v[32:35]
    v_mfma_f32_16x16x32_bf16 v[40:43], v[112:115], v[156:159], v[40:43]
    v_mfma_f32_16x16x32_bf16 v[48:51], v[116:119], v[156:159], v[48:51]
    ds_read_b128 v[168:171], v255 offset:0
    ds_read_b128 v[172:175], v255 offset:2048
    v_mfma_f32_16x16x32_bf16 v[56:59], v[120:123], v[156:159], v[56:59]
    ds_read_b64_tr_b16 v[132:133], v246 offset:6144
    v_mfma_f32_16x16x32_bf16 v[64:67], v[156:159], v[124:127], v[64:67]
    ds_read_b64_tr_b16 v[134:135], v246 offset:6912
    ds_read_b64_tr_b16 v[136:137], v247 offset:6144
    v_mfma_f32_16x16x32_bf16 v[72:75], v[156:159], v[128:131], v[72:75]
    ds_read_b64_tr_b16 v[138:139], v247 offset:6912
    v_mfma_f32_16x16x32_bf16 v[80:83], v[104:107], v[156:159], v[80:83]
    ds_read_b64_tr_b16 v[140:141], v248 offset:6144
    ds_read_b64_tr_b16 v[142:143], v248 offset:6912
    v_mfma_f32_16x16x32_bf16 v[88:91], v[156:159], v[156:159], v[88:91]
    ds_read_b64_tr_b16 v[144:145], v249 offset:6144
    v_mfma_f32_16x16x32_bf16 v[36:39], v[108:111], v[160:163], v[36:39]
    ds_read_b64_tr_b16 v[146:147], v249 offset:6912
    ds_read_b64_tr_b16 v[148:149], v250 offset:6144
    v_mfma_f32_16x16x32_bf16 v[44:47], v[112:115], v[160:163], v[44:47]
    ds_read_b64_tr_b16 v[150:151], v250 offset:6912
    v_mfma_f32_16x16x32_bf16 v[52:55], v[116:119], v[160:163], v[52:55]
    ds_read_b64_tr_b16 v[152:153], v251 offset:6144
    ds_read_b64_tr_b16 v[154:155], v251 offset:6912
    v_mfma_f32_16x16x32_bf16 v[60:63], v[120:123], v[160:163], v[60:63]
    ds_read_b128 v[176:179], v23 offset:512
    v_mfma_f32_16x16x32_bf16 v[68:71], v[160:163], v[124:127], v[68:71]
    ds_read_b32 v17, v18 offset:20
    v_cndmask_b32 v164, v164, v104, s[56:57]
    v_mfma_f32_16x16x32_bf16 v[76:79], v[160:163], v[128:131], v[76:79]
    v_cndmask_b32 v165, v165, v104, s[56:57]
    v_mfma_f32_16x16x32_bf16 v[84:87], v[104:107], v[160:163], v[84:87]
    v_cndmask_b32 v166, v166, v104, s[56:57]
    v_mfma_f32_16x16x32_bf16 v[92:95], v[160:163], v[160:163], v[92:95]
    v_cndmask_b32 v167, v167, v104, s[56:57]
    s_nop 1
    v_mfma_f32_16x16x32_bf16 v[96:99], v[116:119], v[164:167], v[96:99]
    v_mfma_f32_16x16x32_bf16 v[100:103], v[108:111], v[164:167], v[100:103]
    s_waitcnt lgkmcnt(0)
    v_mfma_f32_16x16x32_bf16 v[32:35], v[132:135], v[168:171], v[32:35]
    v_mfma_f32_16x16x32_bf16 v[40:43], v[136:139], v[168:171], v[40:43]
    s_mov_b64 exec, 1
    ds_add_u32 v18, v19 offset:48
    s_mov_b64 exec, -1
    v_readfirstlane_b32 s40, v17
    s_nop 1
    s_cmp_ge_u32 s40, 4
    s_cbranch_scc1 L_sequential_preLN__sliding_local_dilated__geglu_ffn__prompt_kernel_cl0_5x
L_sequential_preLN__sliding_local_dilated__geglu_ffn__prompt_kernel_cl0_5:
    ds_read_b32 v17, v18 offset:20
    s_waitcnt lgkmcnt(0)
    v_readfirstlane_b32 s40, v17
    s_nop 1
    s_cmp_lt_u32 s40, 4
    s_cbranch_scc1 L_sequential_preLN__sliding_local_dilated__geglu_ffn__prompt_kernel_cl0_5
L_sequential_preLN__sliding_local_dilated__geglu_ffn__prompt_kernel_cl0_5x:
    v_mfma_f32_16x16x32_bf16 v[48:51], v[140:143], v[168:171], v[48:51]
    ds_read_b128 v[156:159], v20 offset:0
    ds_read_b128 v[160:163], v20 offset:2048
    v_mfma_f32_16x16x32_bf16 v[56:59], v[144:147], v[168:171], v[56:59]
    ds_read_b64_tr_b16 v[108:109], v26 offset:0
    v_mfma_f32_16x16x32_bf16 v[64:67], v[168:171], v[148:151], v[64:67]
    ds_read_b64_tr_b16 v[110:111], v26 offset:768
    ds_read_b64_tr_b16 v[112:113], v27 offset:0
    v_mfma_f32_16x16x32_bf16 v[72:75], v[168:171], v[152:155], v[72:75]
    ds_read_b64_tr_b16 v[114:115], v27 offset:768
    v_mfma_f32_16x16x32_bf16 v[80:83], v[104:107], v[168:171], v[80:83]
    ds_read_b64_tr_b16 v[116:117], v28 offset:0
    ds_read_b64_tr_b16 v[118:119], v28 offset:768
    v_mfma_f32_16x16x32_bf16 v[88:91], v[168:171], v[168:171], v[88:91]
    ds_read_b64_tr_b16 v[120:121], v29 offset:0
    v_mfma_f32_16x16x32_bf16 v[36:39], v[132:135], v[172:175], v[36:39]
    ds_read_b64_tr_b16 v[122:123], v29 offset:768
    ds_read_b64_tr_b16 v[124:125], v30 offset:0
    v_mfma_f32_16x16x32_bf16 v[44:47], v[136:139], v[172:175], v[44:47]
    ds_read_b64_tr_b16 v[126:127], v30 offset:768
    v_mfma_f32_16x16x32_bf16 v[52:55], v[140:143], v[172:175], v[52:55]
    ds_read_b64_tr_b16 v[128:129], v31 offset:0
    ds_read_b64_tr_b16 v[130:131], v31 offset:768
    v_mfma_f32_16x16x32_bf16 v[60:63], v[144:147], v[172:175], v[60:63]
    ds_read_b128 v[164:167], v24 offset:512
    v_mfma_f32_16x16x32_bf16 v[68:71], v[172:175], v[148:151], v[68:71]
    v_cndmask_b32 v176, v176, v104, s[56:57]
    v_mfma_f32_16x16x32_bf16 v[76:79], v[172:175], v[152:155], v[76:79]
    v_cndmask_b32 v177, v177, v104, s[56:57]
    v_mfma_f32_16x16x32_bf16 v[84:87], v[104:107], v[172:175], v[84:87]
    v_cndmask_b32 v178, v178, v104, s[56:57]
    v_mfma_f32_16x16x32_bf16 v[92:95], v[172:175], v[172:175], v[92:95]
    v_cndmask_b32 v179, v179, v104, s[56:57]
    s_nop 1
    v_mfma_f32_16x16x32_bf16 v[96:99], v[140:143], v[176:179], v[96:99]
    v_mfma_f32_16x16x32_bf16 v[100:103], v[132:135], v[176:179], v[100:103]
    s_waitcnt lgkmcnt(0)
    v_mfma_f32_16x16x32_bf16 v[32:35], v[108:111], v[156:159], v[32:35]
    v_mfma_f32_16x16x32_bf16 v[40:43], v[112:115], v[156:159], v[40:43]
    v_mfma_f32_16x16x32_bf16 v[48:51], v[116:119], v[156:159], v[48:51]
    ds_read_b128 v[168:171], v21 offset:0
    ds_read_b128 v[172:175], v21 offset:2048
    v_mfma_f32_16x16x32_bf16 v[56:59], v[120:123], v[156:159], v[56:59]
    ds_read_b64_tr_b16 v[132:133], v26 offset:6144
    v_mfma_f32_16x16x32_bf16 v[64:67], v[156:159], v[124:127], v[64:67]
    ds_read_b64_tr_b16 v[134:135], v26 offset:6912
    ds_read_b64_tr_b16 v[136:137], v27 offset:6144
    v_mfma_f32_16x16x32_bf16 v[72:75], v[156:159], v[128:131], v[72:75]
    ds_read_b64_tr_b16 v[138:139], v27 offset:6912
    v_mfma_f32_16x16x32_bf16 v[80:83], v[104:107], v[156:159], v[80:83]
    ds_read_b64_tr_b16 v[140:141], v28 offset:6144
    ds_read_b64_tr_b16 v[142:143], v28 offset:6912
    v_mfma_f32_16x16x32_bf16 v[88:91], v[156:159], v[156:159], v[88:91]
    ds_read_b64_tr_b16 v[144:145], v29 offset:6144
    v_mfma_f32_16x16x32_bf16 v[36:39], v[108:111], v[160:163], v[36:39]
    ds_read_b64_tr_b16 v[146:147], v29 offset:6912
    ds_read_b64_tr_b16 v[148:149], v30 offset:6144
    v_mfma_f32_16x16x32_bf16 v[44:47], v[112:115], v[160:163], v[44:47]
    ds_read_b64_tr_b16 v[150:151], v30 offset:6912
    v_mfma_f32_16x16x32_bf16 v[52:55], v[116:119], v[160:163], v[52:55]
    ds_read_b64_tr_b16 v[152:153], v31 offset:6144
    ds_read_b64_tr_b16 v[154:155], v31 offset:6912
    v_mfma_f32_16x16x32_bf16 v[60:63], v[120:123], v[160:163], v[60:63]
    ds_read_b128 v[176:179], v25 offset:512
    v_mfma_f32_16x16x32_bf16 v[68:71], v[160:163], v[124:127], v[68:71]
    ds_read_b32 v17, v18 offset:24
    v_cndmask_b32 v164, v164, v104, s[56:57]
    v_mfma_f32_16x16x32_bf16 v[76:79], v[160:163], v[128:131], v[76:79]
    v_cndmask_b32 v165, v165, v104, s[56:57]
    v_mfma_f32_16x16x32_bf16 v[84:87], v[104:107], v[160:163], v[84:87]
    v_cndmask_b32 v166, v166, v104, s[56:57]
    v_mfma_f32_16x16x32_bf16 v[92:95], v[160:163], v[160:163], v[92:95]
    v_cndmask_b32 v167, v167, v104, s[56:57]
    s_nop 1
    v_mfma_f32_16x16x32_bf16 v[96:99], v[116:119], v[164:167], v[96:99]
    v_mfma_f32_16x16x32_bf16 v[100:103], v[108:111], v[164:167], v[100:103]
    s_waitcnt lgkmcnt(0)
    v_mfma_f32_16x16x32_bf16 v[32:35], v[132:135], v[168:171], v[32:35]
    v_mfma_f32_16x16x32_bf16 v[40:43], v[136:139], v[168:171], v[40:43]
    v_readfirstlane_b32 s40, v17
    s_nop 1
    s_cmp_ge_u32 s40, 4
    s_cbranch_scc1 L_sequential_preLN__sliding_local_dilated__geglu_ffn__prompt_kernel_cl0_6x
L_sequential_preLN__sliding_local_dilated__geglu_ffn__prompt_kernel_cl0_6:
    ds_read_b32 v17, v18 offset:24
    s_waitcnt lgkmcnt(0)
    v_readfirstlane_b32 s40, v17
    s_nop 1
    s_cmp_lt_u32 s40, 4
    s_cbranch_scc1 L_sequential_preLN__sliding_local_dilated__geglu_ffn__prompt_kernel_cl0_6
L_sequential_preLN__sliding_local_dilated__geglu_ffn__prompt_kernel_cl0_6x:
    v_mfma_f32_16x16x32_bf16 v[48:51], v[140:143], v[168:171], v[48:51]
    ds_read_b128 v[156:159], v20 offset:28672
    ds_read_b128 v[160:163], v20 offset:30720
    v_mfma_f32_16x16x32_bf16 v[56:59], v[144:147], v[168:171], v[56:59]
    ds_read_b64_tr_b16 v[108:109], v26 offset:28672
    v_mfma_f32_16x16x32_bf16 v[64:67], v[168:171], v[148:151], v[64:67]
    ds_read_b64_tr_b16 v[110:111], v26 offset:29440
    ds_read_b64_tr_b16 v[112:113], v27 offset:28672
    v_mfma_f32_16x16x32_bf16 v[72:75], v[168:171], v[152:155], v[72:75]
    ds_read_b64_tr_b16 v[114:115], v27 offset:29440
    v_mfma_f32_16x16x32_bf16 v[80:83], v[104:107], v[168:171], v[80:83]
    ds_read_b64_tr_b16 v[116:117], v28 offset:28672
    ds_read_b64_tr_b16 v[118:119], v28 offset:29440
    v_mfma_f32_16x16x32_bf16 v[88:91], v[168:171], v[168:171], v[88:91]
    ds_read_b64_tr_b16 v[120:121], v29 offset:28672
    v_mfma_f32_16x16x32_bf16 v[36:39], v[132:135], v[172:175], v[36:39]
    ds_read_b64_tr_b16 v[122:123], v29 offset:29440
    ds_read_b64_tr_b16 v[124:125], v30 offset:28672
    v_mfma_f32_16x16x32_bf16 v[44:47], v[136:139], v[172:175], v[44:47]
    ds_read_b64_tr_b16 v[126:127], v30 offset:29440
    v_mfma_f32_16x16x32_bf16 v[52:55], v[140:143], v[172:175], v[52:55]
    ds_read_b64_tr_b16 v[128:129], v31 offset:28672
    ds_read_b64_tr_b16 v[130:131], v31 offset:29440
    v_mfma_f32_16x16x32_bf16 v[60:63], v[144:147], v[172:175], v[60:63]
    ds_read_b128 v[164:167], v22 offset:768
    v_mfma_f32_16x16x32_bf16 v[68:71], v[172:175], v[148:151], v[68:71]
    v_cndmask_b32 v176, v176, v104, s[56:57]
    v_mfma_f32_16x16x32_bf16 v[76:79], v[172:175], v[152:155], v[76:79]
    v_cndmask_b32 v177, v177, v104, s[56:57]
    v_mfma_f32_16x16x32_bf16 v[84:87], v[104:107], v[172:175], v[84:87]
    v_cndmask_b32 v178, v178, v104, s[56:57]
    v_mfma_f32_16x16x32_bf16 v[92:95], v[172:175], v[172:175], v[92:95]
    v_cndmask_b32 v179, v179, v104, s[56:57]
    s_nop 1
    v_mfma_f32_16x16x32_bf16 v[96:99], v[140:143], v[176:179], v[96:99]
    v_mfma_f32_16x16x32_bf16 v[100:103], v[132:135], v[176:179], v[100:103]
    s_waitcnt lgkmcnt(0)
    v_mfma_f32_16x16x32_bf16 v[32:35], v[108:111], v[156:159], v[32:35]
    v_mfma_f32_16x16x32_bf16 v[40:43], v[112:115], v[156:159], v[40:43]
    v_mfma_f32_16x16x32_bf16 v[48:51], v[116:119], v[156:159], v[48:51]
    ds_read_b128 v[168:171], v21 offset:28672
    ds_read_b128 v[172:175], v21 offset:30720
    v_mfma_f32_16x16x32_bf16 v[56:59], v[120:123], v[156:159], v[56:59]
    ds_read_b64_tr_b16 v[132:133], v26 offset:34816
    v_mfma_f32_16x16x32_bf16 v[64:67], v[156:159], v[124:127], v[64:67]
    ds_read_b64_tr_b16 v[134:135], v26 offset:35584
    ds_read_b64_tr_b16 v[136:137], v27 offset:34816
    v_mfma_f32_16x16x32_bf16 v[72:75], v[156:159], v[128:131], v[72:75]
    ds_read_b64_tr_b16 v[138:139], v27 offset:35584
    v_mfma_f32_16x16x32_bf16 v[80:83], v[104:107], v[156:159], v[80:83]
    ds_read_b64_tr_b16 v[140:141], v28 offset:34816
    ds_read_b64_tr_b16 v[142:143], v28 offset:35584
    v_mfma_f32_16x16x32_bf16 v[88:91], v[156:159], v[156:159], v[88:91]
    ds_read_b64_tr_b16 v[144:145], v29 offset:34816
    v_mfma_f32_16x16x32_bf16 v[36:39], v[108:111], v[160:163], v[36:39]
    ds_read_b64_tr_b16 v[146:147], v29 offset:35584
    ds_read_b64_tr_b16 v[148:149], v30 offset:34816
    v_mfma_f32_16x16x32_bf16 v[44:47], v[112:115], v[160:163], v[44:47]
    ds_read_b64_tr_b16 v[150:151], v30 offset:35584
    v_mfma_f32_16x16x32_bf16 v[52:55], v[116:119], v[160:163], v[52:55]
    ds_read_b64_tr_b16 v[152:153], v31 offset:34816
    ds_read_b64_tr_b16 v[154:155], v31 offset:35584
    v_mfma_f32_16x16x32_bf16 v[60:63], v[120:123], v[160:163], v[60:63]
    ds_read_b128 v[176:179], v23 offset:768
    v_mfma_f32_16x16x32_bf16 v[68:71], v[160:163], v[124:127], v[68:71]
    ds_read_b32 v17, v18 offset:28
    v_cndmask_b32 v164, v164, v104, s[56:57]
    v_mfma_f32_16x16x32_bf16 v[76:79], v[160:163], v[128:131], v[76:79]
    v_cndmask_b32 v165, v165, v104, s[56:57]
    v_mfma_f32_16x16x32_bf16 v[84:87], v[104:107], v[160:163], v[84:87]
    v_cndmask_b32 v166, v166, v104, s[56:57]
    v_mfma_f32_16x16x32_bf16 v[92:95], v[160:163], v[160:163], v[92:95]
    v_cndmask_b32 v167, v167, v104, s[56:57]
    s_nop 1
    v_mfma_f32_16x16x32_bf16 v[96:99], v[116:119], v[164:167], v[96:99]
    v_mfma_f32_16x16x32_bf16 v[100:103], v[108:111], v[164:167], v[100:103]
    s_waitcnt lgkmcnt(0)
    v_mfma_f32_16x16x32_bf16 v[32:35], v[132:135], v[168:171], v[32:35]
    v_mfma_f32_16x16x32_bf16 v[40:43], v[136:139], v[168:171], v[40:43]
    v_readfirstlane_b32 s40, v17
    s_nop 1
    s_cmp_ge_u32 s40, 4
    s_cbranch_scc1 L_sequential_preLN__sliding_local_dilated__geglu_ffn__prompt_kernel_cl0_7x
L_sequential_preLN__sliding_local_dilated__geglu_ffn__prompt_kernel_cl0_7:
    ds_read_b32 v17, v18 offset:28
    s_waitcnt lgkmcnt(0)
    v_readfirstlane_b32 s40, v17
    s_nop 1
    s_cmp_lt_u32 s40, 4
    s_cbranch_scc1 L_sequential_preLN__sliding_local_dilated__geglu_ffn__prompt_kernel_cl0_7
L_sequential_preLN__sliding_local_dilated__geglu_ffn__prompt_kernel_cl0_7x:
    v_mfma_f32_16x16x32_bf16 v[48:51], v[140:143], v[168:171], v[48:51]
    ds_read_b128 v[156:159], v252 offset:0
    ds_read_b128 v[160:163], v252 offset:2048
    v_mfma_f32_16x16x32_bf16 v[56:59], v[144:147], v[168:171], v[56:59]
    ds_read_b64_tr_b16 v[108:109], v240 offset:0
    v_mfma_f32_16x16x32_bf16 v[64:67], v[168:171], v[148:151], v[64:67]
    ds_read_b64_tr_b16 v[110:111], v240 offset:768
    ds_read_b64_tr_b16 v[112:113], v241 offset:0
    v_mfma_f32_16x16x32_bf16 v[72:75], v[168:171], v[152:155], v[72:75]
    ds_read_b64_tr_b16 v[114:115], v241 offset:768
    v_mfma_f32_16x16x32_bf16 v[80:83], v[104:107], v[168:171], v[80:83]
    ds_read_b64_tr_b16 v[116:117], v242 offset:0
    ds_read_b64_tr_b16 v[118:119], v242 offset:768
    v_mfma_f32_16x16x32_bf16 v[88:91], v[168:171], v[168:171], v[88:91]
    ds_read_b64_tr_b16 v[120:121], v243 offset:0
    v_mfma_f32_16x16x32_bf16 v[36:39], v[132:135], v[172:175], v[36:39]
    ds_read_b64_tr_b16 v[122:123], v243 offset:768
    ds_read_b64_tr_b16 v[124:125], v244 offset:0
    v_mfma_f32_16x16x32_bf16 v[44:47], v[136:139], v[172:175], v[44:47]
    ds_read_b64_tr_b16 v[126:127], v244 offset:768
    v_mfma_f32_16x16x32_bf16 v[52:55], v[140:143], v[172:175], v[52:55]
    ds_read_b64_tr_b16 v[128:129], v245 offset:0
    ds_read_b64_tr_b16 v[130:131], v245 offset:768
    v_mfma_f32_16x16x32_bf16 v[60:63], v[144:147], v[172:175], v[60:63]
    ds_read_b128 v[164:167], v24 offset:768
    v_mfma_f32_16x16x32_bf16 v[68:71], v[172:175], v[148:151], v[68:71]
    v_cndmask_b32 v176, v176, v104, s[56:57]
    v_mfma_f32_16x16x32_bf16 v[76:79], v[172:175], v[152:155], v[76:79]
    v_cndmask_b32 v177, v177, v104, s[56:57]
    v_mfma_f32_16x16x32_bf16 v[84:87], v[104:107], v[172:175], v[84:87]
    v_cndmask_b32 v178, v178, v104, s[56:57]
    v_mfma_f32_16x16x32_bf16 v[92:95], v[172:175], v[172:175], v[92:95]
    v_cndmask_b32 v179, v179, v104, s[56:57]
    s_nop 1
    v_mfma_f32_16x16x32_bf16 v[96:99], v[140:143], v[176:179], v[96:99]
    v_mfma_f32_16x16x32_bf16 v[100:103], v[132:135], v[176:179], v[100:103]
    s_waitcnt lgkmcnt(0)
    v_mfma_f32_16x16x32_bf16 v[32:35], v[108:111], v[156:159], v[32:35]
    v_mfma_f32_16x16x32_bf16 v[40:43], v[112:115], v[156:159], v[40:43]
    v_mfma_f32_16x16x32_bf16 v[48:51], v[116:119], v[156:159], v[48:51]
    ds_read_b128 v[168:171], v253 offset:0
    ds_read_b128 v[172:175], v253 offset:2048
    v_mfma_f32_16x16x32_bf16 v[56:59], v[120:123], v[156:159], v[56:59]
    ds_read_b64_tr_b16 v[132:133], v240 offset:6144
    v_mfma_f32_16x16x32_bf16 v[64:67], v[156:159], v[124:127], v[64:67]
    ds_read_b64_tr_b16 v[134:135], v240 offset:6912
    ds_read_b64_tr_b16 v[136:137], v241 offset:6144
    v_mfma_f32_16x16x32_bf16 v[72:75], v[156:159], v[128:131], v[72:75]
    ds_read_b64_tr_b16 v[138:139], v241 offset:6912
    v_mfma_f32_16x16x32_bf16 v[80:83], v[104:107], v[156:159], v[80:83]
    ds_read_b64_tr_b16 v[140:141], v242 offset:6144
    ds_read_b64_tr_b16 v[142:143], v242 offset:6912
    v_mfma_f32_16x16x32_bf16 v[88:91], v[156:159], v[156:159], v[88:91]
    ds_read_b64_tr_b16 v[144:145], v243 offset:6144
    v_mfma_f32_16x16x32_bf16 v[36:39], v[108:111], v[160:163], v[36:39]
    ds_read_b64_tr_b16 v[146:147], v243 offset:6912
    ds_read_b64_tr_b16 v[148:149], v244 offset:6144
    v_mfma_f32_16x16x32_bf16 v[44:47], v[112:115], v[160:163], v[44:47]
    ds_read_b64_tr_b16 v[150:151], v244 offset:6912
    v_mfma_f32_16x16x32_bf16 v[52:55], v[116:119], v[160:163], v[52:55]
    ds_read_b64_tr_b16 v[152:153], v245 offset:6144
    ds_read_b64_tr_b16 v[154:155], v245 offset:6912
    v_mfma_f32_16x16x32_bf16 v[60:63], v[120:123], v[160:163], v[60:63]
    ds_read_b128 v[176:179], v25 offset:768
    v_mfma_f32_16x16x32_bf16 v[68:71], v[160:163], v[124:127], v[68:71]
    v_cndmask_b32 v164, v164, v104, s[56:57]
    v_mfma_f32_16x16x32_bf16 v[76:79], v[160:163], v[128:131], v[76:79]
    v_cndmask_b32 v165, v165, v104, s[56:57]
    v_mfma_f32_16x16x32_bf16 v[84:87], v[104:107], v[160:163], v[84:87]
    v_cndmask_b32 v166, v166, v104, s[56:57]
    v_mfma_f32_16x16x32_bf16 v[92:95], v[160:163], v[160:163], v[92:95]
    v_cndmask_b32 v167, v167, v104, s[56:57]
    s_nop 1
    v_mfma_f32_16x16x32_bf16 v[96:99], v[116:119], v[164:167], v[96:99]
    v_mfma_f32_16x16x32_bf16 v[100:103], v[108:111], v[164:167], v[100:103]
    s_waitcnt lgkmcnt(0)
    v_mfma_f32_16x16x32_bf16 v[32:35], v[132:135], v[168:171], v[32:35]
    v_mfma_f32_16x16x32_bf16 v[40:43], v[136:139], v[168:171], v[40:43]
    v_mfma_f32_16x16x32_bf16 v[48:51], v[140:143], v[168:171], v[48:51]
    v_mfma_f32_16x16x32_bf16 v[56:59], v[144:147], v[168:171], v[56:59]
    v_mfma_f32_16x16x32_bf16 v[64:67], v[168:171], v[148:151], v[64:67]
    v_mfma_f32_16x16x32_bf16 v[72:75], v[168:171], v[152:155], v[72:75]
    v_mfma_f32_16x16x32_bf16 v[80:83], v[104:107], v[168:171], v[80:83]
    v_mfma_f32_16x16x32_bf16 v[88:91], v[168:171], v[168:171], v[88:91]
    v_mfma_f32_16x16x32_bf16 v[36:39], v[132:135], v[172:175], v[36:39]
    v_mfma_f32_16x16x32_bf16 v[44:47], v[136:139], v[172:175], v[44:47]
    v_mfma_f32_16x16x32_bf16 v[52:55], v[140:143], v[172:175], v[52:55]
    v_mfma_f32_16x16x32_bf16 v[60:63], v[144:147], v[172:175], v[60:63]
    v_mfma_f32_16x16x32_bf16 v[68:71], v[172:175], v[148:151], v[68:71]
    v_cndmask_b32 v176, v176, v104, s[56:57]
    v_mfma_f32_16x16x32_bf16 v[76:79], v[172:175], v[152:155], v[76:79]
    v_cndmask_b32 v177, v177, v104, s[56:57]
    v_mfma_f32_16x16x32_bf16 v[84:87], v[104:107], v[172:175], v[84:87]
    v_cndmask_b32 v178, v178, v104, s[56:57]
    v_mfma_f32_16x16x32_bf16 v[92:95], v[172:175], v[172:175], v[92:95]
    v_cndmask_b32 v179, v179, v104, s[56:57]
    s_nop 1
    v_mfma_f32_16x16x32_bf16 v[96:99], v[140:143], v[176:179], v[96:99]
    v_mfma_f32_16x16x32_bf16 v[100:103], v[132:135], v[176:179], v[100:103]
    s_nop 7
L_sequential_preLN__sliding_local_dilated__geglu_ffn__prompt_kernel_cx0:
    ds_read_b32 v17, v18 offset:48
    s_waitcnt lgkmcnt(0)
    v_readfirstlane_b32 s40, v17
    s_nop 1
    s_cmp_lt_u32 s40, 4
    s_nop 1
    s_cbranch_scc1 L_sequential_preLN__sliding_local_dilated__geglu_ffn__prompt_kernel_cx0
    v_lshlrev_b32 v9, 3, v6
    v_add_u32 v9, 131328, v9
    v_lshlrev_b32 v15, 2, v6
    v_add_u32 v15, 131328, v15
    v_add_u32 v14, 131328, v1
    v_cndmask_b32 v10, v88, v89, s[58:59]
    v_cndmask_b32 v10, v10, v90, s[60:61]
    v_cndmask_b32 v10, v10, v91, s[62:63]
    v_mul_f32 v11, 0.001953125, v80
    v_mul_f32 v10, 0.001953125, v10
    v_fma_f32 v10, -v11, v11, v10
    v_max_f32 v10, 0, v10
    v_add_f32 v10, 0x3727c5ac, v10
    v_rsq_f32 v12, v10
    s_nop 0
    v_mul_f32 v13, v11, v12
    v_sub_f32 v13, 0, v13
    s_mov_b64 exec, s[84:85]
    ds_write_b64 v9, v[12:13] offset:0
    ds_write_b32 v15, v12 offset:640
    ds_write_b32 v15, v13 offset:704
    s_mov_b64 exec, -1
    ds_write_b128 v14, v[52:55] offset:12288
    ds_write_b128 v14, v[60:63] offset:13312
    ds_write_b128 v14, v[68:71] offset:14336
    ds_write_b128 v14, v[76:79] offset:15360
    v_cndmask_b32 v10, v92, v93, s[58:59]
    v_cndmask_b32 v10, v10, v94, s[60:61]
    v_cndmask_b32 v10, v10, v95, s[62:63]
    v_mul_f32 v11, 0.001953125, v84
    v_mul_f32 v10, 0.001953125, v10
    v_fma_f32 v10, -v11, v11, v10
    v_max_f32 v10, 0, v10
    v_add_f32 v10, 0x3727c5ac, v10
    v_rsq_f32 v12, v10
    s_nop 0
    v_mul_f32 v13, v11, v12
    v_sub_f32 v13, 0, v13
    s_mov_b64 exec, s[84:85]
    ds_write_b64 v9, v[12:13] offset:128
    ds_write_b32 v15, v12 offset:768
    ds_write_b32 v15, v13 offset:832
    s_mov_b64 exec, -1
    ds_write_b128 v14, v[96:99] offset:1024
    v_lshlrev_b32 v11, 4, v5
    v_add_u32 v11, 131328, v11
    s_mov_b64 exec, s[56:57]
    ds_write_b128 v11, v[96:99] offset:512
    ds_write_b128 v11, v[100:103] offset:576
    s_mov_b64 exec, -1
    v_lshlrev_b32 v9, 3, v6
    v_lshlrev_b32 v10, 5, v5
    v_lshlrev_b32 v11, 4, v5
    v_lshlrev_b32 v12, 2, v6
    v_add_u32 v9, 131328, v9
    v_add_u32 v10, 131328, v10
    v_add_u32 v11, 131328, v11
    v_add_u32 v12, 131328, v12
    s_waitcnt lgkmcnt(0)
    s_barrier
    ds_read_b64 v[110:111], v9 offset:0
    ds_read_b128 v[140:143], v11 offset:576
    ds_read_b128 v[148:151], v11 offset:512
    ds_read_b32 v156, v12 offset:6656
    ds_read_b128 v[144:147], v11 offset:3648
    ds_read_b128 v[152:155], v11 offset:3584
    ds_read_b32 v157, v12 offset:6720
    ds_read_b128 v[124:127], v11 offset:640
    ds_read_b128 v[128:131], v11 offset:704
    ds_read_b64 v[108:109], v9 offset:9472
    ds_read_b128 v[116:119], v11 offset:10112
    ds_read_b128 v[120:123], v11 offset:10176
    ds_read_b64 v[112:113], v9 offset:128
    ds_read_b128 v[132:135], v11 offset:768
    ds_read_b128 v[136:139], v11 offset:832
    ds_read_b128 v[160:163], v14 offset:1024
    ds_read_b128 v[164:167], v14 offset:4096
    ds_read_b128 v[168:171], v14 offset:7168
    ds_read_b128 v[172:175], v14 offset:8192
    s_waitcnt lgkmcnt(10)
    v_pk_mul_f32 v[16:17], v[140:141], v[110:111] op_sel:[0,1] op_sel_hi:[1,1]
    v_pk_fma_f32 v[16:17], v[32:33], v[110:111], v[16:17] op_sel_hi:[1,0,1]
    v_pk_mul_f32 v[18:19], v[142:143], v[110:111] op_sel:[0,1] op_sel_hi:[1,1]
    v_pk_fma_f32 v[18:19], v[34:35], v[110:111], v[18:19] op_sel_hi:[1,0,1]
    v_cvt_pk_bf16_f32 v190, v16, v17
    v_cvt_pk_bf16_f32 v191, v18, v19
    v_pk_mul_f32 v[224:225], v[144:145], v[110:111] op_sel:[0,1] op_sel_hi:[1,1]
    v_pk_fma_f32 v[224:225], v[40:41], v[110:111], v[224:225] op_sel_hi:[1,0,1]
    v_pk_mul_f32 v[226:227], v[146:147], v[110:111] op_sel:[0,1] op_sel_hi:[1,1]
    v_pk_fma_f32 v[226:227], v[42:43], v[110:111], v[226:227] op_sel_hi:[1,0,1]
    v_cvt_pk_bf16_f32 v196, v224, v225
    v_cvt_pk_bf16_f32 v197, v226, v227
    v_pk_mul_f32 v[16:17], v[148:149], v[110:111] op_sel:[0,1] op_sel_hi:[1,1]
    v_pk_fma_f32 v[16:17], v[48:49], v[110:111], v[16:17] op_sel_hi:[1,0,1]
    v_pk_mul_f32 v[18:19], v[150:151], v[110:111] op_sel:[0,1] op_sel_hi:[1,1]
    v_pk_fma_f32 v[18:19], v[50:51], v[110:111], v[18:19] op_sel_hi:[1,0,1]
    v_cvt_pk_bf16_f32 v202, v16, v17
    v_cvt_pk_bf16_f32 v203, v18, v19
    v_pk_mul_f32 v[224:225], v[152:153], v[110:111] op_sel:[0,1] op_sel_hi:[1,1]
    v_pk_fma_f32 v[224:225], v[56:57], v[110:111], v[224:225] op_sel_hi:[1,0,1]
    v_pk_mul_f32 v[226:227], v[154:155], v[110:111] op_sel:[0,1] op_sel_hi:[1,1]
    v_pk_fma_f32 v[226:227], v[58:59], v[110:111], v[226:227] op_sel_hi:[1,0,1]
    v_cvt_pk_bf16_f32 v208, v224, v225
    v_cvt_pk_bf16_f32 v209, v226, v227
    v_pk_mul_f32 v[16:17], v[128:129], v[156:157] op_sel_hi:[1,0]
    v_pk_fma_f32 v[16:17], v[64:65], v[124:125], v[16:17]
    v_pk_mul_f32 v[18:19], v[130:131], v[156:157] op_sel_hi:[1,0]
    v_pk_fma_f32 v[18:19], v[66:67], v[126:127], v[18:19]
    v_cvt_pk_bf16_f32 v214, v16, v17
    v_cvt_pk_bf16_f32 v215, v18, v19
    v_pk_mul_f32 v[224:225], v[128:129], v[156:157] op_sel:[0,1] op_sel_hi:[1,1]
    v_pk_fma_f32 v[224:225], v[72:73], v[124:125], v[224:225]
    v_pk_mul_f32 v[226:227], v[130:131], v[156:157] op_sel:[0,1] op_sel_hi:[1,1]
    v_pk_fma_f32 v[226:227], v[74:75], v[126:127], v[226:227]
    v_cvt_pk_bf16_f32 v220, v224, v225
    v_cvt_pk_bf16_f32 v221, v226, v227
    s_waitcnt lgkmcnt(0)
    v_pk_mul_f32 v[16:17], v[140:141], v[112:113] op_sel:[0,1] op_sel_hi:[1,1]
    v_pk_fma_f32 v[16:17], v[36:37], v[112:113], v[16:17] op_sel_hi:[1,0,1]
    v_pk_mul_f32 v[18:19], v[142:143], v[112:113] op_sel:[0,1] op_sel_hi:[1,1]
    v_pk_fma_f32 v[18:19], v[38:39], v[112:113], v[18:19] op_sel_hi:[1,0,1]
    v_cvt_pk_bf16_f32 v192, v16, v17
    v_cvt_pk_bf16_f32 v193, v18, v19
    v_pk_mul_f32 v[224:225], v[144:145], v[112:113] op_sel:[0,1] op_sel_hi:[1,1]
    v_pk_fma_f32 v[224:225], v[44:45], v[112:113], v[224:225] op_sel_hi:[1,0,1]
    v_pk_mul_f32 v[226:227], v[146:147], v[112:113] op_sel:[0,1] op_sel_hi:[1,1]
    v_pk_fma_f32 v[226:227], v[46:47], v[112:113], v[226:227] op_sel_hi:[1,0,1]
    v_cvt_pk_bf16_f32 v198, v224, v225
    v_cvt_pk_bf16_f32 v199, v226, v227
    v_pk_mul_f32 v[16:17], v[148:149], v[112:113] op_sel:[0,1] op_sel_hi:[1,1]
    v_pk_fma_f32 v[16:17], v[52:53], v[112:113], v[16:17] op_sel_hi:[1,0,1]
    v_pk_mul_f32 v[18:19], v[150:151], v[112:113] op_sel:[0,1] op_sel_hi:[1,1]
    v_pk_fma_f32 v[18:19], v[54:55], v[112:113], v[18:19] op_sel_hi:[1,0,1]
    v_cvt_pk_bf16_f32 v204, v16, v17
    v_cvt_pk_bf16_f32 v205, v18, v19
    v_pk_mul_f32 v[224:225], v[152:153], v[112:113] op_sel:[0,1] op_sel_hi:[1,1]
    v_pk_fma_f32 v[224:225], v[60:61], v[112:113], v[224:225] op_sel_hi:[1,0,1]
    v_pk_mul_f32 v[226:227], v[154:155], v[112:113] op_sel:[0,1] op_sel_hi:[1,1]
    v_pk_fma_f32 v[226:227], v[62:63], v[112:113], v[226:227] op_sel_hi:[1,0,1]
    v_cvt_pk_bf16_f32 v210, v224, v225
    v_cvt_pk_bf16_f32 v211, v226, v227
    v_pk_mul_f32 v[16:17], v[136:137], v[156:157] op_sel_hi:[1,0]
    v_pk_fma_f32 v[16:17], v[68:69], v[132:133], v[16:17]
    v_pk_mul_f32 v[18:19], v[138:139], v[156:157] op_sel_hi:[1,0]
    v_pk_fma_f32 v[18:19], v[70:71], v[134:135], v[18:19]
    v_cvt_pk_bf16_f32 v216, v16, v17
    v_cvt_pk_bf16_f32 v217, v18, v19
    v_pk_mul_f32 v[224:225], v[136:137], v[156:157] op_sel:[0,1] op_sel_hi:[1,1]
    v_pk_fma_f32 v[224:225], v[76:77], v[132:133], v[224:225]
    v_pk_mul_f32 v[226:227], v[138:139], v[156:157] op_sel:[0,1] op_sel_hi:[1,1]
    v_pk_fma_f32 v[226:227], v[78:79], v[134:135], v[226:227]
    v_cvt_pk_bf16_f32 v222, v224, v225
    v_cvt_pk_bf16_f32 v223, v226, v227
    v_pk_mul_f32 v[16:17], v[148:149], v[108:109] op_sel:[0,1] op_sel_hi:[1,1]
    v_pk_fma_f32 v[16:17], v[160:161], v[108:109], v[16:17] op_sel_hi:[1,0,1]
    v_pk_mul_f32 v[18:19], v[150:151], v[108:109] op_sel:[0,1] op_sel_hi:[1,1]
    v_pk_fma_f32 v[18:19], v[162:163], v[108:109], v[18:19] op_sel_hi:[1,0,1]
    v_cvt_pk_bf16_f32 v200, v16, v17
    v_cvt_pk_bf16_f32 v201, v18, v19
    v_pk_mul_f32 v[224:225], v[152:153], v[108:109] op_sel:[0,1] op_sel_hi:[1,1]
    v_pk_fma_f32 v[224:225], v[164:165], v[108:109], v[224:225] op_sel_hi:[1,0,1]
    v_pk_mul_f32 v[226:227], v[154:155], v[108:109] op_sel:[0,1] op_sel_hi:[1,1]
    v_pk_fma_f32 v[226:227], v[166:167], v[108:109], v[226:227] op_sel_hi:[1,0,1]
    v_cvt_pk_bf16_f32 v206, v224, v225
    v_cvt_pk_bf16_f32 v207, v226, v227
    v_pk_mul_f32 v[16:17], v[120:121], v[156:157] op_sel_hi:[1,0]
    v_pk_fma_f32 v[16:17], v[168:169], v[116:117], v[16:17]
    v_pk_mul_f32 v[18:19], v[122:123], v[156:157] op_sel_hi:[1,0]
    v_pk_fma_f32 v[18:19], v[170:171], v[118:119], v[18:19]
    v_cvt_pk_bf16_f32 v212, v16, v17
    v_cvt_pk_bf16_f32 v213, v18, v19
    v_pk_mul_f32 v[224:225], v[120:121], v[156:157] op_sel:[0,1] op_sel_hi:[1,1]
    v_pk_fma_f32 v[224:225], v[172:173], v[116:117], v[224:225]
    v_pk_mul_f32 v[226:227], v[122:123], v[156:157] op_sel:[0,1] op_sel_hi:[1,1]
    v_pk_fma_f32 v[226:227], v[174:175], v[118:119], v[226:227]
    v_cvt_pk_bf16_f32 v218, v224, v225
    v_cvt_pk_bf16_f32 v219, v226, v227
    v_mfma_f32_16x16x16_bf16 v[32:35], v[200:201], v[190:191], 0
    v_mfma_f32_16x16x16_bf16 v[36:39], v[202:203], v[190:191], 0
    v_mfma_f32_16x16x16_bf16 v[40:43], v[206:207], v[196:197], 0
    v_mfma_f32_16x16x16_bf16 v[44:47], v[208:209], v[196:197], 0
    v_mfma_f32_16x16x16_bf16 v[48:51], v[202:203], v[192:193], 0
    v_mfma_f32_16x16x16_bf16 v[52:55], v[204:205], v[192:193], 0
    v_mfma_f32_16x16x16_bf16 v[56:59], v[208:209], v[198:199], 0
    v_mfma_f32_16x16x16_bf16 v[60:63], v[210:211], v[198:199], 0
    v_mov_b32 v132, s87
    v_pk_fma_f32 v[32:33], v[32:33], v[132:133], v[236:237] op_sel_hi:[1,0,1]
    v_pk_fma_f32 v[34:35], v[34:35], v[132:133], v[238:239] op_sel_hi:[1,0,1]
    v_pk_fma_f32 v[36:37], v[36:37], v[132:133], v[228:229] op_sel_hi:[1,0,1]
    v_pk_fma_f32 v[38:39], v[38:39], v[132:133], v[230:231] op_sel_hi:[1,0,1]
    v_max3_f32 v108, v32, v33, v34
    v_max3_f32 v108, v108, v35, v36
    v_max3_f32 v108, v108, v37, v38
    v_max_f32 v108, v108, v39
    v_pk_fma_f32 v[40:41], v[40:41], v[132:133], v[236:237] op_sel_hi:[1,0,1]
    v_pk_fma_f32 v[42:43], v[42:43], v[132:133], v[238:239] op_sel_hi:[1,0,1]
    v_pk_fma_f32 v[44:45], v[44:45], v[132:133], v[228:229] op_sel_hi:[1,0,1]
    v_pk_fma_f32 v[46:47], v[46:47], v[132:133], v[230:231] op_sel_hi:[1,0,1]
    v_max3_f32 v110, v40, v41, v42
    v_max3_f32 v110, v110, v43, v44
    v_max3_f32 v110, v110, v45, v46
    v_max_f32 v110, v110, v47
    v_pk_fma_f32 v[48:49], v[48:49], v[132:133], v[232:233] op_sel_hi:[1,0,1]
    v_pk_fma_f32 v[50:51], v[50:51], v[132:133], v[234:235] op_sel_hi:[1,0,1]
    v_pk_fma_f32 v[52:53], v[52:53], v[132:133], v[228:229] op_sel_hi:[1,0,1]
    v_pk_fma_f32 v[54:55], v[54:55], v[132:133], v[230:231] op_sel_hi:[1,0,1]
    v_max3_f32 v112, v48, v49, v50
    v_max3_f32 v112, v112, v51, v52
    v_max3_f32 v112, v112, v53, v54
    v_max_f32 v112, v112, v55
    v_pk_fma_f32 v[56:57], v[56:57], v[132:133], v[232:233] op_sel_hi:[1,0,1]
    v_pk_fma_f32 v[58:59], v[58:59], v[132:133], v[234:235] op_sel_hi:[1,0,1]
    v_pk_fma_f32 v[60:61], v[60:61], v[132:133], v[228:229] op_sel_hi:[1,0,1]
    v_pk_fma_f32 v[62:63], v[62:63], v[132:133], v[230:231] op_sel_hi:[1,0,1]
    v_max3_f32 v114, v56, v57, v58
    v_max3_f32 v114, v114, v59, v60
    v_max3_f32 v114, v114, v61, v62
    v_max_f32 v114, v114, v63
    v_mov_b32 v124, v108
    v_mov_b32 v125, v110
    v_mov_b32 v126, v112
    v_mov_b32 v127, v114
    v_permlane32_swap_b32 v108, v124
    v_permlane32_swap_b32 v110, v125
    v_permlane32_swap_b32 v112, v126
    v_permlane32_swap_b32 v114, v127
    v_max_f32 v108, v108, v124
    v_max_f32 v110, v110, v125
    v_max_f32 v112, v112, v126
    v_max_f32 v114, v114, v127
    v_mov_b32 v124, v108
    v_mov_b32 v125, v110
    v_mov_b32 v126, v112
    v_mov_b32 v127, v114
    v_permlane16_swap_b32 v108, v124
    v_permlane16_swap_b32 v110, v125
    v_permlane16_swap_b32 v112, v126
    v_permlane16_swap_b32 v114, v127
    v_max_f32 v108, v108, v124
    v_max_f32 v110, v110, v125
    v_max_f32 v112, v112, v126
    v_max_f32 v114, v114, v127
    v_pk_add_f32 v[32:33], v[32:33], v[108:109] op_sel_hi:[1,0] neg_lo:[0,1] neg_hi:[0,1]
    v_pk_add_f32 v[34:35], v[34:35], v[108:109] op_sel_hi:[1,0] neg_lo:[0,1] neg_hi:[0,1]
    v_pk_add_f32 v[36:37], v[36:37], v[108:109] op_sel_hi:[1,0] neg_lo:[0,1] neg_hi:[0,1]
    v_pk_add_f32 v[38:39], v[38:39], v[108:109] op_sel_hi:[1,0] neg_lo:[0,1] neg_hi:[0,1]
    v_exp_f32 v32, v32
    v_exp_f32 v33, v33
    v_exp_f32 v34, v34
    v_exp_f32 v35, v35
    v_exp_f32 v36, v36
    v_exp_f32 v37, v37
    v_exp_f32 v38, v38
    v_exp_f32 v39, v39
    v_pk_add_f32 v[40:41], v[40:41], v[110:111] op_sel_hi:[1,0] neg_lo:[0,1] neg_hi:[0,1]
    v_pk_add_f32 v[42:43], v[42:43], v[110:111] op_sel_hi:[1,0] neg_lo:[0,1] neg_hi:[0,1]
    v_pk_add_f32 v[44:45], v[44:45], v[110:111] op_sel_hi:[1,0] neg_lo:[0,1] neg_hi:[0,1]
    v_pk_add_f32 v[46:47], v[46:47], v[110:111] op_sel_hi:[1,0] neg_lo:[0,1] neg_hi:[0,1]
    v_exp_f32 v40, v40
    v_exp_f32 v41, v41
    v_exp_f32 v42, v42
    v_exp_f32 v43, v43
    v_exp_f32 v44, v44
    v_exp_f32 v45, v45
    v_exp_f32 v46, v46
    v_exp_f32 v47, v47
    v_pk_add_f32 v[48:49], v[48:49], v[112:113] op_sel_hi:[1,0] neg_lo:[0,1] neg_hi:[0,1]
    v_pk_add_f32 v[50:51], v[50:51], v[112:113] op_sel_hi:[1,0] neg_lo:[0,1] neg_hi:[0,1]
    v_pk_add_f32 v[52:53], v[52:53], v[112:113] op_sel_hi:[1,0] neg_lo:[0,1] neg_hi:[0,1]
    v_pk_add_f32 v[54:55], v[54:55], v[112:113] op_sel_hi:[1,0] neg_lo:[0,1] neg_hi:[0,1]
    v_exp_f32 v48, v48
    v_exp_f32 v49, v49
    v_exp_f32 v50, v50
    v_exp_f32 v51, v51
    v_exp_f32 v52, v52
    v_exp_f32 v53, v53
    v_exp_f32 v54, v54
    v_exp_f32 v55, v55
    v_pk_add_f32 v[56:57], v[56:57], v[114:115] op_sel_hi:[1,0] neg_lo:[0,1] neg_hi:[0,1]
    v_pk_add_f32 v[58:59], v[58:59], v[114:115] op_sel_hi:[1,0] neg_lo:[0,1] neg_hi:[0,1]
    v_pk_add_f32 v[60:61], v[60:61], v[114:115] op_sel_hi:[1,0] neg_lo:[0,1] neg_hi:[0,1]
    v_pk_add_f32 v[62:63], v[62:63], v[114:115] op_sel_hi:[1,0] neg_lo:[0,1] neg_hi:[0,1]
    v_exp_f32 v56, v56
    v_exp_f32 v57, v57
    v_exp_f32 v58, v58
    v_exp_f32 v59, v59
    v_exp_f32 v60, v60
    v_exp_f32 v61, v61
    v_exp_f32 v62, v62
    v_exp_f32 v63, v63
    v_cvt_pk_bf16_f32 v80, v32, v33
    v_cvt_pk_bf16_f32 v81, v34, v35
    v_cvt_pk_bf16_f32 v82, v36, v37
    v_cvt_pk_bf16_f32 v83, v38, v39
    v_cvt_pk_bf16_f32 v84, v40, v41
    v_cvt_pk_bf16_f32 v85, v42, v43
    v_cvt_pk_bf16_f32 v86, v44, v45
    v_cvt_pk_bf16_f32 v87, v46, v47
    v_cvt_pk_bf16_f32 v88, v48, v49
    v_cvt_pk_bf16_f32 v89, v50, v51
    v_cvt_pk_bf16_f32 v90, v52, v53
    v_cvt_pk_bf16_f32 v91, v54, v55
    v_cvt_pk_bf16_f32 v92, v56, v57
    v_cvt_pk_bf16_f32 v93, v58, v59
    v_cvt_pk_bf16_f32 v94, v60, v61
    v_cvt_pk_bf16_f32 v95, v62, v63
    v_mfma_f32_16x16x16_bf16 v[64:67], v[212:213], v[80:81], 0
    v_mfma_f32_16x16x16_bf16 v[68:71], v[218:219], v[84:85], 0
    v_mfma_f32_16x16x16_bf16 v[72:75], v[214:215], v[88:89], 0
    v_mfma_f32_16x16x16_bf16 v[76:79], v[220:221], v[92:93], 0
    v_mfma_f32_16x16x16_bf16 v[64:67], v[214:215], v[82:83], v[64:67]
    v_mfma_f32_16x16x16_bf16 v[68:71], v[220:221], v[86:87], v[68:71]
    v_mfma_f32_16x16x16_bf16 v[72:75], v[216:217], v[90:91], v[72:75]
    v_mfma_f32_16x16x16_bf16 v[76:79], v[222:223], v[94:95], v[76:79]
    v_lshlrev_b32 v32, 16, v80
    v_and_b32 v33, 0xffff0000, v80
    v_lshlrev_b32 v34, 16, v81
    v_and_b32 v35, 0xffff0000, v81
    v_lshlrev_b32 v36, 16, v82
    v_and_b32 v37, 0xffff0000, v82
    v_lshlrev_b32 v38, 16, v83
    v_and_b32 v39, 0xffff0000, v83
    v_pk_add_f32 v[32:33], v[32:33], v[34:35]
    v_pk_add_f32 v[36:37], v[36:37], v[38:39]
    v_pk_add_f32 v[32:33], v[32:33], v[36:37]
    v_add_f32 v116, v32, v33
    v_lshlrev_b32 v40, 16, v84
    v_and_b32 v41, 0xffff0000, v84
    v_lshlrev_b32 v42, 16, v85
    v_and_b32 v43, 0xffff0000, v85
    v_lshlrev_b32 v44, 16, v86
    v_and_b32 v45, 0xffff0000, v86
    v_lshlrev_b32 v46, 16, v87
    v_and_b32 v47, 0xffff0000, v87
    v_pk_add_f32 v[40:41], v[40:41], v[42:43]
    v_pk_add_f32 v[44:45], v[44:45], v[46:47]
    v_pk_add_f32 v[40:41], v[40:41], v[44:45]
    v_add_f32 v118, v40, v41
    v_lshlrev_b32 v48, 16, v88
    v_and_b32 v49, 0xffff0000, v88
    v_lshlrev_b32 v50, 16, v89
    v_and_b32 v51, 0xffff0000, v89
    v_lshlrev_b32 v52, 16, v90
    v_and_b32 v53, 0xffff0000, v90
    v_lshlrev_b32 v54, 16, v91
    v_and_b32 v55, 0xffff0000, v91
    v_pk_add_f32 v[48:49], v[48:49], v[50:51]
    v_pk_add_f32 v[52:53], v[52:53], v[54:55]
    v_pk_add_f32 v[48:49], v[48:49], v[52:53]
    v_add_f32 v120, v48, v49
    v_lshlrev_b32 v56, 16, v92
    v_and_b32 v57, 0xffff0000, v92
    v_lshlrev_b32 v58, 16, v93
    v_and_b32 v59, 0xffff0000, v93
    v_lshlrev_b32 v60, 16, v94
    v_and_b32 v61, 0xffff0000, v94
    v_lshlrev_b32 v62, 16, v95
    v_and_b32 v63, 0xffff0000, v95
    v_pk_add_f32 v[56:57], v[56:57], v[58:59]
    v_pk_add_f32 v[60:61], v[60:61], v[62:63]
    v_pk_add_f32 v[56:57], v[56:57], v[60:61]
    v_add_f32 v122, v56, v57
    v_mov_b32 v124, v116
    v_mov_b32 v125, v118
    v_mov_b32 v126, v120
    v_mov_b32 v127, v122
    v_permlane32_swap_b32 v116, v124
    v_permlane32_swap_b32 v118, v125
    v_permlane32_swap_b32 v120, v126
    v_permlane32_swap_b32 v122, v127
    v_add_f32 v116, v116, v124
    v_add_f32 v118, v118, v125
    v_add_f32 v120, v120, v126
    v_add_f32 v122, v122, v127
    v_mov_b32 v124, v116
    v_mov_b32 v125, v118
    v_mov_b32 v126, v120
    v_mov_b32 v127, v122
    v_permlane16_swap_b32 v116, v124
    v_permlane16_swap_b32 v118, v125
    v_permlane16_swap_b32 v120, v126
    v_permlane16_swap_b32 v122, v127
    v_add_f32 v116, v116, v124
    v_add_f32 v118, v118, v125
    v_add_f32 v120, v120, v126
    v_add_f32 v122, v122, v127
    v_rcp_f32 v116, v116
    v_rcp_f32 v118, v118
    v_rcp_f32 v120, v120
    v_rcp_f32 v122, v122
    v_pk_mul_f32 v[64:65], v[64:65], v[116:117] op_sel_hi:[1,0]
    v_pk_mul_f32 v[66:67], v[66:67], v[116:117] op_sel_hi:[1,0]
    v_pk_mul_f32 v[68:69], v[68:69], v[118:119] op_sel_hi:[1,0]
    v_pk_mul_f32 v[70:71], v[70:71], v[118:119] op_sel_hi:[1,0]
    v_pk_mul_f32 v[72:73], v[72:73], v[120:121] op_sel_hi:[1,0]
    v_pk_mul_f32 v[74:75], v[74:75], v[120:121] op_sel_hi:[1,0]
    v_pk_mul_f32 v[76:77], v[76:77], v[122:123] op_sel_hi:[1,0]
    v_pk_mul_f32 v[78:79], v[78:79], v[122:123] op_sel_hi:[1,0]
    s_lshl_b32 s38, s29, 17
    s_lshl_b32 s39, s43, 10
    s_add_u32 s38, s38, s39
    s_add_u32 s38, s38, 0
    s_add_u32 s39, s38, 16384
    v_cvt_pk_bf16_f32 v96, v64, v65
    v_cvt_pk_bf16_f32 v97, v66, v67
    v_cvt_pk_bf16_f32 v98, v68, v69
    v_cvt_pk_bf16_f32 v99, v70, v71
    v_cvt_pk_bf16_f32 v100, v72, v73
    v_cvt_pk_bf16_f32 v101, v74, v75
    v_cvt_pk_bf16_f32 v102, v76, v77
    v_cvt_pk_bf16_f32 v103, v78, v79
    buffer_store_dwordx4 v[96:99], v1, s[4:7], s38 offen sc1
    buffer_store_dwordx4 v[100:103], v1, s[4:7], s39 offen sc1
    s_nop 1
    s_branch L_sequential_preLN__sliding_local_dilated__geglu_ffn__prompt_kernel_p1join
L_sequential_preLN__sliding_local_dilated__geglu_ffn__prompt_kernel_w1:
L_sequential_preLN__sliding_local_dilated__geglu_ffn__prompt_kernel_cl1_0:
    ds_read_b32 v17, v18 offset:0
    s_waitcnt lgkmcnt(0)
    v_readfirstlane_b32 s40, v17
    s_nop 1
    s_cmp_lt_u32 s40, 4
    s_cbranch_scc1 L_sequential_preLN__sliding_local_dilated__geglu_ffn__prompt_kernel_cl1_0
L_sequential_preLN__sliding_local_dilated__geglu_ffn__prompt_kernel_cl1_0x:
    ds_read_b128 v[156:159], v20 offset:0
    ds_read_b128 v[160:163], v20 offset:2048
    ds_read_b64_tr_b16 v[108:109], v26 offset:0
    ds_read_b64_tr_b16 v[110:111], v26 offset:768
    ds_read_b64_tr_b16 v[112:113], v27 offset:0
    ds_read_b64_tr_b16 v[114:115], v27 offset:768
    ds_read_b64_tr_b16 v[116:117], v28 offset:0
    ds_read_b64_tr_b16 v[118:119], v28 offset:768
    ds_read_b64_tr_b16 v[120:121], v29 offset:0
    ds_read_b64_tr_b16 v[122:123], v29 offset:768
    ds_read_b64_tr_b16 v[124:125], v30 offset:0
    ds_read_b64_tr_b16 v[126:127], v30 offset:768
    ds_read_b64_tr_b16 v[128:129], v31 offset:0
    ds_read_b64_tr_b16 v[130:131], v31 offset:768
    ds_read_b128 v[164:167], v22 offset:0
    s_waitcnt lgkmcnt(0)
    v_mfma_f32_16x16x32_bf16 v[32:35], v[108:111], v[156:159], v[32:35]
    v_mfma_f32_16x16x32_bf16 v[40:43], v[112:115], v[156:159], v[40:43]
    v_mfma_f32_16x16x32_bf16 v[48:51], v[116:119], v[156:159], v[48:51]
    ds_read_b128 v[168:171], v21 offset:0
    ds_read_b128 v[172:175], v21 offset:2048
    v_mfma_f32_16x16x32_bf16 v[56:59], v[120:123], v[156:159], v[56:59]
    ds_read_b64_tr_b16 v[132:133], v26 offset:6144
    v_mfma_f32_16x16x32_bf16 v[64:67], v[156:159], v[124:127], v[64:67]
    ds_read_b64_tr_b16 v[134:135], v26 offset:6912
    ds_read_b64_tr_b16 v[136:137], v27 offset:6144
    v_mfma_f32_16x16x32_bf16 v[72:75], v[156:159], v[128:131], v[72:75]
    ds_read_b64_tr_b16 v[138:139], v27 offset:6912
    v_mfma_f32_16x16x32_bf16 v[80:83], v[104:107], v[156:159], v[80:83]
    ds_read_b64_tr_b16 v[140:141], v28 offset:6144
    ds_read_b64_tr_b16 v[142:143], v28 offset:6912
    v_mfma_f32_16x16x32_bf16 v[88:91], v[156:159], v[156:159], v[88:91]
    ds_read_b64_tr_b16 v[144:145], v29 offset:6144
    v_mfma_f32_16x16x32_bf16 v[36:39], v[108:111], v[160:163], v[36:39]
    ds_read_b64_tr_b16 v[146:147], v29 offset:6912
    ds_read_b64_tr_b16 v[148:149], v30 offset:6144
    v_mfma_f32_16x16x32_bf16 v[44:47], v[112:115], v[160:163], v[44:47]
    ds_read_b64_tr_b16 v[150:151], v30 offset:6912
    v_mfma_f32_16x16x32_bf16 v[52:55], v[116:119], v[160:163], v[52:55]
    ds_read_b64_tr_b16 v[152:153], v31 offset:6144
    ds_read_b64_tr_b16 v[154:155], v31 offset:6912
    v_mfma_f32_16x16x32_bf16 v[60:63], v[120:123], v[160:163], v[60:63]
    ds_read_b128 v[176:179], v23 offset:0
    v_mfma_f32_16x16x32_bf16 v[68:71], v[160:163], v[124:127], v[68:71]
    ds_read_b32 v17, v18 offset:4
    v_cndmask_b32 v164, v164, v104, s[56:57]
    v_mfma_f32_16x16x32_bf16 v[76:79], v[160:163], v[128:131], v[76:79]
    v_cndmask_b32 v165, v165, v104, s[56:57]
    v_mfma_f32_16x16x32_bf16 v[84:87], v[104:107], v[160:163], v[84:87]
    v_cndmask_b32 v166, v166, v104, s[56:57]
    v_mfma_f32_16x16x32_bf16 v[92:95], v[160:163], v[160:163], v[92:95]
    v_cndmask_b32 v167, v167, v104, s[56:57]
    s_nop 1
    v_mfma_f32_16x16x32_bf16 v[96:99], v[120:123], v[164:167], v[96:99]
    v_mfma_f32_16x16x32_bf16 v[100:103], v[112:115], v[164:167], v[100:103]
    s_waitcnt lgkmcnt(0)
    v_mfma_f32_16x16x32_bf16 v[32:35], v[132:135], v[168:171], v[32:35]
    v_mfma_f32_16x16x32_bf16 v[40:43], v[136:139], v[168:171], v[40:43]
    s_mov_b64 exec, 1
    ds_add_u32 v18, v19 offset:32
    s_mov_b64 exec, -1
    v_readfirstlane_b32 s40, v17
    s_nop 1
    s_cmp_ge_u32 s40, 4
    s_cbranch_scc1 L_sequential_preLN__sliding_local_dilated__geglu_ffn__prompt_kernel_cl1_1x
L_sequential_preLN__sliding_local_dilated__geglu_ffn__prompt_kernel_cl1_1:
    ds_read_b32 v17, v18 offset:4
    s_waitcnt lgkmcnt(0)
    v_readfirstlane_b32 s40, v17
    s_nop 1
    s_cmp_lt_u32 s40, 4
    s_cbranch_scc1 L_sequential_preLN__sliding_local_dilated__geglu_ffn__prompt_kernel_cl1_1
L_sequential_preLN__sliding_local_dilated__geglu_ffn__prompt_kernel_cl1_1x:
    v_mfma_f32_16x16x32_bf16 v[48:51], v[140:143], v[168:171], v[48:51]
    ds_read_b128 v[156:159], v20 offset:28672
    ds_read_b128 v[160:163], v20 offset:30720
    v_mfma_f32_16x16x32_bf16 v[56:59], v[144:147], v[168:171], v[56:59]
    ds_read_b64_tr_b16 v[108:109], v26 offset:28672
    v_mfma_f32_16x16x32_bf16 v[64:67], v[168:171], v[148:151], v[64:67]
    ds_read_b64_tr_b16 v[110:111], v26 offset:29440
    ds_read_b64_tr_b16 v[112:113], v27 offset:28672
    v_mfma_f32_16x16x32_bf16 v[72:75], v[168:171], v[152:155], v[72:75]
    ds_read_b64_tr_b16 v[114:115], v27 offset:29440
    v_mfma_f32_16x16x32_bf16 v[80:83], v[104:107], v[168:171], v[80:83]
    ds_read_b64_tr_b16 v[116:117], v28 offset:28672
    ds_read_b64_tr_b16 v[118:119], v28 offset:29440
    v_mfma_f32_16x16x32_bf16 v[88:91], v[168:171], v[168:171], v[88:91]
    ds_read_b64_tr_b16 v[120:121], v29 offset:28672
    v_mfma_f32_16x16x32_bf16 v[36:39], v[132:135], v[172:175], v[36:39]
    ds_read_b64_tr_b16 v[122:123], v29 offset:29440
    ds_read_b64_tr_b16 v[124:125], v30 offset:28672
    v_mfma_f32_16x16x32_bf16 v[44:47], v[136:139], v[172:175], v[44:47]
    ds_read_b64_tr_b16 v[126:127], v30 offset:29440
    v_mfma_f32_16x16x32_bf16 v[52:55], v[140:143], v[172:175], v[52:55]
    ds_read_b64_tr_b16 v[128:129], v31 offset:28672
    ds_read_b64_tr_b16 v[130:131], v31 offset:29440
    v_mfma_f32_16x16x32_bf16 v[60:63], v[144:147], v[172:175], v[60:63]
    ds_read_b128 v[164:167], v24 offset:0
    v_mfma_f32_16x16x32_bf16 v[68:71], v[172:175], v[148:151], v[68:71]
    v_cndmask_b32 v176, v176, v104, s[56:57]
    v_mfma_f32_16x16x32_bf16 v[76:79], v[172:175], v[152:155], v[76:79]
    v_cndmask_b32 v177, v177, v104, s[56:57]
    v_mfma_f32_16x16x32_bf16 v[84:87], v[104:107], v[172:175], v[84:87]
    v_cndmask_b32 v178, v178, v104, s[56:57]
    v_mfma_f32_16x16x32_bf16 v[92:95], v[172:175], v[172:175], v[92:95]
    v_cndmask_b32 v179, v179, v104, s[56:57]
    s_nop 1
    v_mfma_f32_16x16x32_bf16 v[96:99], v[144:147], v[176:179], v[96:99]
    v_mfma_f32_16x16x32_bf16 v[100:103], v[136:139], v[176:179], v[100:103]
    s_waitcnt lgkmcnt(0)
    v_mfma_f32_16x16x32_bf16 v[32:35], v[108:111], v[156:159], v[32:35]
    v_mfma_f32_16x16x32_bf16 v[40:43], v[112:115], v[156:159], v[40:43]
    v_mfma_f32_16x16x32_bf16 v[48:51], v[116:119], v[156:159], v[48:51]
    ds_read_b128 v[168:171], v21 offset:28672
    ds_read_b128 v[172:175], v21 offset:30720
    v_mfma_f32_16x16x32_bf16 v[56:59], v[120:123], v[156:159], v[56:59]
    ds_read_b64_tr_b16 v[132:133], v26 offset:34816
    v_mfma_f32_16x16x32_bf16 v[64:67], v[156:159], v[124:127], v[64:67]
    ds_read_b64_tr_b16 v[134:135], v26 offset:35584
    ds_read_b64_tr_b16 v[136:137], v27 offset:34816
    v_mfma_f32_16x16x32_bf16 v[72:75], v[156:159], v[128:131], v[72:75]
    ds_read_b64_tr_b16 v[138:139], v27 offset:35584
    v_mfma_f32_16x16x32_bf16 v[80:83], v[104:107], v[156:159], v[80:83]
    ds_read_b64_tr_b16 v[140:141], v28 offset:34816
    ds_read_b64_tr_b16 v[142:143], v28 offset:35584
    v_mfma_f32_16x16x32_bf16 v[88:91], v[156:159], v[156:159], v[88:91]
    ds_read_b64_tr_b16 v[144:145], v29 offset:34816
    v_mfma_f32_16x16x32_bf16 v[36:39], v[108:111], v[160:163], v[36:39]
    ds_read_b64_tr_b16 v[146:147], v29 offset:35584
    ds_read_b64_tr_b16 v[148:149], v30 offset:34816
    v_mfma_f32_16x16x32_bf16 v[44:47], v[112:115], v[160:163], v[44:47]
    ds_read_b64_tr_b16 v[150:151], v30 offset:35584
    v_mfma_f32_16x16x32_bf16 v[52:55], v[116:119], v[160:163], v[52:55]
    ds_read_b64_tr_b16 v[152:153], v31 offset:34816
    ds_read_b64_tr_b16 v[154:155], v31 offset:35584
    v_mfma_f32_16x16x32_bf16 v[60:63], v[120:123], v[160:163], v[60:63]
    ds_read_b128 v[176:179], v25 offset:0
    v_mfma_f32_16x16x32_bf16 v[68:71], v[160:163], v[124:127], v[68:71]
    ds_read_b32 v17, v18 offset:8
    v_cndmask_b32 v164, v164, v104, s[56:57]
    v_mfma_f32_16x16x32_bf16 v[76:79], v[160:163], v[128:131], v[76:79]
    v_cndmask_b32 v165, v165, v104, s[56:57]
    v_mfma_f32_16x16x32_bf16 v[84:87], v[104:107], v[160:163], v[84:87]
    v_cndmask_b32 v166, v166, v104, s[56:57]
    v_mfma_f32_16x16x32_bf16 v[92:95], v[160:163], v[160:163], v[92:95]
    v_cndmask_b32 v167, v167, v104, s[56:57]
    s_nop 1
    v_mfma_f32_16x16x32_bf16 v[96:99], v[120:123], v[164:167], v[96:99]
    v_mfma_f32_16x16x32_bf16 v[100:103], v[112:115], v[164:167], v[100:103]
    s_waitcnt lgkmcnt(0)
    v_mfma_f32_16x16x32_bf16 v[32:35], v[132:135], v[168:171], v[32:35]
    v_mfma_f32_16x16x32_bf16 v[40:43], v[136:139], v[168:171], v[40:43]
    s_mov_b64 exec, 1
    ds_add_u32 v18, v19 offset:36
    s_mov_b64 exec, -1
    v_readfirstlane_b32 s40, v17
    s_nop 1
    s_cmp_ge_u32 s40, 4
    s_cbranch_scc1 L_sequential_preLN__sliding_local_dilated__geglu_ffn__prompt_kernel_cl1_2x
L_sequential_preLN__sliding_local_dilated__geglu_ffn__prompt_kernel_cl1_2:
    ds_read_b32 v17, v18 offset:8
    s_waitcnt lgkmcnt(0)
    v_readfirstlane_b32 s40, v17
    s_nop 1
    s_cmp_lt_u32 s40, 4
    s_cbranch_scc1 L_sequential_preLN__sliding_local_dilated__geglu_ffn__prompt_kernel_cl1_2
L_sequential_preLN__sliding_local_dilated__geglu_ffn__prompt_kernel_cl1_2x:
    v_mfma_f32_16x16x32_bf16 v[48:51], v[140:143], v[168:171], v[48:51]
    ds_read_b128 v[156:159], v252 offset:0
    ds_read_b128 v[160:163], v252 offset:2048
    v_mfma_f32_16x16x32_bf16 v[56:59], v[144:147], v[168:171], v[56:59]
    ds_read_b64_tr_b16 v[108:109], v240 offset:0
    v_mfma_f32_16x16x32_bf16 v[64:67], v[168:171], v[148:151], v[64:67]
    ds_read_b64_tr_b16 v[110:111], v240 offset:768
    ds_read_b64_tr_b16 v[112:113], v241 offset:0
    v_mfma_f32_16x16x32_bf16 v[72:75], v[168:171], v[152:155], v[72:75]
    ds_read_b64_tr_b16 v[114:115], v241 offset:768
    v_mfma_f32_16x16x32_bf16 v[80:83], v[104:107], v[168:171], v[80:83]
    ds_read_b64_tr_b16 v[116:117], v242 offset:0
    ds_read_b64_tr_b16 v[118:119], v242 offset:768
    v_mfma_f32_16x16x32_bf16 v[88:91], v[168:171], v[168:171], v[88:91]
    ds_read_b64_tr_b16 v[120:121], v243 offset:0
    v_mfma_f32_16x16x32_bf16 v[36:39], v[132:135], v[172:175], v[36:39]
    ds_read_b64_tr_b16 v[122:123], v243 offset:768
    ds_read_b64_tr_b16 v[124:125], v244 offset:0
    v_mfma_f32_16x16x32_bf16 v[44:47], v[136:139], v[172:175], v[44:47]
    ds_read_b64_tr_b16 v[126:127], v244 offset:768
    v_mfma_f32_16x16x32_bf16 v[52:55], v[140:143], v[172:175], v[52:55]
    ds_read_b64_tr_b16 v[128:129], v245 offset:0
    ds_read_b64_tr_b16 v[130:131], v245 offset:768
    v_mfma_f32_16x16x32_bf16 v[60:63], v[144:147], v[172:175], v[60:63]
    ds_read_b128 v[164:167], v22 offset:256
    v_mfma_f32_16x16x32_bf16 v[68:71], v[172:175], v[148:151], v[68:71]
    v_cndmask_b32 v176, v176, v104, s[56:57]
    v_mfma_f32_16x16x32_bf16 v[76:79], v[172:175], v[152:155], v[76:79]
    v_cndmask_b32 v177, v177, v104, s[56:57]
    v_mfma_f32_16x16x32_bf16 v[84:87], v[104:107], v[172:175], v[84:87]
    v_cndmask_b32 v178, v178, v104, s[56:57]
    v_mfma_f32_16x16x32_bf16 v[92:95], v[172:175], v[172:175], v[92:95]
    v_cndmask_b32 v179, v179, v104, s[56:57]
    s_nop 1
    v_mfma_f32_16x16x32_bf16 v[96:99], v[144:147], v[176:179], v[96:99]
    v_mfma_f32_16x16x32_bf16 v[100:103], v[136:139], v[176:179], v[100:103]
    s_waitcnt lgkmcnt(0)
    v_mfma_f32_16x16x32_bf16 v[32:35], v[108:111], v[156:159], v[32:35]
    v_mfma_f32_16x16x32_bf16 v[40:43], v[112:115], v[156:159], v[40:43]
    v_mfma_f32_16x16x32_bf16 v[48:51], v[116:119], v[156:159], v[48:51]
    ds_read_b128 v[168:171], v253 offset:0
    ds_read_b128 v[172:175], v253 offset:2048
    v_mfma_f32_16x16x32_bf16 v[56:59], v[120:123], v[156:159], v[56:59]
    ds_read_b64_tr_b16 v[132:133], v240 offset:6144
    v_mfma_f32_16x16x32_bf16 v[64:67], v[156:159], v[124:127], v[64:67]
    ds_read_b64_tr_b16 v[134:135], v240 offset:6912
    ds_read_b64_tr_b16 v[136:137], v241 offset:6144
    v_mfma_f32_16x16x32_bf16 v[72:75], v[156:159], v[128:131], v[72:75]
    ds_read_b64_tr_b16 v[138:139], v241 offset:6912
    v_mfma_f32_16x16x32_bf16 v[80:83], v[104:107], v[156:159], v[80:83]
    ds_read_b64_tr_b16 v[140:141], v242 offset:6144
    ds_read_b64_tr_b16 v[142:143], v242 offset:6912
    v_mfma_f32_16x16x32_bf16 v[88:91], v[156:159], v[156:159], v[88:91]
    ds_read_b64_tr_b16 v[144:145], v243 offset:6144
    v_mfma_f32_16x16x32_bf16 v[36:39], v[108:111], v[160:163], v[36:39]
    ds_read_b64_tr_b16 v[146:147], v243 offset:6912
    ds_read_b64_tr_b16 v[148:149], v244 offset:6144
    v_mfma_f32_16x16x32_bf16 v[44:47], v[112:115], v[160:163], v[44:47]
    ds_read_b64_tr_b16 v[150:151], v244 offset:6912
    v_mfma_f32_16x16x32_bf16 v[52:55], v[116:119], v[160:163], v[52:55]
    ds_read_b64_tr_b16 v[152:153], v245 offset:6144
    ds_read_b64_tr_b16 v[154:155], v245 offset:6912
    v_mfma_f32_16x16x32_bf16 v[60:63], v[120:123], v[160:163], v[60:63]
    ds_read_b128 v[176:179], v23 offset:256
    v_mfma_f32_16x16x32_bf16 v[68:71], v[160:163], v[124:127], v[68:71]
    ds_read_b32 v17, v18 offset:12
    v_cndmask_b32 v164, v164, v104, s[56:57]
    v_mfma_f32_16x16x32_bf16 v[76:79], v[160:163], v[128:131], v[76:79]
    v_cndmask_b32 v165, v165, v104, s[56:57]
    v_mfma_f32_16x16x32_bf16 v[84:87], v[104:107], v[160:163], v[84:87]
    v_cndmask_b32 v166, v166, v104, s[56:57]
    v_mfma_f32_16x16x32_bf16 v[92:95], v[160:163], v[160:163], v[92:95]
    v_cndmask_b32 v167, v167, v104, s[56:57]
    s_nop 1
    v_mfma_f32_16x16x32_bf16 v[96:99], v[120:123], v[164:167], v[96:99]
    v_mfma_f32_16x16x32_bf16 v[100:103], v[112:115], v[164:167], v[100:103]
    s_waitcnt lgkmcnt(0)
    v_mfma_f32_16x16x32_bf16 v[32:35], v[132:135], v[168:171], v[32:35]
    v_mfma_f32_16x16x32_bf16 v[40:43], v[136:139], v[168:171], v[40:43]
    s_mov_b64 exec, 1
    ds_add_u32 v18, v19 offset:40
    s_mov_b64 exec, -1
    v_readfirstlane_b32 s40, v17
    s_nop 1
    s_cmp_ge_u32 s40, 4
    s_cbranch_scc1 L_sequential_preLN__sliding_local_dilated__geglu_ffn__prompt_kernel_cl1_3x
L_sequential_preLN__sliding_local_dilated__geglu_ffn__prompt_kernel_cl1_3:
    ds_read_b32 v17, v18 offset:12
    s_waitcnt lgkmcnt(0)
    v_readfirstlane_b32 s40, v17
    s_nop 1
    s_cmp_lt_u32 s40, 4
    s_cbranch_scc1 L_sequential_preLN__sliding_local_dilated__geglu_ffn__prompt_kernel_cl1_3
L_sequential_preLN__sliding_local_dilated__geglu_ffn__prompt_kernel_cl1_3x:
    v_mfma_f32_16x16x32_bf16 v[48:51], v[140:143], v[168:171], v[48:51]
    ds_read_b128 v[156:159], v252 offset:28672
    ds_read_b128 v[160:163], v252 offset:30720
    v_mfma_f32_16x16x32_bf16 v[56:59], v[144:147], v[168:171], v[56:59]
    ds_read_b64_tr_b16 v[108:109], v240 offset:28672
    v_mfma_f32_16x16x32_bf16 v[64:67], v[168:171], v[148:151], v[64:67]
    ds_read_b64_tr_b16 v[110:111], v240 offset:29440
    ds_read_b64_tr_b16 v[112:113], v241 offset:28672
    v_mfma_f32_16x16x32_bf16 v[72:75], v[168:171], v[152:155], v[72:75]
    ds_read_b64_tr_b16 v[114:115], v241 offset:29440
    v_mfma_f32_16x16x32_bf16 v[80:83], v[104:107], v[168:171], v[80:83]
    ds_read_b64_tr_b16 v[116:117], v242 offset:28672
    ds_read_b64_tr_b16 v[118:119], v242 offset:29440
    v_mfma_f32_16x16x32_bf16 v[88:91], v[168:171], v[168:171], v[88:91]
    ds_read_b64_tr_b16 v[120:121], v243 offset:28672
    v_mfma_f32_16x16x32_bf16 v[36:39], v[132:135], v[172:175], v[36:39]
    ds_read_b64_tr_b16 v[122:123], v243 offset:29440
    ds_read_b64_tr_b16 v[124:125], v244 offset:28672
    v_mfma_f32_16x16x32_bf16 v[44:47], v[136:139], v[172:175], v[44:47]
    ds_read_b64_tr_b16 v[126:127], v244 offset:29440
    v_mfma_f32_16x16x32_bf16 v[52:55], v[140:143], v[172:175], v[52:55]
    ds_read_b64_tr_b16 v[128:129], v245 offset:28672
    ds_read_b64_tr_b16 v[130:131], v245 offset:29440
    v_mfma_f32_16x16x32_bf16 v[60:63], v[144:147], v[172:175], v[60:63]
    ds_read_b128 v[164:167], v24 offset:256
    v_mfma_f32_16x16x32_bf16 v[68:71], v[172:175], v[148:151], v[68:71]
    v_cndmask_b32 v176, v176, v104, s[56:57]
    v_mfma_f32_16x16x32_bf16 v[76:79], v[172:175], v[152:155], v[76:79]
    v_cndmask_b32 v177, v177, v104, s[56:57]
    v_mfma_f32_16x16x32_bf16 v[84:87], v[104:107], v[172:175], v[84:87]
    v_cndmask_b32 v178, v178, v104, s[56:57]
    v_mfma_f32_16x16x32_bf16 v[92:95], v[172:175], v[172:175], v[92:95]
    v_cndmask_b32 v179, v179, v104, s[56:57]
    s_nop 1
    v_mfma_f32_16x16x32_bf16 v[96:99], v[144:147], v[176:179], v[96:99]
    v_mfma_f32_16x16x32_bf16 v[100:103], v[136:139], v[176:179], v[100:103]
    s_waitcnt lgkmcnt(0)
    v_mfma_f32_16x16x32_bf16 v[32:35], v[108:111], v[156:159], v[32:35]
    v_mfma_f32_16x16x32_bf16 v[40:43], v[112:115], v[156:159], v[40:43]
    v_mfma_f32_16x16x32_bf16 v[48:51], v[116:119], v[156:159], v[48:51]
    ds_read_b128 v[168:171], v253 offset:28672
    ds_read_b128 v[172:175], v253 offset:30720
    v_mfma_f32_16x16x32_bf16 v[56:59], v[120:123], v[156:159], v[56:59]
    ds_read_b64_tr_b16 v[132:133], v240 offset:34816
    v_mfma_f32_16x16x32_bf16 v[64:67], v[156:159], v[124:127], v[64:67]
    ds_read_b64_tr_b16 v[134:135], v240 offset:35584
    ds_read_b64_tr_b16 v[136:137], v241 offset:34816
    v_mfma_f32_16x16x32_bf16 v[72:75], v[156:159], v[128:131], v[72:75]
    ds_read_b64_tr_b16 v[138:139], v241 offset:35584
    v_mfma_f32_16x16x32_bf16 v[80:83], v[104:107], v[156:159], v[80:83]
    ds_read_b64_tr_b16 v[140:141], v242 offset:34816
    ds_read_b64_tr_b16 v[142:143], v242 offset:35584
    v_mfma_f32_16x16x32_bf16 v[88:91], v[156:159], v[156:159], v[88:91]
    ds_read_b64_tr_b16 v[144:145], v243 offset:34816
    v_mfma_f32_16x16x32_bf16 v[36:39], v[108:111], v[160:163], v[36:39]
    ds_read_b64_tr_b16 v[146:147], v243 offset:35584
    ds_read_b64_tr_b16 v[148:149], v244 offset:34816
    v_mfma_f32_16x16x32_bf16 v[44:47], v[112:115], v[160:163], v[44:47]
    ds_read_b64_tr_b16 v[150:151], v244 offset:35584
    v_mfma_f32_16x16x32_bf16 v[52:55], v[116:119], v[160:163], v[52:55]
    ds_read_b64_tr_b16 v[152:153], v245 offset:34816
    ds_read_b64_tr_b16 v[154:155], v245 offset:35584
    v_mfma_f32_16x16x32_bf16 v[60:63], v[120:123], v[160:163], v[60:63]
    ds_read_b128 v[176:179], v25 offset:256
    v_mfma_f32_16x16x32_bf16 v[68:71], v[160:163], v[124:127], v[68:71]
    ds_read_b32 v17, v18 offset:16
    v_cndmask_b32 v164, v164, v104, s[56:57]
    v_mfma_f32_16x16x32_bf16 v[76:79], v[160:163], v[128:131], v[76:79]
    v_cndmask_b32 v165, v165, v104, s[56:57]
    v_mfma_f32_16x16x32_bf16 v[84:87], v[104:107], v[160:163], v[84:87]
    v_cndmask_b32 v166, v166, v104, s[56:57]
    v_mfma_f32_16x16x32_bf16 v[92:95], v[160:163], v[160:163], v[92:95]
    v_cndmask_b32 v167, v167, v104, s[56:57]
    s_nop 1
    v_mfma_f32_16x16x32_bf16 v[96:99], v[120:123], v[164:167], v[96:99]
    v_mfma_f32_16x16x32_bf16 v[100:103], v[112:115], v[164:167], v[100:103]
    s_waitcnt lgkmcnt(0)
    v_mfma_f32_16x16x32_bf16 v[32:35], v[132:135], v[168:171], v[32:35]
    v_mfma_f32_16x16x32_bf16 v[40:43], v[136:139], v[168:171], v[40:43]
    v_readfirstlane_b32 s40, v17
    s_nop 1
    s_cmp_ge_u32 s40, 4
    s_cbranch_scc1 L_sequential_preLN__sliding_local_dilated__geglu_ffn__prompt_kernel_cl1_4x
L_sequential_preLN__sliding_local_dilated__geglu_ffn__prompt_kernel_cl1_4:
    ds_read_b32 v17, v18 offset:16
    s_waitcnt lgkmcnt(0)
    v_readfirstlane_b32 s40, v17
    s_nop 1
    s_cmp_lt_u32 s40, 4
    s_cbranch_scc1 L_sequential_preLN__sliding_local_dilated__geglu_ffn__prompt_kernel_cl1_4
L_sequential_preLN__sliding_local_dilated__geglu_ffn__prompt_kernel_cl1_4x:
    v_mfma_f32_16x16x32_bf16 v[48:51], v[140:143], v[168:171], v[48:51]
    ds_read_b128 v[156:159], v254 offset:0
    ds_read_b128 v[160:163], v254 offset:2048
    v_mfma_f32_16x16x32_bf16 v[56:59], v[144:147], v[168:171], v[56:59]
    ds_read_b64_tr_b16 v[108:109], v246 offset:0
    v_mfma_f32_16x16x32_bf16 v[64:67], v[168:171], v[148:151], v[64:67]
    ds_read_b64_tr_b16 v[110:111], v246 offset:768
    ds_read_b64_tr_b16 v[112:113], v247 offset:0
    v_mfma_f32_16x16x32_bf16 v[72:75], v[168:171], v[152:155], v[72:75]
    ds_read_b64_tr_b16 v[114:115], v247 offset:768
    v_mfma_f32_16x16x32_bf16 v[80:83], v[104:107], v[168:171], v[80:83]
    ds_read_b64_tr_b16 v[116:117], v248 offset:0
    ds_read_b64_tr_b16 v[118:119], v248 offset:768
    v_mfma_f32_16x16x32_bf16 v[88:91], v[168:171], v[168:171], v[88:91]
    ds_read_b64_tr_b16 v[120:121], v249 offset:0
    v_mfma_f32_16x16x32_bf16 v[36:39], v[132:135], v[172:175], v[36:39]
    ds_read_b64_tr_b16 v[122:123], v249 offset:768
    ds_read_b64_tr_b16 v[124:125], v250 offset:0
    v_mfma_f32_16x16x32_bf16 v[44:47], v[136:139], v[172:175], v[44:47]
    ds_read_b64_tr_b16 v[126:127], v250 offset:768
    v_mfma_f32_16x16x32_bf16 v[52:55], v[140:143], v[172:175], v[52:55]
    ds_read_b64_tr_b16 v[128:129], v251 offset:0
    ds_read_b64_tr_b16 v[130:131], v251 offset:768
    v_mfma_f32_16x16x32_bf16 v[60:63], v[144:147], v[172:175], v[60:63]
    ds_read_b128 v[164:167], v22 offset:512
    v_mfma_f32_16x16x32_bf16 v[68:71], v[172:175], v[148:151], v[68:71]
    v_cndmask_b32 v176, v176, v104, s[56:57]
    v_mfma_f32_16x16x32_bf16 v[76:79], v[172:175], v[152:155], v[76:79]
    v_cndmask_b32 v177, v177, v104, s[56:57]
    v_mfma_f32_16x16x32_bf16 v[84:87], v[104:107], v[172:175], v[84:87]
    v_cndmask_b32 v178, v178, v104, s[56:57]
    v_mfma_f32_16x16x32_bf16 v[92:95], v[172:175], v[172:175], v[92:95]
    v_cndmask_b32 v179, v179, v104, s[56:57]
    s_nop 1
    v_mfma_f32_16x16x32_bf16 v[96:99], v[144:147], v[176:179], v[96:99]
    v_mfma_f32_16x16x32_bf16 v[100:103], v[136:139], v[176:179], v[100:103]
    s_waitcnt lgkmcnt(0)
    v_mfma_f32_16x16x32_bf16 v[32:35], v[108:111], v[156:159], v[32:35]
    v_mfma_f32_16x16x32_bf16 v[40:43], v[112:115], v[156:159], v[40:43]
    v_mfma_f32_16x16x32_bf16 v[48:51], v[116:119], v[156:159], v[48:51]
    ds_read_b128 v[168:171], v255 offset:0
    ds_read_b128 v[172:175], v255 offset:2048
    v_mfma_f32_16x16x32_bf16 v[56:59], v[120:123], v[156:159], v[56:59]
    ds_read_b64_tr_b16 v[132:133], v246 offset:6144
    v_mfma_f32_16x16x32_bf16 v[64:67], v[156:159], v[124:127], v[64:67]
    ds_read_b64_tr_b16 v[134:135], v246 offset:6912
    ds_read_b64_tr_b16 v[136:137], v247 offset:6144
    v_mfma_f32_16x16x32_bf16 v[72:75], v[156:159], v[128:131], v[72:75]
    ds_read_b64_tr_b16 v[138:139], v247 offset:6912
    v_mfma_f32_16x16x32_bf16 v[80:83], v[104:107], v[156:159], v[80:83]
    ds_read_b64_tr_b16 v[140:141], v248 offset:6144
    ds_read_b64_tr_b16 v[142:143], v248 offset:6912
    v_mfma_f32_16x16x32_bf16 v[88:91], v[156:159], v[156:159], v[88:91]
    ds_read_b64_tr_b16 v[144:145], v249 offset:6144
    v_mfma_f32_16x16x32_bf16 v[36:39], v[108:111], v[160:163], v[36:39]
    ds_read_b64_tr_b16 v[146:147], v249 offset:6912
    ds_read_b64_tr_b16 v[148:149], v250 offset:6144
    v_mfma_f32_16x16x32_bf16 v[44:47], v[112:115], v[160:163], v[44:47]
    ds_read_b64_tr_b16 v[150:151], v250 offset:6912
    v_mfma_f32_16x16x32_bf16 v[52:55], v[116:119], v[160:163], v[52:55]
    ds_read_b64_tr_b16 v[152:153], v251 offset:6144
    ds_read_b64_tr_b16 v[154:155], v251 offset:6912
    v_mfma_f32_16x16x32_bf16 v[60:63], v[120:123], v[160:163], v[60:63]
    ds_read_b128 v[176:179], v23 offset:512
    v_mfma_f32_16x16x32_bf16 v[68:71], v[160:163], v[124:127], v[68:71]
    ds_read_b32 v17, v18 offset:20
    v_cndmask_b32 v164, v164, v104, s[56:57]
    v_mfma_f32_16x16x32_bf16 v[76:79], v[160:163], v[128:131], v[76:79]
    v_cndmask_b32 v165, v165, v104, s[56:57]
    v_mfma_f32_16x16x32_bf16 v[84:87], v[104:107], v[160:163], v[84:87]
    v_cndmask_b32 v166, v166, v104, s[56:57]
    v_mfma_f32_16x16x32_bf16 v[92:95], v[160:163], v[160:163], v[92:95]
    v_cndmask_b32 v167, v167, v104, s[56:57]
    s_nop 1
    v_mfma_f32_16x16x32_bf16 v[96:99], v[120:123], v[164:167], v[96:99]
    v_mfma_f32_16x16x32_bf16 v[100:103], v[112:115], v[164:167], v[100:103]
    s_waitcnt lgkmcnt(0)
    v_mfma_f32_16x16x32_bf16 v[32:35], v[132:135], v[168:171], v[32:35]
    v_mfma_f32_16x16x32_bf16 v[40:43], v[136:139], v[168:171], v[40:43]
    s_mov_b64 exec, 1
    ds_add_u32 v18, v19 offset:48
    s_mov_b64 exec, -1
    v_readfirstlane_b32 s40, v17
    s_nop 1
    s_cmp_ge_u32 s40, 4
    s_cbranch_scc1 L_sequential_preLN__sliding_local_dilated__geglu_ffn__prompt_kernel_cl1_5x
L_sequential_preLN__sliding_local_dilated__geglu_ffn__prompt_kernel_cl1_5:
    ds_read_b32 v17, v18 offset:20
    s_waitcnt lgkmcnt(0)
    v_readfirstlane_b32 s40, v17
    s_nop 1
    s_cmp_lt_u32 s40, 4
    s_cbranch_scc1 L_sequential_preLN__sliding_local_dilated__geglu_ffn__prompt_kernel_cl1_5
L_sequential_preLN__sliding_local_dilated__geglu_ffn__prompt_kernel_cl1_5x:
    v_mfma_f32_16x16x32_bf16 v[48:51], v[140:143], v[168:171], v[48:51]
    ds_read_b128 v[156:159], v20 offset:0
    ds_read_b128 v[160:163], v20 offset:2048
    v_mfma_f32_16x16x32_bf16 v[56:59], v[144:147], v[168:171], v[56:59]
    ds_read_b64_tr_b16 v[108:109], v26 offset:0
    v_mfma_f32_16x16x32_bf16 v[64:67], v[168:171], v[148:151], v[64:67]
    ds_read_b64_tr_b16 v[110:111], v26 offset:768
    ds_read_b64_tr_b16 v[112:113], v27 offset:0
    v_mfma_f32_16x16x32_bf16 v[72:75], v[168:171], v[152:155], v[72:75]
    ds_read_b64_tr_b16 v[114:115], v27 offset:768
    v_mfma_f32_16x16x32_bf16 v[80:83], v[104:107], v[168:171], v[80:83]
    ds_read_b64_tr_b16 v[116:117], v28 offset:0
    ds_read_b64_tr_b16 v[118:119], v28 offset:768
    v_mfma_f32_16x16x32_bf16 v[88:91], v[168:171], v[168:171], v[88:91]
    ds_read_b64_tr_b16 v[120:121], v29 offset:0
    v_mfma_f32_16x16x32_bf16 v[36:39], v[132:135], v[172:175], v[36:39]
    ds_read_b64_tr_b16 v[122:123], v29 offset:768
    ds_read_b64_tr_b16 v[124:125], v30 offset:0
    v_mfma_f32_16x16x32_bf16 v[44:47], v[136:139], v[172:175], v[44:47]
    ds_read_b64_tr_b16 v[126:127], v30 offset:768
    v_mfma_f32_16x16x32_bf16 v[52:55], v[140:143], v[172:175], v[52:55]
    ds_read_b64_tr_b16 v[128:129], v31 offset:0
    ds_read_b64_tr_b16 v[130:131], v31 offset:768
    v_mfma_f32_16x16x32_bf16 v[60:63], v[144:147], v[172:175], v[60:63]
    ds_read_b128 v[164:167], v24 offset:512
    v_mfma_f32_16x16x32_bf16 v[68:71], v[172:175], v[148:151], v[68:71]
    v_cndmask_b32 v176, v176, v104, s[56:57]
    v_mfma_f32_16x16x32_bf16 v[76:79], v[172:175], v[152:155], v[76:79]
    v_cndmask_b32 v177, v177, v104, s[56:57]
    v_mfma_f32_16x16x32_bf16 v[84:87], v[104:107], v[172:175], v[84:87]
    v_cndmask_b32 v178, v178, v104, s[56:57]
    v_mfma_f32_16x16x32_bf16 v[92:95], v[172:175], v[172:175], v[92:95]
    v_cndmask_b32 v179, v179, v104, s[56:57]
    s_nop 1
    v_mfma_f32_16x16x32_bf16 v[96:99], v[144:147], v[176:179], v[96:99]
    v_mfma_f32_16x16x32_bf16 v[100:103], v[136:139], v[176:179], v[100:103]
    s_waitcnt lgkmcnt(0)
    v_mfma_f32_16x16x32_bf16 v[32:35], v[108:111], v[156:159], v[32:35]
    v_mfma_f32_16x16x32_bf16 v[40:43], v[112:115], v[156:159], v[40:43]
    v_mfma_f32_16x16x32_bf16 v[48:51], v[116:119], v[156:159], v[48:51]
    ds_read_b128 v[168:171], v21 offset:0
    ds_read_b128 v[172:175], v21 offset:2048
    v_mfma_f32_16x16x32_bf16 v[56:59], v[120:123], v[156:159], v[56:59]
    ds_read_b64_tr_b16 v[132:133], v26 offset:6144
    v_mfma_f32_16x16x32_bf16 v[64:67], v[156:159], v[124:127], v[64:67]
    ds_read_b64_tr_b16 v[134:135], v26 offset:6912
    ds_read_b64_tr_b16 v[136:137], v27 offset:6144
    v_mfma_f32_16x16x32_bf16 v[72:75], v[156:159], v[128:131], v[72:75]
    ds_read_b64_tr_b16 v[138:139], v27 offset:6912
    v_mfma_f32_16x16x32_bf16 v[80:83], v[104:107], v[156:159], v[80:83]
    ds_read_b64_tr_b16 v[140:141], v28 offset:6144
    ds_read_b64_tr_b16 v[142:143], v28 offset:6912
    v_mfma_f32_16x16x32_bf16 v[88:91], v[156:159], v[156:159], v[88:91]
    ds_read_b64_tr_b16 v[144:145], v29 offset:6144
    v_mfma_f32_16x16x32_bf16 v[36:39], v[108:111], v[160:163], v[36:39]
    ds_read_b64_tr_b16 v[146:147], v29 offset:6912
    ds_read_b64_tr_b16 v[148:149], v30 offset:6144
    v_mfma_f32_16x16x32_bf16 v[44:47], v[112:115], v[160:163], v[44:47]
    ds_read_b64_tr_b16 v[150:151], v30 offset:6912
    v_mfma_f32_16x16x32_bf16 v[52:55], v[116:119], v[160:163], v[52:55]
    ds_read_b64_tr_b16 v[152:153], v31 offset:6144
    ds_read_b64_tr_b16 v[154:155], v31 offset:6912
    v_mfma_f32_16x16x32_bf16 v[60:63], v[120:123], v[160:163], v[60:63]
    ds_read_b128 v[176:179], v25 offset:512
    v_mfma_f32_16x16x32_bf16 v[68:71], v[160:163], v[124:127], v[68:71]
    ds_read_b32 v17, v18 offset:24
    v_cndmask_b32 v164, v164, v104, s[56:57]
    v_mfma_f32_16x16x32_bf16 v[76:79], v[160:163], v[128:131], v[76:79]
    v_cndmask_b32 v165, v165, v104, s[56:57]
    v_mfma_f32_16x16x32_bf16 v[84:87], v[104:107], v[160:163], v[84:87]
    v_cndmask_b32 v166, v166, v104, s[56:57]
    v_mfma_f32_16x16x32_bf16 v[92:95], v[160:163], v[160:163], v[92:95]
    v_cndmask_b32 v167, v167, v104, s[56:57]
    s_nop 1
    v_mfma_f32_16x16x32_bf16 v[96:99], v[120:123], v[164:167], v[96:99]
    v_mfma_f32_16x16x32_bf16 v[100:103], v[112:115], v[164:167], v[100:103]
    s_waitcnt lgkmcnt(0)
    v_mfma_f32_16x16x32_bf16 v[32:35], v[132:135], v[168:171], v[32:35]
    v_mfma_f32_16x16x32_bf16 v[40:43], v[136:139], v[168:171], v[40:43]
    v_readfirstlane_b32 s40, v17
    s_nop 1
    s_cmp_ge_u32 s40, 4
    s_cbranch_scc1 L_sequential_preLN__sliding_local_dilated__geglu_ffn__prompt_kernel_cl1_6x
L_sequential_preLN__sliding_local_dilated__geglu_ffn__prompt_kernel_cl1_6:
    ds_read_b32 v17, v18 offset:24
    s_waitcnt lgkmcnt(0)
    v_readfirstlane_b32 s40, v17
    s_nop 1
    s_cmp_lt_u32 s40, 4
    s_cbranch_scc1 L_sequential_preLN__sliding_local_dilated__geglu_ffn__prompt_kernel_cl1_6
L_sequential_preLN__sliding_local_dilated__geglu_ffn__prompt_kernel_cl1_6x:
    v_mfma_f32_16x16x32_bf16 v[48:51], v[140:143], v[168:171], v[48:51]
    ds_read_b128 v[156:159], v20 offset:28672
    ds_read_b128 v[160:163], v20 offset:30720
    v_mfma_f32_16x16x32_bf16 v[56:59], v[144:147], v[168:171], v[56:59]
    ds_read_b64_tr_b16 v[108:109], v26 offset:28672
    v_mfma_f32_16x16x32_bf16 v[64:67], v[168:171], v[148:151], v[64:67]
    ds_read_b64_tr_b16 v[110:111], v26 offset:29440
    ds_read_b64_tr_b16 v[112:113], v27 offset:28672
    v_mfma_f32_16x16x32_bf16 v[72:75], v[168:171], v[152:155], v[72:75]
    ds_read_b64_tr_b16 v[114:115], v27 offset:29440
    v_mfma_f32_16x16x32_bf16 v[80:83], v[104:107], v[168:171], v[80:83]
    ds_read_b64_tr_b16 v[116:117], v28 offset:28672
    ds_read_b64_tr_b16 v[118:119], v28 offset:29440
    v_mfma_f32_16x16x32_bf16 v[88:91], v[168:171], v[168:171], v[88:91]
    ds_read_b64_tr_b16 v[120:121], v29 offset:28672
    v_mfma_f32_16x16x32_bf16 v[36:39], v[132:135], v[172:175], v[36:39]
    ds_read_b64_tr_b16 v[122:123], v29 offset:29440
    ds_read_b64_tr_b16 v[124:125], v30 offset:28672
    v_mfma_f32_16x16x32_bf16 v[44:47], v[136:139], v[172:175], v[44:47]
    ds_read_b64_tr_b16 v[126:127], v30 offset:29440
    v_mfma_f32_16x16x32_bf16 v[52:55], v[140:143], v[172:175], v[52:55]
    ds_read_b64_tr_b16 v[128:129], v31 offset:28672
    ds_read_b64_tr_b16 v[130:131], v31 offset:29440
    v_mfma_f32_16x16x32_bf16 v[60:63], v[144:147], v[172:175], v[60:63]
    ds_read_b128 v[164:167], v22 offset:768
    v_mfma_f32_16x16x32_bf16 v[68:71], v[172:175], v[148:151], v[68:71]
    v_cndmask_b32 v176, v176, v104, s[56:57]
    v_mfma_f32_16x16x32_bf16 v[76:79], v[172:175], v[152:155], v[76:79]
    v_cndmask_b32 v177, v177, v104, s[56:57]
    v_mfma_f32_16x16x32_bf16 v[84:87], v[104:107], v[172:175], v[84:87]
    v_cndmask_b32 v178, v178, v104, s[56:57]
    v_mfma_f32_16x16x32_bf16 v[92:95], v[172:175], v[172:175], v[92:95]
    v_cndmask_b32 v179, v179, v104, s[56:57]
    s_nop 1
    v_mfma_f32_16x16x32_bf16 v[96:99], v[144:147], v[176:179], v[96:99]
    v_mfma_f32_16x16x32_bf16 v[100:103], v[136:139], v[176:179], v[100:103]
    s_waitcnt lgkmcnt(0)
    v_mfma_f32_16x16x32_bf16 v[32:35], v[108:111], v[156:159], v[32:35]
    v_mfma_f32_16x16x32_bf16 v[40:43], v[112:115], v[156:159], v[40:43]
    v_mfma_f32_16x16x32_bf16 v[48:51], v[116:119], v[156:159], v[48:51]
    ds_read_b128 v[168:171], v21 offset:28672
    ds_read_b128 v[172:175], v21 offset:30720
    v_mfma_f32_16x16x32_bf16 v[56:59], v[120:123], v[156:159], v[56:59]
    ds_read_b64_tr_b16 v[132:133], v26 offset:34816
    v_mfma_f32_16x16x32_bf16 v[64:67], v[156:159], v[124:127], v[64:67]
    ds_read_b64_tr_b16 v[134:135], v26 offset:35584
    ds_read_b64_tr_b16 v[136:137], v27 offset:34816
    v_mfma_f32_16x16x32_bf16 v[72:75], v[156:159], v[128:131], v[72:75]
    ds_read_b64_tr_b16 v[138:139], v27 offset:35584
    v_mfma_f32_16x16x32_bf16 v[80:83], v[104:107], v[156:159], v[80:83]
    ds_read_b64_tr_b16 v[140:141], v28 offset:34816
    ds_read_b64_tr_b16 v[142:143], v28 offset:35584
    v_mfma_f32_16x16x32_bf16 v[88:91], v[156:159], v[156:159], v[88:91]
    ds_read_b64_tr_b16 v[144:145], v29 offset:34816
    v_mfma_f32_16x16x32_bf16 v[36:39], v[108:111], v[160:163], v[36:39]
    ds_read_b64_tr_b16 v[146:147], v29 offset:35584
    ds_read_b64_tr_b16 v[148:149], v30 offset:34816
    v_mfma_f32_16x16x32_bf16 v[44:47], v[112:115], v[160:163], v[44:47]
    ds_read_b64_tr_b16 v[150:151], v30 offset:35584
    v_mfma_f32_16x16x32_bf16 v[52:55], v[116:119], v[160:163], v[52:55]
    ds_read_b64_tr_b16 v[152:153], v31 offset:34816
    ds_read_b64_tr_b16 v[154:155], v31 offset:35584
    v_mfma_f32_16x16x32_bf16 v[60:63], v[120:123], v[160:163], v[60:63]
    ds_read_b128 v[176:179], v23 offset:768
    v_mfma_f32_16x16x32_bf16 v[68:71], v[160:163], v[124:127], v[68:71]
    ds_read_b32 v17, v18 offset:28
    v_cndmask_b32 v164, v164, v104, s[56:57]
    v_mfma_f32_16x16x32_bf16 v[76:79], v[160:163], v[128:131], v[76:79]
    v_cndmask_b32 v165, v165, v104, s[56:57]
    v_mfma_f32_16x16x32_bf16 v[84:87], v[104:107], v[160:163], v[84:87]
    v_cndmask_b32 v166, v166, v104, s[56:57]
    v_mfma_f32_16x16x32_bf16 v[92:95], v[160:163], v[160:163], v[92:95]
    v_cndmask_b32 v167, v167, v104, s[56:57]
    s_nop 1
    v_mfma_f32_16x16x32_bf16 v[96:99], v[120:123], v[164:167], v[96:99]
    v_mfma_f32_16x16x32_bf16 v[100:103], v[112:115], v[164:167], v[100:103]
    s_waitcnt lgkmcnt(0)
    v_mfma_f32_16x16x32_bf16 v[32:35], v[132:135], v[168:171], v[32:35]
    v_mfma_f32_16x16x32_bf16 v[40:43], v[136:139], v[168:171], v[40:43]
    v_readfirstlane_b32 s40, v17
    s_nop 1
    s_cmp_ge_u32 s40, 4
    s_cbranch_scc1 L_sequential_preLN__sliding_local_dilated__geglu_ffn__prompt_kernel_cl1_7x
L_sequential_preLN__sliding_local_dilated__geglu_ffn__prompt_kernel_cl1_7:
    ds_read_b32 v17, v18 offset:28
    s_waitcnt lgkmcnt(0)
    v_readfirstlane_b32 s40, v17
    s_nop 1
    s_cmp_lt_u32 s40, 4
    s_cbranch_scc1 L_sequential_preLN__sliding_local_dilated__geglu_ffn__prompt_kernel_cl1_7
L_sequential_preLN__sliding_local_dilated__geglu_ffn__prompt_kernel_cl1_7x:
    v_mfma_f32_16x16x32_bf16 v[48:51], v[140:143], v[168:171], v[48:51]
    ds_read_b128 v[156:159], v252 offset:0
    ds_read_b128 v[160:163], v252 offset:2048
    v_mfma_f32_16x16x32_bf16 v[56:59], v[144:147], v[168:171], v[56:59]
    ds_read_b64_tr_b16 v[108:109], v240 offset:0
    v_mfma_f32_16x16x32_bf16 v[64:67], v[168:171], v[148:151], v[64:67]
    ds_read_b64_tr_b16 v[110:111], v240 offset:768
    ds_read_b64_tr_b16 v[112:113], v241 offset:0
    v_mfma_f32_16x16x32_bf16 v[72:75], v[168:171], v[152:155], v[72:75]
    ds_read_b64_tr_b16 v[114:115], v241 offset:768
    v_mfma_f32_16x16x32_bf16 v[80:83], v[104:107], v[168:171], v[80:83]
    ds_read_b64_tr_b16 v[116:117], v242 offset:0
    ds_read_b64_tr_b16 v[118:119], v242 offset:768
    v_mfma_f32_16x16x32_bf16 v[88:91], v[168:171], v[168:171], v[88:91]
    ds_read_b64_tr_b16 v[120:121], v243 offset:0
    v_mfma_f32_16x16x32_bf16 v[36:39], v[132:135], v[172:175], v[36:39]
    ds_read_b64_tr_b16 v[122:123], v243 offset:768
    ds_read_b64_tr_b16 v[124:125], v244 offset:0
    v_mfma_f32_16x16x32_bf16 v[44:47], v[136:139], v[172:175], v[44:47]
    ds_read_b64_tr_b16 v[126:127], v244 offset:768
    v_mfma_f32_16x16x32_bf16 v[52:55], v[140:143], v[172:175], v[52:55]
    ds_read_b64_tr_b16 v[128:129], v245 offset:0
    ds_read_b64_tr_b16 v[130:131], v245 offset:768
    v_mfma_f32_16x16x32_bf16 v[60:63], v[144:147], v[172:175], v[60:63]
    ds_read_b128 v[164:167], v24 offset:768
    v_mfma_f32_16x16x32_bf16 v[68:71], v[172:175], v[148:151], v[68:71]
    v_cndmask_b32 v176, v176, v104, s[56:57]
    v_mfma_f32_16x16x32_bf16 v[76:79], v[172:175], v[152:155], v[76:79]
    v_cndmask_b32 v177, v177, v104, s[56:57]
    v_mfma_f32_16x16x32_bf16 v[84:87], v[104:107], v[172:175], v[84:87]
    v_cndmask_b32 v178, v178, v104, s[56:57]
    v_mfma_f32_16x16x32_bf16 v[92:95], v[172:175], v[172:175], v[92:95]
    v_cndmask_b32 v179, v179, v104, s[56:57]
    s_nop 1
    v_mfma_f32_16x16x32_bf16 v[96:99], v[144:147], v[176:179], v[96:99]
    v_mfma_f32_16x16x32_bf16 v[100:103], v[136:139], v[176:179], v[100:103]
    s_waitcnt lgkmcnt(0)
    v_mfma_f32_16x16x32_bf16 v[32:35], v[108:111], v[156:159], v[32:35]
    v_mfma_f32_16x16x32_bf16 v[40:43], v[112:115], v[156:159], v[40:43]
    v_mfma_f32_16x16x32_bf16 v[48:51], v[116:119], v[156:159], v[48:51]
    ds_read_b128 v[168:171], v253 offset:0
    ds_read_b128 v[172:175], v253 offset:2048
    v_mfma_f32_16x16x32_bf16 v[56:59], v[120:123], v[156:159], v[56:59]
    ds_read_b64_tr_b16 v[132:133], v240 offset:6144
    v_mfma_f32_16x16x32_bf16 v[64:67], v[156:159], v[124:127], v[64:67]
    ds_read_b64_tr_b16 v[134:135], v240 offset:6912
    ds_read_b64_tr_b16 v[136:137], v241 offset:6144
    v_mfma_f32_16x16x32_bf16 v[72:75], v[156:159], v[128:131], v[72:75]
    ds_read_b64_tr_b16 v[138:139], v241 offset:6912
    v_mfma_f32_16x16x32_bf16 v[80:83], v[104:107], v[156:159], v[80:83]
    ds_read_b64_tr_b16 v[140:141], v242 offset:6144
    ds_read_b64_tr_b16 v[142:143], v242 offset:6912
    v_mfma_f32_16x16x32_bf16 v[88:91], v[156:159], v[156:159], v[88:91]
    ds_read_b64_tr_b16 v[144:145], v243 offset:6144
    v_mfma_f32_16x16x32_bf16 v[36:39], v[108:111], v[160:163], v[36:39]
    ds_read_b64_tr_b16 v[146:147], v243 offset:6912
    ds_read_b64_tr_b16 v[148:149], v244 offset:6144
    v_mfma_f32_16x16x32_bf16 v[44:47], v[112:115], v[160:163], v[44:47]
    ds_read_b64_tr_b16 v[150:151], v244 offset:6912
    v_mfma_f32_16x16x32_bf16 v[52:55], v[116:119], v[160:163], v[52:55]
    ds_read_b64_tr_b16 v[152:153], v245 offset:6144
    ds_read_b64_tr_b16 v[154:155], v245 offset:6912
    v_mfma_f32_16x16x32_bf16 v[60:63], v[120:123], v[160:163], v[60:63]
    ds_read_b128 v[176:179], v25 offset:768
    v_mfma_f32_16x16x32_bf16 v[68:71], v[160:163], v[124:127], v[68:71]
    v_cndmask_b32 v164, v164, v104, s[56:57]
    v_mfma_f32_16x16x32_bf16 v[76:79], v[160:163], v[128:131], v[76:79]
    v_cndmask_b32 v165, v165, v104, s[56:57]
    v_mfma_f32_16x16x32_bf16 v[84:87], v[104:107], v[160:163], v[84:87]
    v_cndmask_b32 v166, v166, v104, s[56:57]
    v_mfma_f32_16x16x32_bf16 v[92:95], v[160:163], v[160:163], v[92:95]
    v_cndmask_b32 v167, v167, v104, s[56:57]
    s_nop 1
    v_mfma_f32_16x16x32_bf16 v[96:99], v[120:123], v[164:167], v[96:99]
    v_mfma_f32_16x16x32_bf16 v[100:103], v[112:115], v[164:167], v[100:103]
    s_waitcnt lgkmcnt(0)
    v_mfma_f32_16x16x32_bf16 v[32:35], v[132:135], v[168:171], v[32:35]
    v_mfma_f32_16x16x32_bf16 v[40:43], v[136:139], v[168:171], v[40:43]
    v_mfma_f32_16x16x32_bf16 v[48:51], v[140:143], v[168:171], v[48:51]
    v_mfma_f32_16x16x32_bf16 v[56:59], v[144:147], v[168:171], v[56:59]
    v_mfma_f32_16x16x32_bf16 v[64:67], v[168:171], v[148:151], v[64:67]
    v_mfma_f32_16x16x32_bf16 v[72:75], v[168:171], v[152:155], v[72:75]
    v_mfma_f32_16x16x32_bf16 v[80:83], v[104:107], v[168:171], v[80:83]
    v_mfma_f32_16x16x32_bf16 v[88:91], v[168:171], v[168:171], v[88:91]
    v_mfma_f32_16x16x32_bf16 v[36:39], v[132:135], v[172:175], v[36:39]
    v_mfma_f32_16x16x32_bf16 v[44:47], v[136:139], v[172:175], v[44:47]
    v_mfma_f32_16x16x32_bf16 v[52:55], v[140:143], v[172:175], v[52:55]
    v_mfma_f32_16x16x32_bf16 v[60:63], v[144:147], v[172:175], v[60:63]
    v_mfma_f32_16x16x32_bf16 v[68:71], v[172:175], v[148:151], v[68:71]
    v_cndmask_b32 v176, v176, v104, s[56:57]
    v_mfma_f32_16x16x32_bf16 v[76:79], v[172:175], v[152:155], v[76:79]
    v_cndmask_b32 v177, v177, v104, s[56:57]
    v_mfma_f32_16x16x32_bf16 v[84:87], v[104:107], v[172:175], v[84:87]
    v_cndmask_b32 v178, v178, v104, s[56:57]
    v_mfma_f32_16x16x32_bf16 v[92:95], v[172:175], v[172:175], v[92:95]
    v_cndmask_b32 v179, v179, v104, s[56:57]
    s_nop 1
    v_mfma_f32_16x16x32_bf16 v[96:99], v[144:147], v[176:179], v[96:99]
    v_mfma_f32_16x16x32_bf16 v[100:103], v[136:139], v[176:179], v[100:103]
    s_nop 7
L_sequential_preLN__sliding_local_dilated__geglu_ffn__prompt_kernel_cx1:
    ds_read_b32 v17, v18 offset:48
    s_waitcnt lgkmcnt(0)
    v_readfirstlane_b32 s40, v17
    s_nop 1
    s_cmp_lt_u32 s40, 4
    s_nop 1
    s_cbranch_scc1 L_sequential_preLN__sliding_local_dilated__geglu_ffn__prompt_kernel_cx1
    v_lshlrev_b32 v9, 3, v6
    v_add_u32 v9, 134400, v9
    v_lshlrev_b32 v15, 2, v6
    v_add_u32 v15, 134400, v15
    v_add_u32 v14, 131328, v1
    v_cndmask_b32 v10, v88, v89, s[58:59]
    v_cndmask_b32 v10, v10, v90, s[60:61]
    v_cndmask_b32 v10, v10, v91, s[62:63]
    v_mul_f32 v11, 0.001953125, v80
    v_mul_f32 v10, 0.001953125, v10
    v_fma_f32 v10, -v11, v11, v10
    v_max_f32 v10, 0, v10
    v_add_f32 v10, 0x3727c5ac, v10
    v_rsq_f32 v12, v10
    s_nop 0
    v_mul_f32 v13, v11, v12
    v_sub_f32 v13, 0, v13
    s_mov_b64 exec, s[84:85]
    ds_write_b64 v9, v[12:13] offset:0
    ds_write_b32 v15, v12 offset:640
    ds_write_b32 v15, v13 offset:704
    s_mov_b64 exec, -1
    ds_write_b128 v14, v[52:55] offset:16384
    ds_write_b128 v14, v[60:63] offset:17408
    ds_write_b128 v14, v[68:71] offset:18432
    ds_write_b128 v14, v[76:79] offset:19456
    v_cndmask_b32 v10, v92, v93, s[58:59]
    v_cndmask_b32 v10, v10, v94, s[60:61]
    v_cndmask_b32 v10, v10, v95, s[62:63]
    v_mul_f32 v11, 0.001953125, v84
    v_mul_f32 v10, 0.001953125, v10
    v_fma_f32 v10, -v11, v11, v10
    v_max_f32 v10, 0, v10
    v_add_f32 v10, 0x3727c5ac, v10
    v_rsq_f32 v12, v10
    s_nop 0
    v_mul_f32 v13, v11, v12
    v_sub_f32 v13, 0, v13
    s_mov_b64 exec, s[84:85]
    ds_write_b64 v9, v[12:13] offset:128
    ds_write_b32 v15, v12 offset:768
    ds_write_b32 v15, v13 offset:832
    s_mov_b64 exec, -1
    ds_write_b128 v14, v[96:99] offset:4096
    v_lshlrev_b32 v11, 4, v5
    v_add_u32 v11, 134400, v11
    s_mov_b64 exec, s[56:57]
    ds_write_b128 v11, v[96:99] offset:512
    ds_write_b128 v11, v[100:103] offset:576
    s_mov_b64 exec, -1
    v_lshlrev_b32 v9, 3, v6
    v_lshlrev_b32 v10, 5, v5
    v_lshlrev_b32 v11, 4, v5
    v_lshlrev_b32 v12, 2, v6
    v_add_u32 v9, 131328, v9
    v_add_u32 v10, 131328, v10
    v_add_u32 v11, 131328, v11
    v_add_u32 v12, 131328, v12
    s_waitcnt lgkmcnt(0)
    s_barrier
    ds_read_b64 v[110:111], v9 offset:3072
    ds_read_b128 v[140:143], v11 offset:576
    ds_read_b128 v[148:151], v11 offset:512
    ds_read_b32 v156, v12 offset:6656
    ds_read_b128 v[144:147], v11 offset:3648
    ds_read_b128 v[152:155], v11 offset:3584
    ds_read_b32 v157, v12 offset:6720
    ds_read_b128 v[124:127], v11 offset:3712
    ds_read_b128 v[128:131], v11 offset:3776
    ds_read_b64 v[108:109], v9 offset:128
    ds_read_b128 v[116:119], v11 offset:768
    ds_read_b128 v[120:123], v11 offset:832
    ds_read_b64 v[112:113], v9 offset:3200
    ds_read_b128 v[132:135], v11 offset:3840
    ds_read_b128 v[136:139], v11 offset:3904
    ds_read_b128 v[160:163], v14 offset:12288
    ds_read_b128 v[164:167], v14 offset:13312
    ds_read_b128 v[168:171], v14 offset:14336
    ds_read_b128 v[172:175], v14 offset:15360
    s_waitcnt lgkmcnt(10)
    v_pk_mul_f32 v[16:17], v[140:141], v[110:111] op_sel:[0,1] op_sel_hi:[1,1]
    v_pk_fma_f32 v[16:17], v[32:33], v[110:111], v[16:17] op_sel_hi:[1,0,1]
    v_pk_mul_f32 v[18:19], v[142:143], v[110:111] op_sel:[0,1] op_sel_hi:[1,1]
    v_pk_fma_f32 v[18:19], v[34:35], v[110:111], v[18:19] op_sel_hi:[1,0,1]
    v_cvt_pk_bf16_f32 v190, v16, v17
    v_cvt_pk_bf16_f32 v191, v18, v19
    v_pk_mul_f32 v[224:225], v[144:145], v[110:111] op_sel:[0,1] op_sel_hi:[1,1]
    v_pk_fma_f32 v[224:225], v[40:41], v[110:111], v[224:225] op_sel_hi:[1,0,1]
    v_pk_mul_f32 v[226:227], v[146:147], v[110:111] op_sel:[0,1] op_sel_hi:[1,1]
    v_pk_fma_f32 v[226:227], v[42:43], v[110:111], v[226:227] op_sel_hi:[1,0,1]
    v_cvt_pk_bf16_f32 v196, v224, v225
    v_cvt_pk_bf16_f32 v197, v226, v227
    v_pk_mul_f32 v[16:17], v[148:149], v[110:111] op_sel:[0,1] op_sel_hi:[1,1]
    v_pk_fma_f32 v[16:17], v[48:49], v[110:111], v[16:17] op_sel_hi:[1,0,1]
    v_pk_mul_f32 v[18:19], v[150:151], v[110:111] op_sel:[0,1] op_sel_hi:[1,1]
    v_pk_fma_f32 v[18:19], v[50:51], v[110:111], v[18:19] op_sel_hi:[1,0,1]
    v_cvt_pk_bf16_f32 v202, v16, v17
    v_cvt_pk_bf16_f32 v203, v18, v19
    v_pk_mul_f32 v[224:225], v[152:153], v[110:111] op_sel:[0,1] op_sel_hi:[1,1]
    v_pk_fma_f32 v[224:225], v[56:57], v[110:111], v[224:225] op_sel_hi:[1,0,1]
    v_pk_mul_f32 v[226:227], v[154:155], v[110:111] op_sel:[0,1] op_sel_hi:[1,1]
    v_pk_fma_f32 v[226:227], v[58:59], v[110:111], v[226:227] op_sel_hi:[1,0,1]
    v_cvt_pk_bf16_f32 v208, v224, v225
    v_cvt_pk_bf16_f32 v209, v226, v227
    v_pk_mul_f32 v[16:17], v[128:129], v[156:157] op_sel_hi:[1,0]
    v_pk_fma_f32 v[16:17], v[64:65], v[124:125], v[16:17]
    v_pk_mul_f32 v[18:19], v[130:131], v[156:157] op_sel_hi:[1,0]
    v_pk_fma_f32 v[18:19], v[66:67], v[126:127], v[18:19]
    v_cvt_pk_bf16_f32 v214, v16, v17
    v_cvt_pk_bf16_f32 v215, v18, v19
    v_pk_mul_f32 v[224:225], v[128:129], v[156:157] op_sel:[0,1] op_sel_hi:[1,1]
    v_pk_fma_f32 v[224:225], v[72:73], v[124:125], v[224:225]
    v_pk_mul_f32 v[226:227], v[130:131], v[156:157] op_sel:[0,1] op_sel_hi:[1,1]
    v_pk_fma_f32 v[226:227], v[74:75], v[126:127], v[226:227]
    v_cvt_pk_bf16_f32 v220, v224, v225
    v_cvt_pk_bf16_f32 v221, v226, v227
    s_waitcnt lgkmcnt(0)
    v_pk_mul_f32 v[16:17], v[140:141], v[112:113] op_sel:[0,1] op_sel_hi:[1,1]
    v_pk_fma_f32 v[16:17], v[36:37], v[112:113], v[16:17] op_sel_hi:[1,0,1]
    v_pk_mul_f32 v[18:19], v[142:143], v[112:113] op_sel:[0,1] op_sel_hi:[1,1]
    v_pk_fma_f32 v[18:19], v[38:39], v[112:113], v[18:19] op_sel_hi:[1,0,1]
    v_cvt_pk_bf16_f32 v192, v16, v17
    v_cvt_pk_bf16_f32 v193, v18, v19
    v_pk_mul_f32 v[224:225], v[144:145], v[112:113] op_sel:[0,1] op_sel_hi:[1,1]
    v_pk_fma_f32 v[224:225], v[44:45], v[112:113], v[224:225] op_sel_hi:[1,0,1]
    v_pk_mul_f32 v[226:227], v[146:147], v[112:113] op_sel:[0,1] op_sel_hi:[1,1]
    v_pk_fma_f32 v[226:227], v[46:47], v[112:113], v[226:227] op_sel_hi:[1,0,1]
    v_cvt_pk_bf16_f32 v198, v224, v225
    v_cvt_pk_bf16_f32 v199, v226, v227
    v_pk_mul_f32 v[16:17], v[148:149], v[112:113] op_sel:[0,1] op_sel_hi:[1,1]
    v_pk_fma_f32 v[16:17], v[52:53], v[112:113], v[16:17] op_sel_hi:[1,0,1]
    v_pk_mul_f32 v[18:19], v[150:151], v[112:113] op_sel:[0,1] op_sel_hi:[1,1]
    v_pk_fma_f32 v[18:19], v[54:55], v[112:113], v[18:19] op_sel_hi:[1,0,1]
    v_cvt_pk_bf16_f32 v204, v16, v17
    v_cvt_pk_bf16_f32 v205, v18, v19
    v_pk_mul_f32 v[224:225], v[152:153], v[112:113] op_sel:[0,1] op_sel_hi:[1,1]
    v_pk_fma_f32 v[224:225], v[60:61], v[112:113], v[224:225] op_sel_hi:[1,0,1]
    v_pk_mul_f32 v[226:227], v[154:155], v[112:113] op_sel:[0,1] op_sel_hi:[1,1]
    v_pk_fma_f32 v[226:227], v[62:63], v[112:113], v[226:227] op_sel_hi:[1,0,1]
    v_cvt_pk_bf16_f32 v210, v224, v225
    v_cvt_pk_bf16_f32 v211, v226, v227
    v_pk_mul_f32 v[16:17], v[136:137], v[156:157] op_sel_hi:[1,0]
    v_pk_fma_f32 v[16:17], v[68:69], v[132:133], v[16:17]
    v_pk_mul_f32 v[18:19], v[138:139], v[156:157] op_sel_hi:[1,0]
    v_pk_fma_f32 v[18:19], v[70:71], v[134:135], v[18:19]
    v_cvt_pk_bf16_f32 v216, v16, v17
    v_cvt_pk_bf16_f32 v217, v18, v19
    v_pk_mul_f32 v[224:225], v[136:137], v[156:157] op_sel:[0,1] op_sel_hi:[1,1]
    v_pk_fma_f32 v[224:225], v[76:77], v[132:133], v[224:225]
    v_pk_mul_f32 v[226:227], v[138:139], v[156:157] op_sel:[0,1] op_sel_hi:[1,1]
    v_pk_fma_f32 v[226:227], v[78:79], v[134:135], v[226:227]
    v_cvt_pk_bf16_f32 v222, v224, v225
    v_cvt_pk_bf16_f32 v223, v226, v227
    v_pk_mul_f32 v[16:17], v[148:149], v[108:109] op_sel:[0,1] op_sel_hi:[1,1]
    v_pk_fma_f32 v[16:17], v[160:161], v[108:109], v[16:17] op_sel_hi:[1,0,1]
    v_pk_mul_f32 v[18:19], v[150:151], v[108:109] op_sel:[0,1] op_sel_hi:[1,1]
    v_pk_fma_f32 v[18:19], v[162:163], v[108:109], v[18:19] op_sel_hi:[1,0,1]
    v_cvt_pk_bf16_f32 v200, v16, v17
    v_cvt_pk_bf16_f32 v201, v18, v19
    v_pk_mul_f32 v[224:225], v[152:153], v[108:109] op_sel:[0,1] op_sel_hi:[1,1]
    v_pk_fma_f32 v[224:225], v[164:165], v[108:109], v[224:225] op_sel_hi:[1,0,1]
    v_pk_mul_f32 v[226:227], v[154:155], v[108:109] op_sel:[0,1] op_sel_hi:[1,1]
    v_pk_fma_f32 v[226:227], v[166:167], v[108:109], v[226:227] op_sel_hi:[1,0,1]
    v_cvt_pk_bf16_f32 v206, v224, v225
    v_cvt_pk_bf16_f32 v207, v226, v227
    v_pk_mul_f32 v[16:17], v[120:121], v[156:157] op_sel_hi:[1,0]
    v_pk_fma_f32 v[16:17], v[168:169], v[116:117], v[16:17]
    v_pk_mul_f32 v[18:19], v[122:123], v[156:157] op_sel_hi:[1,0]
    v_pk_fma_f32 v[18:19], v[170:171], v[118:119], v[18:19]
    v_cvt_pk_bf16_f32 v212, v16, v17
    v_cvt_pk_bf16_f32 v213, v18, v19
    v_pk_mul_f32 v[224:225], v[120:121], v[156:157] op_sel:[0,1] op_sel_hi:[1,1]
    v_pk_fma_f32 v[224:225], v[172:173], v[116:117], v[224:225]
    v_pk_mul_f32 v[226:227], v[122:123], v[156:157] op_sel:[0,1] op_sel_hi:[1,1]
    v_pk_fma_f32 v[226:227], v[174:175], v[118:119], v[226:227]
    v_cvt_pk_bf16_f32 v218, v224, v225
    v_cvt_pk_bf16_f32 v219, v226, v227
    v_mfma_f32_16x16x16_bf16 v[32:35], v[200:201], v[190:191], 0
    v_mfma_f32_16x16x16_bf16 v[36:39], v[202:203], v[190:191], 0
    v_mfma_f32_16x16x16_bf16 v[40:43], v[206:207], v[196:197], 0
    v_mfma_f32_16x16x16_bf16 v[44:47], v[208:209], v[196:197], 0
    v_mfma_f32_16x16x16_bf16 v[48:51], v[202:203], v[192:193], 0
    v_mfma_f32_16x16x16_bf16 v[52:55], v[204:205], v[192:193], 0
    v_mfma_f32_16x16x16_bf16 v[56:59], v[208:209], v[198:199], 0
    v_mfma_f32_16x16x16_bf16 v[60:63], v[210:211], v[198:199], 0
    v_mov_b32 v132, s87
    v_pk_fma_f32 v[32:33], v[32:33], v[132:133], v[232:233] op_sel_hi:[1,0,1]
    v_pk_fma_f32 v[34:35], v[34:35], v[132:133], v[234:235] op_sel_hi:[1,0,1]
    v_pk_fma_f32 v[36:37], v[36:37], v[132:133], v[228:229] op_sel_hi:[1,0,1]
    v_pk_fma_f32 v[38:39], v[38:39], v[132:133], v[230:231] op_sel_hi:[1,0,1]
    v_max3_f32 v108, v32, v33, v34
    v_max3_f32 v108, v108, v35, v36
    v_max3_f32 v108, v108, v37, v38
    v_max_f32 v108, v108, v39
    v_pk_fma_f32 v[40:41], v[40:41], v[132:133], v[232:233] op_sel_hi:[1,0,1]
    v_pk_fma_f32 v[42:43], v[42:43], v[132:133], v[234:235] op_sel_hi:[1,0,1]
    v_pk_fma_f32 v[44:45], v[44:45], v[132:133], v[228:229] op_sel_hi:[1,0,1]
    v_pk_fma_f32 v[46:47], v[46:47], v[132:133], v[230:231] op_sel_hi:[1,0,1]
    v_max3_f32 v110, v40, v41, v42
    v_max3_f32 v110, v110, v43, v44
    v_max3_f32 v110, v110, v45, v46
    v_max_f32 v110, v110, v47
    v_pk_fma_f32 v[48:49], v[48:49], v[132:133], v[232:233] op_sel_hi:[1,0,1]
    v_pk_fma_f32 v[50:51], v[50:51], v[132:133], v[234:235] op_sel_hi:[1,0,1]
    v_pk_fma_f32 v[52:53], v[52:53], v[132:133], v[228:229] op_sel_hi:[1,0,1]
    v_pk_fma_f32 v[54:55], v[54:55], v[132:133], v[230:231] op_sel_hi:[1,0,1]
    v_max3_f32 v112, v48, v49, v50
    v_max3_f32 v112, v112, v51, v52
    v_max3_f32 v112, v112, v53, v54
    v_max_f32 v112, v112, v55
    v_pk_fma_f32 v[56:57], v[56:57], v[132:133], v[232:233] op_sel_hi:[1,0,1]
    v_pk_fma_f32 v[58:59], v[58:59], v[132:133], v[234:235] op_sel_hi:[1,0,1]
    v_pk_fma_f32 v[60:61], v[60:61], v[132:133], v[228:229] op_sel_hi:[1,0,1]
    v_pk_fma_f32 v[62:63], v[62:63], v[132:133], v[230:231] op_sel_hi:[1,0,1]
    v_max3_f32 v114, v56, v57, v58
    v_max3_f32 v114, v114, v59, v60
    v_max3_f32 v114, v114, v61, v62
    v_max_f32 v114, v114, v63
    v_mov_b32 v124, v108
    v_mov_b32 v125, v110
    v_mov_b32 v126, v112
    v_mov_b32 v127, v114
    v_permlane32_swap_b32 v108, v124
    v_permlane32_swap_b32 v110, v125
    v_permlane32_swap_b32 v112, v126
    v_permlane32_swap_b32 v114, v127
    v_max_f32 v108, v108, v124
    v_max_f32 v110, v110, v125
    v_max_f32 v112, v112, v126
    v_max_f32 v114, v114, v127
    v_mov_b32 v124, v108
    v_mov_b32 v125, v110
    v_mov_b32 v126, v112
    v_mov_b32 v127, v114
    v_permlane16_swap_b32 v108, v124
    v_permlane16_swap_b32 v110, v125
    v_permlane16_swap_b32 v112, v126
    v_permlane16_swap_b32 v114, v127
    v_max_f32 v108, v108, v124
    v_max_f32 v110, v110, v125
    v_max_f32 v112, v112, v126
    v_max_f32 v114, v114, v127
    v_pk_add_f32 v[32:33], v[32:33], v[108:109] op_sel_hi:[1,0] neg_lo:[0,1] neg_hi:[0,1]
    v_pk_add_f32 v[34:35], v[34:35], v[108:109] op_sel_hi:[1,0] neg_lo:[0,1] neg_hi:[0,1]
    v_pk_add_f32 v[36:37], v[36:37], v[108:109] op_sel_hi:[1,0] neg_lo:[0,1] neg_hi:[0,1]
    v_pk_add_f32 v[38:39], v[38:39], v[108:109] op_sel_hi:[1,0] neg_lo:[0,1] neg_hi:[0,1]
    v_exp_f32 v32, v32
    v_exp_f32 v33, v33
    v_exp_f32 v34, v34
    v_exp_f32 v35, v35
    v_exp_f32 v36, v36
    v_exp_f32 v37, v37
    v_exp_f32 v38, v38
    v_exp_f32 v39, v39
    v_pk_add_f32 v[40:41], v[40:41], v[110:111] op_sel_hi:[1,0] neg_lo:[0,1] neg_hi:[0,1]
    v_pk_add_f32 v[42:43], v[42:43], v[110:111] op_sel_hi:[1,0] neg_lo:[0,1] neg_hi:[0,1]
    v_pk_add_f32 v[44:45], v[44:45], v[110:111] op_sel_hi:[1,0] neg_lo:[0,1] neg_hi:[0,1]
    v_pk_add_f32 v[46:47], v[46:47], v[110:111] op_sel_hi:[1,0] neg_lo:[0,1] neg_hi:[0,1]
    v_exp_f32 v40, v40
    v_exp_f32 v41, v41
    v_exp_f32 v42, v42
    v_exp_f32 v43, v43
    v_exp_f32 v44, v44
    v_exp_f32 v45, v45
    v_exp_f32 v46, v46
    v_exp_f32 v47, v47
    v_pk_add_f32 v[48:49], v[48:49], v[112:113] op_sel_hi:[1,0] neg_lo:[0,1] neg_hi:[0,1]
    v_pk_add_f32 v[50:51], v[50:51], v[112:113] op_sel_hi:[1,0] neg_lo:[0,1] neg_hi:[0,1]
    v_pk_add_f32 v[52:53], v[52:53], v[112:113] op_sel_hi:[1,0] neg_lo:[0,1] neg_hi:[0,1]
    v_pk_add_f32 v[54:55], v[54:55], v[112:113] op_sel_hi:[1,0] neg_lo:[0,1] neg_hi:[0,1]
    v_exp_f32 v48, v48
    v_exp_f32 v49, v49
    v_exp_f32 v50, v50
    v_exp_f32 v51, v51
    v_exp_f32 v52, v52
    v_exp_f32 v53, v53
    v_exp_f32 v54, v54
    v_exp_f32 v55, v55
    v_pk_add_f32 v[56:57], v[56:57], v[114:115] op_sel_hi:[1,0] neg_lo:[0,1] neg_hi:[0,1]
    v_pk_add_f32 v[58:59], v[58:59], v[114:115] op_sel_hi:[1,0] neg_lo:[0,1] neg_hi:[0,1]
    v_pk_add_f32 v[60:61], v[60:61], v[114:115] op_sel_hi:[1,0] neg_lo:[0,1] neg_hi:[0,1]
    v_pk_add_f32 v[62:63], v[62:63], v[114:115] op_sel_hi:[1,0] neg_lo:[0,1] neg_hi:[0,1]
    v_exp_f32 v56, v56
    v_exp_f32 v57, v57
    v_exp_f32 v58, v58
    v_exp_f32 v59, v59
    v_exp_f32 v60, v60
    v_exp_f32 v61, v61
    v_exp_f32 v62, v62
    v_exp_f32 v63, v63
    v_cvt_pk_bf16_f32 v80, v32, v33
    v_cvt_pk_bf16_f32 v81, v34, v35
    v_cvt_pk_bf16_f32 v82, v36, v37
    v_cvt_pk_bf16_f32 v83, v38, v39
    v_cvt_pk_bf16_f32 v84, v40, v41
    v_cvt_pk_bf16_f32 v85, v42, v43
    v_cvt_pk_bf16_f32 v86, v44, v45
    v_cvt_pk_bf16_f32 v87, v46, v47
    v_cvt_pk_bf16_f32 v88, v48, v49
    v_cvt_pk_bf16_f32 v89, v50, v51
    v_cvt_pk_bf16_f32 v90, v52, v53
    v_cvt_pk_bf16_f32 v91, v54, v55
    v_cvt_pk_bf16_f32 v92, v56, v57
    v_cvt_pk_bf16_f32 v93, v58, v59
    v_cvt_pk_bf16_f32 v94, v60, v61
    v_cvt_pk_bf16_f32 v95, v62, v63
    v_mfma_f32_16x16x16_bf16 v[64:67], v[212:213], v[80:81], 0
    v_mfma_f32_16x16x16_bf16 v[68:71], v[218:219], v[84:85], 0
    v_mfma_f32_16x16x16_bf16 v[72:75], v[214:215], v[88:89], 0
    v_mfma_f32_16x16x16_bf16 v[76:79], v[220:221], v[92:93], 0
    v_mfma_f32_16x16x16_bf16 v[64:67], v[214:215], v[82:83], v[64:67]
    v_mfma_f32_16x16x16_bf16 v[68:71], v[220:221], v[86:87], v[68:71]
    v_mfma_f32_16x16x16_bf16 v[72:75], v[216:217], v[90:91], v[72:75]
    v_mfma_f32_16x16x16_bf16 v[76:79], v[222:223], v[94:95], v[76:79]
    v_lshlrev_b32 v32, 16, v80
    v_and_b32 v33, 0xffff0000, v80
    v_lshlrev_b32 v34, 16, v81
    v_and_b32 v35, 0xffff0000, v81
    v_lshlrev_b32 v36, 16, v82
    v_and_b32 v37, 0xffff0000, v82
    v_lshlrev_b32 v38, 16, v83
    v_and_b32 v39, 0xffff0000, v83
    v_pk_add_f32 v[32:33], v[32:33], v[34:35]
    v_pk_add_f32 v[36:37], v[36:37], v[38:39]
    v_pk_add_f32 v[32:33], v[32:33], v[36:37]
    v_add_f32 v116, v32, v33
    v_lshlrev_b32 v40, 16, v84
    v_and_b32 v41, 0xffff0000, v84
    v_lshlrev_b32 v42, 16, v85
    v_and_b32 v43, 0xffff0000, v85
    v_lshlrev_b32 v44, 16, v86
    v_and_b32 v45, 0xffff0000, v86
    v_lshlrev_b32 v46, 16, v87
    v_and_b32 v47, 0xffff0000, v87
    v_pk_add_f32 v[40:41], v[40:41], v[42:43]
    v_pk_add_f32 v[44:45], v[44:45], v[46:47]
    v_pk_add_f32 v[40:41], v[40:41], v[44:45]
    v_add_f32 v118, v40, v41
    v_lshlrev_b32 v48, 16, v88
    v_and_b32 v49, 0xffff0000, v88
    v_lshlrev_b32 v50, 16, v89
    v_and_b32 v51, 0xffff0000, v89
    v_lshlrev_b32 v52, 16, v90
    v_and_b32 v53, 0xffff0000, v90
    v_lshlrev_b32 v54, 16, v91
    v_and_b32 v55, 0xffff0000, v91
    v_pk_add_f32 v[48:49], v[48:49], v[50:51]
    v_pk_add_f32 v[52:53], v[52:53], v[54:55]
    v_pk_add_f32 v[48:49], v[48:49], v[52:53]
    v_add_f32 v120, v48, v49
    v_lshlrev_b32 v56, 16, v92
    v_and_b32 v57, 0xffff0000, v92
    v_lshlrev_b32 v58, 16, v93
    v_and_b32 v59, 0xffff0000, v93
    v_lshlrev_b32 v60, 16, v94
    v_and_b32 v61, 0xffff0000, v94
    v_lshlrev_b32 v62, 16, v95
    v_and_b32 v63, 0xffff0000, v95
    v_pk_add_f32 v[56:57], v[56:57], v[58:59]
    v_pk_add_f32 v[60:61], v[60:61], v[62:63]
    v_pk_add_f32 v[56:57], v[56:57], v[60:61]
    v_add_f32 v122, v56, v57
    v_mov_b32 v124, v116
    v_mov_b32 v125, v118
    v_mov_b32 v126, v120
    v_mov_b32 v127, v122
    v_permlane32_swap_b32 v116, v124
    v_permlane32_swap_b32 v118, v125
    v_permlane32_swap_b32 v120, v126
    v_permlane32_swap_b32 v122, v127
    v_add_f32 v116, v116, v124
    v_add_f32 v118, v118, v125
    v_add_f32 v120, v120, v126
    v_add_f32 v122, v122, v127
    v_mov_b32 v124, v116
    v_mov_b32 v125, v118
    v_mov_b32 v126, v120
    v_mov_b32 v127, v122
    v_permlane16_swap_b32 v116, v124
    v_permlane16_swap_b32 v118, v125
    v_permlane16_swap_b32 v120, v126
    v_permlane16_swap_b32 v122, v127
    v_add_f32 v116, v116, v124
    v_add_f32 v118, v118, v125
    v_add_f32 v120, v120, v126
    v_add_f32 v122, v122, v127
    v_rcp_f32 v116, v116
    v_rcp_f32 v118, v118
    v_rcp_f32 v120, v120
    v_rcp_f32 v122, v122
    v_pk_mul_f32 v[64:65], v[64:65], v[116:117] op_sel_hi:[1,0]
    v_pk_mul_f32 v[66:67], v[66:67], v[116:117] op_sel_hi:[1,0]
    v_pk_mul_f32 v[68:69], v[68:69], v[118:119] op_sel_hi:[1,0]
    v_pk_mul_f32 v[70:71], v[70:71], v[118:119] op_sel_hi:[1,0]
    v_pk_mul_f32 v[72:73], v[72:73], v[120:121] op_sel_hi:[1,0]
    v_pk_mul_f32 v[74:75], v[74:75], v[120:121] op_sel_hi:[1,0]
    v_pk_mul_f32 v[76:77], v[76:77], v[122:123] op_sel_hi:[1,0]
    v_pk_mul_f32 v[78:79], v[78:79], v[122:123] op_sel_hi:[1,0]
    s_lshl_b32 s38, s29, 17
    s_lshl_b32 s39, s43, 10
    s_add_u32 s38, s38, s39
    s_add_u32 s38, s38, 32768
    s_add_u32 s39, s38, 16384
    v_cvt_pk_bf16_f32 v96, v64, v65
    v_cvt_pk_bf16_f32 v97, v66, v67
    v_cvt_pk_bf16_f32 v98, v68, v69
    v_cvt_pk_bf16_f32 v99, v70, v71
    v_cvt_pk_bf16_f32 v100, v72, v73
    v_cvt_pk_bf16_f32 v101, v74, v75
    v_cvt_pk_bf16_f32 v102, v76, v77
    v_cvt_pk_bf16_f32 v103, v78, v79
    buffer_store_dwordx4 v[96:99], v1, s[4:7], s38 offen sc1
    buffer_store_dwordx4 v[100:103], v1, s[4:7], s39 offen sc1
    s_nop 1
    s_branch L_sequential_preLN__sliding_local_dilated__geglu_ffn__prompt_kernel_p1join
L_sequential_preLN__sliding_local_dilated__geglu_ffn__prompt_kernel_w2:
L_sequential_preLN__sliding_local_dilated__geglu_ffn__prompt_kernel_cl2_0:
    ds_read_b32 v17, v18 offset:0
    s_waitcnt lgkmcnt(0)
    v_readfirstlane_b32 s40, v17
    s_nop 1
    s_cmp_lt_u32 s40, 4
    s_cbranch_scc1 L_sequential_preLN__sliding_local_dilated__geglu_ffn__prompt_kernel_cl2_0
L_sequential_preLN__sliding_local_dilated__geglu_ffn__prompt_kernel_cl2_0x:
    ds_read_b128 v[156:159], v20 offset:0
    ds_read_b128 v[160:163], v20 offset:2048
    ds_read_b64_tr_b16 v[108:109], v26 offset:0
    ds_read_b64_tr_b16 v[110:111], v26 offset:768
    ds_read_b64_tr_b16 v[112:113], v27 offset:0
    ds_read_b64_tr_b16 v[114:115], v27 offset:768
    ds_read_b64_tr_b16 v[116:117], v28 offset:0
    ds_read_b64_tr_b16 v[118:119], v28 offset:768
    ds_read_b64_tr_b16 v[120:121], v29 offset:0
    ds_read_b64_tr_b16 v[122:123], v29 offset:768
    ds_read_b64_tr_b16 v[124:125], v30 offset:0
    ds_read_b64_tr_b16 v[126:127], v30 offset:768
    ds_read_b64_tr_b16 v[128:129], v31 offset:0
    ds_read_b64_tr_b16 v[130:131], v31 offset:768
    ds_read_b128 v[164:167], v22 offset:0
    s_waitcnt lgkmcnt(0)
    v_mfma_f32_16x16x32_bf16 v[32:35], v[108:111], v[156:159], v[32:35]
    v_mfma_f32_16x16x32_bf16 v[40:43], v[112:115], v[156:159], v[40:43]
    v_mfma_f32_16x16x32_bf16 v[48:51], v[116:119], v[156:159], v[48:51]
    ds_read_b128 v[168:171], v21 offset:0
    ds_read_b128 v[172:175], v21 offset:2048
    v_mfma_f32_16x16x32_bf16 v[56:59], v[120:123], v[156:159], v[56:59]
    ds_read_b64_tr_b16 v[132:133], v26 offset:6144
    v_mfma_f32_16x16x32_bf16 v[64:67], v[156:159], v[124:127], v[64:67]
    ds_read_b64_tr_b16 v[134:135], v26 offset:6912
    ds_read_b64_tr_b16 v[136:137], v27 offset:6144
    v_mfma_f32_16x16x32_bf16 v[72:75], v[156:159], v[128:131], v[72:75]
    ds_read_b64_tr_b16 v[138:139], v27 offset:6912
    v_mfma_f32_16x16x32_bf16 v[80:83], v[104:107], v[156:159], v[80:83]
    ds_read_b64_tr_b16 v[140:141], v28 offset:6144
    ds_read_b64_tr_b16 v[142:143], v28 offset:6912
    v_mfma_f32_16x16x32_bf16 v[88:91], v[156:159], v[156:159], v[88:91]
    ds_read_b64_tr_b16 v[144:145], v29 offset:6144
    v_mfma_f32_16x16x32_bf16 v[36:39], v[108:111], v[160:163], v[36:39]
    ds_read_b64_tr_b16 v[146:147], v29 offset:6912
    ds_read_b64_tr_b16 v[148:149], v30 offset:6144
    v_mfma_f32_16x16x32_bf16 v[44:47], v[112:115], v[160:163], v[44:47]
    ds_read_b64_tr_b16 v[150:151], v30 offset:6912
    v_mfma_f32_16x16x32_bf16 v[52:55], v[116:119], v[160:163], v[52:55]
    ds_read_b64_tr_b16 v[152:153], v31 offset:6144
    ds_read_b64_tr_b16 v[154:155], v31 offset:6912
    v_mfma_f32_16x16x32_bf16 v[60:63], v[120:123], v[160:163], v[60:63]
    ds_read_b128 v[176:179], v23 offset:0
    v_mfma_f32_16x16x32_bf16 v[68:71], v[160:163], v[124:127], v[68:71]
    ds_read_b32 v17, v18 offset:4
    v_cndmask_b32 v164, v164, v104, s[56:57]
    v_mfma_f32_16x16x32_bf16 v[76:79], v[160:163], v[128:131], v[76:79]
    v_cndmask_b32 v165, v165, v104, s[56:57]
    v_mfma_f32_16x16x32_bf16 v[84:87], v[104:107], v[160:163], v[84:87]
    v_cndmask_b32 v166, v166, v104, s[56:57]
    v_mfma_f32_16x16x32_bf16 v[92:95], v[160:163], v[160:163], v[92:95]
    v_cndmask_b32 v167, v167, v104, s[56:57]
    s_nop 1
    v_mfma_f32_16x16x32_bf16 v[96:99], v[164:167], v[124:127], v[96:99]
    v_mfma_f32_16x16x32_bf16 v[100:103], v[164:167], v[128:131], v[100:103]
    s_waitcnt lgkmcnt(0)
    v_mfma_f32_16x16x32_bf16 v[32:35], v[132:135], v[168:171], v[32:35]
    v_mfma_f32_16x16x32_bf16 v[40:43], v[136:139], v[168:171], v[40:43]
    s_mov_b64 exec, 1
    ds_add_u32 v18, v19 offset:32
    s_mov_b64 exec, -1
    v_readfirstlane_b32 s40, v17
    s_nop 1
    s_cmp_ge_u32 s40, 4
    s_cbranch_scc1 L_sequential_preLN__sliding_local_dilated__geglu_ffn__prompt_kernel_cl2_1x
L_sequential_preLN__sliding_local_dilated__geglu_ffn__prompt_kernel_cl2_1:
    ds_read_b32 v17, v18 offset:4
    s_waitcnt lgkmcnt(0)
    v_readfirstlane_b32 s40, v17
    s_nop 1
    s_cmp_lt_u32 s40, 4
    s_cbranch_scc1 L_sequential_preLN__sliding_local_dilated__geglu_ffn__prompt_kernel_cl2_1
L_sequential_preLN__sliding_local_dilated__geglu_ffn__prompt_kernel_cl2_1x:
    v_mfma_f32_16x16x32_bf16 v[48:51], v[140:143], v[168:171], v[48:51]
    ds_read_b128 v[156:159], v20 offset:28672
    ds_read_b128 v[160:163], v20 offset:30720
    v_mfma_f32_16x16x32_bf16 v[56:59], v[144:147], v[168:171], v[56:59]
    ds_read_b64_tr_b16 v[108:109], v26 offset:28672
    v_mfma_f32_16x16x32_bf16 v[64:67], v[168:171], v[148:151], v[64:67]
    ds_read_b64_tr_b16 v[110:111], v26 offset:29440
    ds_read_b64_tr_b16 v[112:113], v27 offset:28672
    v_mfma_f32_16x16x32_bf16 v[72:75], v[168:171], v[152:155], v[72:75]
    ds_read_b64_tr_b16 v[114:115], v27 offset:29440
    v_mfma_f32_16x16x32_bf16 v[80:83], v[104:107], v[168:171], v[80:83]
    ds_read_b64_tr_b16 v[116:117], v28 offset:28672
    ds_read_b64_tr_b16 v[118:119], v28 offset:29440
    v_mfma_f32_16x16x32_bf16 v[88:91], v[168:171], v[168:171], v[88:91]
    ds_read_b64_tr_b16 v[120:121], v29 offset:28672
    v_mfma_f32_16x16x32_bf16 v[36:39], v[132:135], v[172:175], v[36:39]
    ds_read_b64_tr_b16 v[122:123], v29 offset:29440
    ds_read_b64_tr_b16 v[124:125], v30 offset:28672
    v_mfma_f32_16x16x32_bf16 v[44:47], v[136:139], v[172:175], v[44:47]
    ds_read_b64_tr_b16 v[126:127], v30 offset:29440
    v_mfma_f32_16x16x32_bf16 v[52:55], v[140:143], v[172:175], v[52:55]
    ds_read_b64_tr_b16 v[128:129], v31 offset:28672
    ds_read_b64_tr_b16 v[130:131], v31 offset:29440
    v_mfma_f32_16x16x32_bf16 v[60:63], v[144:147], v[172:175], v[60:63]
    ds_read_b128 v[164:167], v24 offset:0
    v_mfma_f32_16x16x32_bf16 v[68:71], v[172:175], v[148:151], v[68:71]
    v_cndmask_b32 v176, v176, v104, s[56:57]
    v_mfma_f32_16x16x32_bf16 v[76:79], v[172:175], v[152:155], v[76:79]
    v_cndmask_b32 v177, v177, v104, s[56:57]
    v_mfma_f32_16x16x32_bf16 v[84:87], v[104:107], v[172:175], v[84:87]
    v_cndmask_b32 v178, v178, v104, s[56:57]
    v_mfma_f32_16x16x32_bf16 v[92:95], v[172:175], v[172:175], v[92:95]
    v_cndmask_b32 v179, v179, v104, s[56:57]
    s_nop 1
    v_mfma_f32_16x16x32_bf16 v[96:99], v[176:179], v[148:151], v[96:99]
    v_mfma_f32_16x16x32_bf16 v[100:103], v[176:179], v[152:155], v[100:103]
    s_waitcnt lgkmcnt(0)
    v_mfma_f32_16x16x32_bf16 v[32:35], v[108:111], v[156:159], v[32:35]
    v_mfma_f32_16x16x32_bf16 v[40:43], v[112:115], v[156:159], v[40:43]
    v_mfma_f32_16x16x32_bf16 v[48:51], v[116:119], v[156:159], v[48:51]
    ds_read_b128 v[168:171], v21 offset:28672
    ds_read_b128 v[172:175], v21 offset:30720
    v_mfma_f32_16x16x32_bf16 v[56:59], v[120:123], v[156:159], v[56:59]
    ds_read_b64_tr_b16 v[132:133], v26 offset:34816
    v_mfma_f32_16x16x32_bf16 v[64:67], v[156:159], v[124:127], v[64:67]
    ds_read_b64_tr_b16 v[134:135], v26 offset:35584
    ds_read_b64_tr_b16 v[136:137], v27 offset:34816
    v_mfma_f32_16x16x32_bf16 v[72:75], v[156:159], v[128:131], v[72:75]
    ds_read_b64_tr_b16 v[138:139], v27 offset:35584
    v_mfma_f32_16x16x32_bf16 v[80:83], v[104:107], v[156:159], v[80:83]
    ds_read_b64_tr_b16 v[140:141], v28 offset:34816
    ds_read_b64_tr_b16 v[142:143], v28 offset:35584
    v_mfma_f32_16x16x32_bf16 v[88:91], v[156:159], v[156:159], v[88:91]
    ds_read_b64_tr_b16 v[144:145], v29 offset:34816
    v_mfma_f32_16x16x32_bf16 v[36:39], v[108:111], v[160:163], v[36:39]
    ds_read_b64_tr_b16 v[146:147], v29 offset:35584
    ds_read_b64_tr_b16 v[148:149], v30 offset:34816
    v_mfma_f32_16x16x32_bf16 v[44:47], v[112:115], v[160:163], v[44:47]
    ds_read_b64_tr_b16 v[150:151], v30 offset:35584
    v_mfma_f32_16x16x32_bf16 v[52:55], v[116:119], v[160:163], v[52:55]
    ds_read_b64_tr_b16 v[152:153], v31 offset:34816
    ds_read_b64_tr_b16 v[154:155], v31 offset:35584
    v_mfma_f32_16x16x32_bf16 v[60:63], v[120:123], v[160:163], v[60:63]
    ds_read_b128 v[176:179], v25 offset:0
    v_mfma_f32_16x16x32_bf16 v[68:71], v[160:163], v[124:127], v[68:71]
    ds_read_b32 v17, v18 offset:8
    v_cndmask_b32 v164, v164, v104, s[56:57]
    v_mfma_f32_16x16x32_bf16 v[76:79], v[160:163], v[128:131], v[76:79]
    v_cndmask_b32 v165, v165, v104, s[56:57]
    v_mfma_f32_16x16x32_bf16 v[84:87], v[104:107], v[160:163], v[84:87]
    v_cndmask_b32 v166, v166, v104, s[56:57]
    v_mfma_f32_16x16x32_bf16 v[92:95], v[160:163], v[160:163], v[92:95]
    v_cndmask_b32 v167, v167, v104, s[56:57]
    s_nop 1
    v_mfma_f32_16x16x32_bf16 v[96:99], v[164:167], v[124:127], v[96:99]
    v_mfma_f32_16x16x32_bf16 v[100:103], v[164:167], v[128:131], v[100:103]
    s_waitcnt lgkmcnt(0)
    v_mfma_f32_16x16x32_bf16 v[32:35], v[132:135], v[168:171], v[32:35]
    v_mfma_f32_16x16x32_bf16 v[40:43], v[136:139], v[168:171], v[40:43]
    s_mov_b64 exec, 1
    ds_add_u32 v18, v19 offset:36
    s_mov_b64 exec, -1
    v_readfirstlane_b32 s40, v17
    s_nop 1
    s_cmp_ge_u32 s40, 4
    s_cbranch_scc1 L_sequential_preLN__sliding_local_dilated__geglu_ffn__prompt_kernel_cl2_2x
L_sequential_preLN__sliding_local_dilated__geglu_ffn__prompt_kernel_cl2_2:
    ds_read_b32 v17, v18 offset:8
    s_waitcnt lgkmcnt(0)
    v_readfirstlane_b32 s40, v17
    s_nop 1
    s_cmp_lt_u32 s40, 4
    s_cbranch_scc1 L_sequential_preLN__sliding_local_dilated__geglu_ffn__prompt_kernel_cl2_2
L_sequential_preLN__sliding_local_dilated__geglu_ffn__prompt_kernel_cl2_2x:
    v_mfma_f32_16x16x32_bf16 v[48:51], v[140:143], v[168:171], v[48:51]
    ds_read_b128 v[156:159], v252 offset:0
    ds_read_b128 v[160:163], v252 offset:2048
    v_mfma_f32_16x16x32_bf16 v[56:59], v[144:147], v[168:171], v[56:59]
    ds_read_b64_tr_b16 v[108:109], v240 offset:0
    v_mfma_f32_16x16x32_bf16 v[64:67], v[168:171], v[148:151], v[64:67]
    ds_read_b64_tr_b16 v[110:111], v240 offset:768
    ds_read_b64_tr_b16 v[112:113], v241 offset:0
    v_mfma_f32_16x16x32_bf16 v[72:75], v[168:171], v[152:155], v[72:75]
    ds_read_b64_tr_b16 v[114:115], v241 offset:768
    v_mfma_f32_16x16x32_bf16 v[80:83], v[104:107], v[168:171], v[80:83]
    ds_read_b64_tr_b16 v[116:117], v242 offset:0
    ds_read_b64_tr_b16 v[118:119], v242 offset:768
    v_mfma_f32_16x16x32_bf16 v[88:91], v[168:171], v[168:171], v[88:91]
    ds_read_b64_tr_b16 v[120:121], v243 offset:0
    v_mfma_f32_16x16x32_bf16 v[36:39], v[132:135], v[172:175], v[36:39]
    ds_read_b64_tr_b16 v[122:123], v243 offset:768
    ds_read_b64_tr_b16 v[124:125], v244 offset:0
    v_mfma_f32_16x16x32_bf16 v[44:47], v[136:139], v[172:175], v[44:47]
    ds_read_b64_tr_b16 v[126:127], v244 offset:768
    v_mfma_f32_16x16x32_bf16 v[52:55], v[140:143], v[172:175], v[52:55]
    ds_read_b64_tr_b16 v[128:129], v245 offset:0
    ds_read_b64_tr_b16 v[130:131], v245 offset:768
    v_mfma_f32_16x16x32_bf16 v[60:63], v[144:147], v[172:175], v[60:63]
    ds_read_b128 v[164:167], v22 offset:256
    v_mfma_f32_16x16x32_bf16 v[68:71], v[172:175], v[148:151], v[68:71]
    v_cndmask_b32 v176, v176, v104, s[56:57]
    v_mfma_f32_16x16x32_bf16 v[76:79], v[172:175], v[152:155], v[76:79]
    v_cndmask_b32 v177, v177, v104, s[56:57]
    v_mfma_f32_16x16x32_bf16 v[84:87], v[104:107], v[172:175], v[84:87]
    v_cndmask_b32 v178, v178, v104, s[56:57]
    v_mfma_f32_16x16x32_bf16 v[92:95], v[172:175], v[172:175], v[92:95]
    v_cndmask_b32 v179, v179, v104, s[56:57]
    s_nop 1
    v_mfma_f32_16x16x32_bf16 v[96:99], v[176:179], v[148:151], v[96:99]
    v_mfma_f32_16x16x32_bf16 v[100:103], v[176:179], v[152:155], v[100:103]
    s_waitcnt lgkmcnt(0)
    v_mfma_f32_16x16x32_bf16 v[32:35], v[108:111], v[156:159], v[32:35]
    v_mfma_f32_16x16x32_bf16 v[40:43], v[112:115], v[156:159], v[40:43]
    v_mfma_f32_16x16x32_bf16 v[48:51], v[116:119], v[156:159], v[48:51]
    ds_read_b128 v[168:171], v253 offset:0
    ds_read_b128 v[172:175], v253 offset:2048
    v_mfma_f32_16x16x32_bf16 v[56:59], v[120:123], v[156:159], v[56:59]
    ds_read_b64_tr_b16 v[132:133], v240 offset:6144
    v_mfma_f32_16x16x32_bf16 v[64:67], v[156:159], v[124:127], v[64:67]
    ds_read_b64_tr_b16 v[134:135], v240 offset:6912
    ds_read_b64_tr_b16 v[136:137], v241 offset:6144
    v_mfma_f32_16x16x32_bf16 v[72:75], v[156:159], v[128:131], v[72:75]
    ds_read_b64_tr_b16 v[138:139], v241 offset:6912
    v_mfma_f32_16x16x32_bf16 v[80:83], v[104:107], v[156:159], v[80:83]
    ds_read_b64_tr_b16 v[140:141], v242 offset:6144
    ds_read_b64_tr_b16 v[142:143], v242 offset:6912
    v_mfma_f32_16x16x32_bf16 v[88:91], v[156:159], v[156:159], v[88:91]
    ds_read_b64_tr_b16 v[144:145], v243 offset:6144
    v_mfma_f32_16x16x32_bf16 v[36:39], v[108:111], v[160:163], v[36:39]
    ds_read_b64_tr_b16 v[146:147], v243 offset:6912
    ds_read_b64_tr_b16 v[148:149], v244 offset:6144
    v_mfma_f32_16x16x32_bf16 v[44:47], v[112:115], v[160:163], v[44:47]
    ds_read_b64_tr_b16 v[150:151], v244 offset:6912
    v_mfma_f32_16x16x32_bf16 v[52:55], v[116:119], v[160:163], v[52:55]
    ds_read_b64_tr_b16 v[152:153], v245 offset:6144
    ds_read_b64_tr_b16 v[154:155], v245 offset:6912
    v_mfma_f32_16x16x32_bf16 v[60:63], v[120:123], v[160:163], v[60:63]
    ds_read_b128 v[176:179], v23 offset:256
    v_mfma_f32_16x16x32_bf16 v[68:71], v[160:163], v[124:127], v[68:71]
    ds_read_b32 v17, v18 offset:12
    v_cndmask_b32 v164, v164, v104, s[56:57]
    v_mfma_f32_16x16x32_bf16 v[76:79], v[160:163], v[128:131], v[76:79]
    v_cndmask_b32 v165, v165, v104, s[56:57]
    v_mfma_f32_16x16x32_bf16 v[84:87], v[104:107], v[160:163], v[84:87]
    v_cndmask_b32 v166, v166, v104, s[56:57]
    v_mfma_f32_16x16x32_bf16 v[92:95], v[160:163], v[160:163], v[92:95]
    v_cndmask_b32 v167, v167, v104, s[56:57]
    s_nop 1
    v_mfma_f32_16x16x32_bf16 v[96:99], v[164:167], v[124:127], v[96:99]
    v_mfma_f32_16x16x32_bf16 v[100:103], v[164:167], v[128:131], v[100:103]
    s_waitcnt lgkmcnt(0)
    v_mfma_f32_16x16x32_bf16 v[32:35], v[132:135], v[168:171], v[32:35]
    v_mfma_f32_16x16x32_bf16 v[40:43], v[136:139], v[168:171], v[40:43]
    s_mov_b64 exec, 1
    ds_add_u32 v18, v19 offset:40
    s_mov_b64 exec, -1
    v_readfirstlane_b32 s40, v17
    s_nop 1
    s_cmp_ge_u32 s40, 4
    s_cbranch_scc1 L_sequential_preLN__sliding_local_dilated__geglu_ffn__prompt_kernel_cl2_3x
L_sequential_preLN__sliding_local_dilated__geglu_ffn__prompt_kernel_cl2_3:
    ds_read_b32 v17, v18 offset:12
    s_waitcnt lgkmcnt(0)
    v_readfirstlane_b32 s40, v17
    s_nop 1
    s_cmp_lt_u32 s40, 4
    s_cbranch_scc1 L_sequential_preLN__sliding_local_dilated__geglu_ffn__prompt_kernel_cl2_3
L_sequential_preLN__sliding_local_dilated__geglu_ffn__prompt_kernel_cl2_3x:
    v_mfma_f32_16x16x32_bf16 v[48:51], v[140:143], v[168:171], v[48:51]
    ds_read_b128 v[156:159], v252 offset:28672
    ds_read_b128 v[160:163], v252 offset:30720
    v_mfma_f32_16x16x32_bf16 v[56:59], v[144:147], v[168:171], v[56:59]
    ds_read_b64_tr_b16 v[108:109], v240 offset:28672
    v_mfma_f32_16x16x32_bf16 v[64:67], v[168:171], v[148:151], v[64:67]
    ds_read_b64_tr_b16 v[110:111], v240 offset:29440
    ds_read_b64_tr_b16 v[112:113], v241 offset:28672
    v_mfma_f32_16x16x32_bf16 v[72:75], v[168:171], v[152:155], v[72:75]
    ds_read_b64_tr_b16 v[114:115], v241 offset:29440
    v_mfma_f32_16x16x32_bf16 v[80:83], v[104:107], v[168:171], v[80:83]
    ds_read_b64_tr_b16 v[116:117], v242 offset:28672
    ds_read_b64_tr_b16 v[118:119], v242 offset:29440
    v_mfma_f32_16x16x32_bf16 v[88:91], v[168:171], v[168:171], v[88:91]
    ds_read_b64_tr_b16 v[120:121], v243 offset:28672
    v_mfma_f32_16x16x32_bf16 v[36:39], v[132:135], v[172:175], v[36:39]
    ds_read_b64_tr_b16 v[122:123], v243 offset:29440
    ds_read_b64_tr_b16 v[124:125], v244 offset:28672
    v_mfma_f32_16x16x32_bf16 v[44:47], v[136:139], v[172:175], v[44:47]
    ds_read_b64_tr_b16 v[126:127], v244 offset:29440
    v_mfma_f32_16x16x32_bf16 v[52:55], v[140:143], v[172:175], v[52:55]
    ds_read_b64_tr_b16 v[128:129], v245 offset:28672
    ds_read_b64_tr_b16 v[130:131], v245 offset:29440
    v_mfma_f32_16x16x32_bf16 v[60:63], v[144:147], v[172:175], v[60:63]
    ds_read_b128 v[164:167], v24 offset:256
    v_mfma_f32_16x16x32_bf16 v[68:71], v[172:175], v[148:151], v[68:71]
    v_cndmask_b32 v176, v176, v104, s[56:57]
    v_mfma_f32_16x16x32_bf16 v[76:79], v[172:175], v[152:155], v[76:79]
    v_cndmask_b32 v177, v177, v104, s[56:57]
    v_mfma_f32_16x16x32_bf16 v[84:87], v[104:107], v[172:175], v[84:87]
    v_cndmask_b32 v178, v178, v104, s[56:57]
    v_mfma_f32_16x16x32_bf16 v[92:95], v[172:175], v[172:175], v[92:95]
    v_cndmask_b32 v179, v179, v104, s[56:57]
    s_nop 1
    v_mfma_f32_16x16x32_bf16 v[96:99], v[176:179], v[148:151], v[96:99]
    v_mfma_f32_16x16x32_bf16 v[100:103], v[176:179], v[152:155], v[100:103]
    s_waitcnt lgkmcnt(0)
    v_mfma_f32_16x16x32_bf16 v[32:35], v[108:111], v[156:159], v[32:35]
    v_mfma_f32_16x16x32_bf16 v[40:43], v[112:115], v[156:159], v[40:43]
    v_mfma_f32_16x16x32_bf16 v[48:51], v[116:119], v[156:159], v[48:51]
    ds_read_b128 v[168:171], v253 offset:28672
    ds_read_b128 v[172:175], v253 offset:30720
    v_mfma_f32_16x16x32_bf16 v[56:59], v[120:123], v[156:159], v[56:59]
    ds_read_b64_tr_b16 v[132:133], v240 offset:34816
    v_mfma_f32_16x16x32_bf16 v[64:67], v[156:159], v[124:127], v[64:67]
    ds_read_b64_tr_b16 v[134:135], v240 offset:35584
    ds_read_b64_tr_b16 v[136:137], v241 offset:34816
    v_mfma_f32_16x16x32_bf16 v[72:75], v[156:159], v[128:131], v[72:75]
    ds_read_b64_tr_b16 v[138:139], v241 offset:35584
    v_mfma_f32_16x16x32_bf16 v[80:83], v[104:107], v[156:159], v[80:83]
    ds_read_b64_tr_b16 v[140:141], v242 offset:34816
    ds_read_b64_tr_b16 v[142:143], v242 offset:35584
    v_mfma_f32_16x16x32_bf16 v[88:91], v[156:159], v[156:159], v[88:91]
    ds_read_b64_tr_b16 v[144:145], v243 offset:34816
    v_mfma_f32_16x16x32_bf16 v[36:39], v[108:111], v[160:163], v[36:39]
    ds_read_b64_tr_b16 v[146:147], v243 offset:35584
    ds_read_b64_tr_b16 v[148:149], v244 offset:34816
    v_mfma_f32_16x16x32_bf16 v[44:47], v[112:115], v[160:163], v[44:47]
    ds_read_b64_tr_b16 v[150:151], v244 offset:35584
    v_mfma_f32_16x16x32_bf16 v[52:55], v[116:119], v[160:163], v[52:55]
    ds_read_b64_tr_b16 v[152:153], v245 offset:34816
    ds_read_b64_tr_b16 v[154:155], v245 offset:35584
    v_mfma_f32_16x16x32_bf16 v[60:63], v[120:123], v[160:163], v[60:63]
    ds_read_b128 v[176:179], v25 offset:256
    v_mfma_f32_16x16x32_bf16 v[68:71], v[160:163], v[124:127], v[68:71]
    ds_read_b32 v17, v18 offset:16
    v_cndmask_b32 v164, v164, v104, s[56:57]
    v_mfma_f32_16x16x32_bf16 v[76:79], v[160:163], v[128:131], v[76:79]
    v_cndmask_b32 v165, v165, v104, s[56:57]
    v_mfma_f32_16x16x32_bf16 v[84:87], v[104:107], v[160:163], v[84:87]
    v_cndmask_b32 v166, v166, v104, s[56:57]
    v_mfma_f32_16x16x32_bf16 v[92:95], v[160:163], v[160:163], v[92:95]
    v_cndmask_b32 v167, v167, v104, s[56:57]
    s_nop 1
    v_mfma_f32_16x16x32_bf16 v[96:99], v[164:167], v[124:127], v[96:99]
    v_mfma_f32_16x16x32_bf16 v[100:103], v[164:167], v[128:131], v[100:103]
    s_waitcnt lgkmcnt(0)
    v_mfma_f32_16x16x32_bf16 v[32:35], v[132:135], v[168:171], v[32:35]
    v_mfma_f32_16x16x32_bf16 v[40:43], v[136:139], v[168:171], v[40:43]
    v_readfirstlane_b32 s40, v17
    s_nop 1
    s_cmp_ge_u32 s40, 4
    s_cbranch_scc1 L_sequential_preLN__sliding_local_dilated__geglu_ffn__prompt_kernel_cl2_4x
L_sequential_preLN__sliding_local_dilated__geglu_ffn__prompt_kernel_cl2_4:
    ds_read_b32 v17, v18 offset:16
    s_waitcnt lgkmcnt(0)
    v_readfirstlane_b32 s40, v17
    s_nop 1
    s_cmp_lt_u32 s40, 4
    s_cbranch_scc1 L_sequential_preLN__sliding_local_dilated__geglu_ffn__prompt_kernel_cl2_4
L_sequential_preLN__sliding_local_dilated__geglu_ffn__prompt_kernel_cl2_4x:
    v_mfma_f32_16x16x32_bf16 v[48:51], v[140:143], v[168:171], v[48:51]
    ds_read_b128 v[156:159], v254 offset:0
    ds_read_b128 v[160:163], v254 offset:2048
    v_mfma_f32_16x16x32_bf16 v[56:59], v[144:147], v[168:171], v[56:59]
    ds_read_b64_tr_b16 v[108:109], v246 offset:0
    v_mfma_f32_16x16x32_bf16 v[64:67], v[168:171], v[148:151], v[64:67]
    ds_read_b64_tr_b16 v[110:111], v246 offset:768
    ds_read_b64_tr_b16 v[112:113], v247 offset:0
    v_mfma_f32_16x16x32_bf16 v[72:75], v[168:171], v[152:155], v[72:75]
    ds_read_b64_tr_b16 v[114:115], v247 offset:768
    v_mfma_f32_16x16x32_bf16 v[80:83], v[104:107], v[168:171], v[80:83]
    ds_read_b64_tr_b16 v[116:117], v248 offset:0
    ds_read_b64_tr_b16 v[118:119], v248 offset:768
    v_mfma_f32_16x16x32_bf16 v[88:91], v[168:171], v[168:171], v[88:91]
    ds_read_b64_tr_b16 v[120:121], v249 offset:0
    v_mfma_f32_16x16x32_bf16 v[36:39], v[132:135], v[172:175], v[36:39]
    ds_read_b64_tr_b16 v[122:123], v249 offset:768
    ds_read_b64_tr_b16 v[124:125], v250 offset:0
    v_mfma_f32_16x16x32_bf16 v[44:47], v[136:139], v[172:175], v[44:47]
    ds_read_b64_tr_b16 v[126:127], v250 offset:768
    v_mfma_f32_16x16x32_bf16 v[52:55], v[140:143], v[172:175], v[52:55]
    ds_read_b64_tr_b16 v[128:129], v251 offset:0
    ds_read_b64_tr_b16 v[130:131], v251 offset:768
    v_mfma_f32_16x16x32_bf16 v[60:63], v[144:147], v[172:175], v[60:63]
    ds_read_b128 v[164:167], v22 offset:512
    v_mfma_f32_16x16x32_bf16 v[68:71], v[172:175], v[148:151], v[68:71]
    v_cndmask_b32 v176, v176, v104, s[56:57]
    v_mfma_f32_16x16x32_bf16 v[76:79], v[172:175], v[152:155], v[76:79]
    v_cndmask_b32 v177, v177, v104, s[56:57]
    v_mfma_f32_16x16x32_bf16 v[84:87], v[104:107], v[172:175], v[84:87]
    v_cndmask_b32 v178, v178, v104, s[56:57]
    v_mfma_f32_16x16x32_bf16 v[92:95], v[172:175], v[172:175], v[92:95]
    v_cndmask_b32 v179, v179, v104, s[56:57]
    s_nop 1
    v_mfma_f32_16x16x32_bf16 v[96:99], v[176:179], v[148:151], v[96:99]
    v_mfma_f32_16x16x32_bf16 v[100:103], v[176:179], v[152:155], v[100:103]
    s_waitcnt lgkmcnt(0)
    v_mfma_f32_16x16x32_bf16 v[32:35], v[108:111], v[156:159], v[32:35]
    v_mfma_f32_16x16x32_bf16 v[40:43], v[112:115], v[156:159], v[40:43]
    v_mfma_f32_16x16x32_bf16 v[48:51], v[116:119], v[156:159], v[48:51]
    ds_read_b128 v[168:171], v255 offset:0
    ds_read_b128 v[172:175], v255 offset:2048
    v_mfma_f32_16x16x32_bf16 v[56:59], v[120:123], v[156:159], v[56:59]
    ds_read_b64_tr_b16 v[132:133], v246 offset:6144
    v_mfma_f32_16x16x32_bf16 v[64:67], v[156:159], v[124:127], v[64:67]
    ds_read_b64_tr_b16 v[134:135], v246 offset:6912
    ds_read_b64_tr_b16 v[136:137], v247 offset:6144
    v_mfma_f32_16x16x32_bf16 v[72:75], v[156:159], v[128:131], v[72:75]
    ds_read_b64_tr_b16 v[138:139], v247 offset:6912
    v_mfma_f32_16x16x32_bf16 v[80:83], v[104:107], v[156:159], v[80:83]
    ds_read_b64_tr_b16 v[140:141], v248 offset:6144
    ds_read_b64_tr_b16 v[142:143], v248 offset:6912
    v_mfma_f32_16x16x32_bf16 v[88:91], v[156:159], v[156:159], v[88:91]
    ds_read_b64_tr_b16 v[144:145], v249 offset:6144
    v_mfma_f32_16x16x32_bf16 v[36:39], v[108:111], v[160:163], v[36:39]
    ds_read_b64_tr_b16 v[146:147], v249 offset:6912
    ds_read_b64_tr_b16 v[148:149], v250 offset:6144
    v_mfma_f32_16x16x32_bf16 v[44:47], v[112:115], v[160:163], v[44:47]
    ds_read_b64_tr_b16 v[150:151], v250 offset:6912
    v_mfma_f32_16x16x32_bf16 v[52:55], v[116:119], v[160:163], v[52:55]
    ds_read_b64_tr_b16 v[152:153], v251 offset:6144
    ds_read_b64_tr_b16 v[154:155], v251 offset:6912
    v_mfma_f32_16x16x32_bf16 v[60:63], v[120:123], v[160:163], v[60:63]
    ds_read_b128 v[176:179], v23 offset:512
    v_mfma_f32_16x16x32_bf16 v[68:71], v[160:163], v[124:127], v[68:71]
    ds_read_b32 v17, v18 offset:20
    v_cndmask_b32 v164, v164, v104, s[56:57]
    v_mfma_f32_16x16x32_bf16 v[76:79], v[160:163], v[128:131], v[76:79]
    v_cndmask_b32 v165, v165, v104, s[56:57]
    v_mfma_f32_16x16x32_bf16 v[84:87], v[104:107], v[160:163], v[84:87]
    v_cndmask_b32 v166, v166, v104, s[56:57]
    v_mfma_f32_16x16x32_bf16 v[92:95], v[160:163], v[160:163], v[92:95]
    v_cndmask_b32 v167, v167, v104, s[56:57]
    s_nop 1
    v_mfma_f32_16x16x32_bf16 v[96:99], v[164:167], v[124:127], v[96:99]
    v_mfma_f32_16x16x32_bf16 v[100:103], v[164:167], v[128:131], v[100:103]
    s_waitcnt lgkmcnt(0)
    v_mfma_f32_16x16x32_bf16 v[32:35], v[132:135], v[168:171], v[32:35]
    v_mfma_f32_16x16x32_bf16 v[40:43], v[136:139], v[168:171], v[40:43]
    s_mov_b64 exec, 1
    ds_add_u32 v18, v19 offset:48
    s_mov_b64 exec, -1
    v_readfirstlane_b32 s40, v17
    s_nop 1
    s_cmp_ge_u32 s40, 4
    s_cbranch_scc1 L_sequential_preLN__sliding_local_dilated__geglu_ffn__prompt_kernel_cl2_5x
L_sequential_preLN__sliding_local_dilated__geglu_ffn__prompt_kernel_cl2_5:
    ds_read_b32 v17, v18 offset:20
    s_waitcnt lgkmcnt(0)
    v_readfirstlane_b32 s40, v17
    s_nop 1
    s_cmp_lt_u32 s40, 4
    s_cbranch_scc1 L_sequential_preLN__sliding_local_dilated__geglu_ffn__prompt_kernel_cl2_5
L_sequential_preLN__sliding_local_dilated__geglu_ffn__prompt_kernel_cl2_5x:
    v_mfma_f32_16x16x32_bf16 v[48:51], v[140:143], v[168:171], v[48:51]
    ds_read_b128 v[156:159], v20 offset:0
    ds_read_b128 v[160:163], v20 offset:2048
    v_mfma_f32_16x16x32_bf16 v[56:59], v[144:147], v[168:171], v[56:59]
    ds_read_b64_tr_b16 v[108:109], v26 offset:0
    v_mfma_f32_16x16x32_bf16 v[64:67], v[168:171], v[148:151], v[64:67]
    ds_read_b64_tr_b16 v[110:111], v26 offset:768
    ds_read_b64_tr_b16 v[112:113], v27 offset:0
    v_mfma_f32_16x16x32_bf16 v[72:75], v[168:171], v[152:155], v[72:75]
    ds_read_b64_tr_b16 v[114:115], v27 offset:768
    v_mfma_f32_16x16x32_bf16 v[80:83], v[104:107], v[168:171], v[80:83]
    ds_read_b64_tr_b16 v[116:117], v28 offset:0
    ds_read_b64_tr_b16 v[118:119], v28 offset:768
    v_mfma_f32_16x16x32_bf16 v[88:91], v[168:171], v[168:171], v[88:91]
    ds_read_b64_tr_b16 v[120:121], v29 offset:0
    v_mfma_f32_16x16x32_bf16 v[36:39], v[132:135], v[172:175], v[36:39]
    ds_read_b64_tr_b16 v[122:123], v29 offset:768
    ds_read_b64_tr_b16 v[124:125], v30 offset:0
    v_mfma_f32_16x16x32_bf16 v[44:47], v[136:139], v[172:175], v[44:47]
    ds_read_b64_tr_b16 v[126:127], v30 offset:768
    v_mfma_f32_16x16x32_bf16 v[52:55], v[140:143], v[172:175], v[52:55]
    ds_read_b64_tr_b16 v[128:129], v31 offset:0
    ds_read_b64_tr_b16 v[130:131], v31 offset:768
    v_mfma_f32_16x16x32_bf16 v[60:63], v[144:147], v[172:175], v[60:63]
    ds_read_b128 v[164:167], v24 offset:512
    v_mfma_f32_16x16x32_bf16 v[68:71], v[172:175], v[148:151], v[68:71]
    v_cndmask_b32 v176, v176, v104, s[56:57]
    v_mfma_f32_16x16x32_bf16 v[76:79], v[172:175], v[152:155], v[76:79]
    v_cndmask_b32 v177, v177, v104, s[56:57]
    v_mfma_f32_16x16x32_bf16 v[84:87], v[104:107], v[172:175], v[84:87]
    v_cndmask_b32 v178, v178, v104, s[56:57]
    v_mfma_f32_16x16x32_bf16 v[92:95], v[172:175], v[172:175], v[92:95]
    v_cndmask_b32 v179, v179, v104, s[56:57]
    s_nop 1
    v_mfma_f32_16x16x32_bf16 v[96:99], v[176:179], v[148:151], v[96:99]
    v_mfma_f32_16x16x32_bf16 v[100:103], v[176:179], v[152:155], v[100:103]
    s_waitcnt lgkmcnt(0)
    v_mfma_f32_16x16x32_bf16 v[32:35], v[108:111], v[156:159], v[32:35]
    v_mfma_f32_16x16x32_bf16 v[40:43], v[112:115], v[156:159], v[40:43]
    v_mfma_f32_16x16x32_bf16 v[48:51], v[116:119], v[156:159], v[48:51]
    ds_read_b128 v[168:171], v21 offset:0
    ds_read_b128 v[172:175], v21 offset:2048
    v_mfma_f32_16x16x32_bf16 v[56:59], v[120:123], v[156:159], v[56:59]
    ds_read_b64_tr_b16 v[132:133], v26 offset:6144
    v_mfma_f32_16x16x32_bf16 v[64:67], v[156:159], v[124:127], v[64:67]
    ds_read_b64_tr_b16 v[134:135], v26 offset:6912
    ds_read_b64_tr_b16 v[136:137], v27 offset:6144
    v_mfma_f32_16x16x32_bf16 v[72:75], v[156:159], v[128:131], v[72:75]
    ds_read_b64_tr_b16 v[138:139], v27 offset:6912
    v_mfma_f32_16x16x32_bf16 v[80:83], v[104:107], v[156:159], v[80:83]
    ds_read_b64_tr_b16 v[140:141], v28 offset:6144
    ds_read_b64_tr_b16 v[142:143], v28 offset:6912
    v_mfma_f32_16x16x32_bf16 v[88:91], v[156:159], v[156:159], v[88:91]
    ds_read_b64_tr_b16 v[144:145], v29 offset:6144
    v_mfma_f32_16x16x32_bf16 v[36:39], v[108:111], v[160:163], v[36:39]
    ds_read_b64_tr_b16 v[146:147], v29 offset:6912
    ds_read_b64_tr_b16 v[148:149], v30 offset:6144
    v_mfma_f32_16x16x32_bf16 v[44:47], v[112:115], v[160:163], v[44:47]
    ds_read_b64_tr_b16 v[150:151], v30 offset:6912
    v_mfma_f32_16x16x32_bf16 v[52:55], v[116:119], v[160:163], v[52:55]
    ds_read_b64_tr_b16 v[152:153], v31 offset:6144
    ds_read_b64_tr_b16 v[154:155], v31 offset:6912
    v_mfma_f32_16x16x32_bf16 v[60:63], v[120:123], v[160:163], v[60:63]
    ds_read_b128 v[176:179], v25 offset:512
    v_mfma_f32_16x16x32_bf16 v[68:71], v[160:163], v[124:127], v[68:71]
    ds_read_b32 v17, v18 offset:24
    v_cndmask_b32 v164, v164, v104, s[56:57]
    v_mfma_f32_16x16x32_bf16 v[76:79], v[160:163], v[128:131], v[76:79]
    v_cndmask_b32 v165, v165, v104, s[56:57]
    v_mfma_f32_16x16x32_bf16 v[84:87], v[104:107], v[160:163], v[84:87]
    v_cndmask_b32 v166, v166, v104, s[56:57]
    v_mfma_f32_16x16x32_bf16 v[92:95], v[160:163], v[160:163], v[92:95]
    v_cndmask_b32 v167, v167, v104, s[56:57]
    s_nop 1
    v_mfma_f32_16x16x32_bf16 v[96:99], v[164:167], v[124:127], v[96:99]
    v_mfma_f32_16x16x32_bf16 v[100:103], v[164:167], v[128:131], v[100:103]
    s_waitcnt lgkmcnt(0)
    v_mfma_f32_16x16x32_bf16 v[32:35], v[132:135], v[168:171], v[32:35]
    v_mfma_f32_16x16x32_bf16 v[40:43], v[136:139], v[168:171], v[40:43]
    v_readfirstlane_b32 s40, v17
    s_nop 1
    s_cmp_ge_u32 s40, 4
    s_cbranch_scc1 L_sequential_preLN__sliding_local_dilated__geglu_ffn__prompt_kernel_cl2_6x
L_sequential_preLN__sliding_local_dilated__geglu_ffn__prompt_kernel_cl2_6:
    ds_read_b32 v17, v18 offset:24
    s_waitcnt lgkmcnt(0)
    v_readfirstlane_b32 s40, v17
    s_nop 1
    s_cmp_lt_u32 s40, 4
    s_cbranch_scc1 L_sequential_preLN__sliding_local_dilated__geglu_ffn__prompt_kernel_cl2_6
L_sequential_preLN__sliding_local_dilated__geglu_ffn__prompt_kernel_cl2_6x:
    v_mfma_f32_16x16x32_bf16 v[48:51], v[140:143], v[168:171], v[48:51]
    ds_read_b128 v[156:159], v20 offset:28672
    ds_read_b128 v[160:163], v20 offset:30720
    v_mfma_f32_16x16x32_bf16 v[56:59], v[144:147], v[168:171], v[56:59]
    ds_read_b64_tr_b16 v[108:109], v26 offset:28672
    v_mfma_f32_16x16x32_bf16 v[64:67], v[168:171], v[148:151], v[64:67]
    ds_read_b64_tr_b16 v[110:111], v26 offset:29440
    ds_read_b64_tr_b16 v[112:113], v27 offset:28672
    v_mfma_f32_16x16x32_bf16 v[72:75], v[168:171], v[152:155], v[72:75]
    ds_read_b64_tr_b16 v[114:115], v27 offset:29440
    v_mfma_f32_16x16x32_bf16 v[80:83], v[104:107], v[168:171], v[80:83]
    ds_read_b64_tr_b16 v[116:117], v28 offset:28672
    ds_read_b64_tr_b16 v[118:119], v28 offset:29440
    v_mfma_f32_16x16x32_bf16 v[88:91], v[168:171], v[168:171], v[88:91]
    ds_read_b64_tr_b16 v[120:121], v29 offset:28672
    v_mfma_f32_16x16x32_bf16 v[36:39], v[132:135], v[172:175], v[36:39]
    ds_read_b64_tr_b16 v[122:123], v29 offset:29440
    ds_read_b64_tr_b16 v[124:125], v30 offset:28672
    v_mfma_f32_16x16x32_bf16 v[44:47], v[136:139], v[172:175], v[44:47]
    ds_read_b64_tr_b16 v[126:127], v30 offset:29440
    v_mfma_f32_16x16x32_bf16 v[52:55], v[140:143], v[172:175], v[52:55]
    ds_read_b64_tr_b16 v[128:129], v31 offset:28672
    ds_read_b64_tr_b16 v[130:131], v31 offset:29440
    v_mfma_f32_16x16x32_bf16 v[60:63], v[144:147], v[172:175], v[60:63]
    ds_read_b128 v[164:167], v22 offset:768
    v_mfma_f32_16x16x32_bf16 v[68:71], v[172:175], v[148:151], v[68:71]
    v_cndmask_b32 v176, v176, v104, s[56:57]
    v_mfma_f32_16x16x32_bf16 v[76:79], v[172:175], v[152:155], v[76:79]
    v_cndmask_b32 v177, v177, v104, s[56:57]
    v_mfma_f32_16x16x32_bf16 v[84:87], v[104:107], v[172:175], v[84:87]
    v_cndmask_b32 v178, v178, v104, s[56:57]
    v_mfma_f32_16x16x32_bf16 v[92:95], v[172:175], v[172:175], v[92:95]
    v_cndmask_b32 v179, v179, v104, s[56:57]
    s_nop 1
    v_mfma_f32_16x16x32_bf16 v[96:99], v[176:179], v[148:151], v[96:99]
    v_mfma_f32_16x16x32_bf16 v[100:103], v[176:179], v[152:155], v[100:103]
    s_waitcnt lgkmcnt(0)
    v_mfma_f32_16x16x32_bf16 v[32:35], v[108:111], v[156:159], v[32:35]
    v_mfma_f32_16x16x32_bf16 v[40:43], v[112:115], v[156:159], v[40:43]
    v_mfma_f32_16x16x32_bf16 v[48:51], v[116:119], v[156:159], v[48:51]
    ds_read_b128 v[168:171], v21 offset:28672
    ds_read_b128 v[172:175], v21 offset:30720
    v_mfma_f32_16x16x32_bf16 v[56:59], v[120:123], v[156:159], v[56:59]
    ds_read_b64_tr_b16 v[132:133], v26 offset:34816
    v_mfma_f32_16x16x32_bf16 v[64:67], v[156:159], v[124:127], v[64:67]
    ds_read_b64_tr_b16 v[134:135], v26 offset:35584
    ds_read_b64_tr_b16 v[136:137], v27 offset:34816
    v_mfma_f32_16x16x32_bf16 v[72:75], v[156:159], v[128:131], v[72:75]
    ds_read_b64_tr_b16 v[138:139], v27 offset:35584
    v_mfma_f32_16x16x32_bf16 v[80:83], v[104:107], v[156:159], v[80:83]
    ds_read_b64_tr_b16 v[140:141], v28 offset:34816
    ds_read_b64_tr_b16 v[142:143], v28 offset:35584
    v_mfma_f32_16x16x32_bf16 v[88:91], v[156:159], v[156:159], v[88:91]
    ds_read_b64_tr_b16 v[144:145], v29 offset:34816
    v_mfma_f32_16x16x32_bf16 v[36:39], v[108:111], v[160:163], v[36:39]
    ds_read_b64_tr_b16 v[146:147], v29 offset:35584
    ds_read_b64_tr_b16 v[148:149], v30 offset:34816
    v_mfma_f32_16x16x32_bf16 v[44:47], v[112:115], v[160:163], v[44:47]
    ds_read_b64_tr_b16 v[150:151], v30 offset:35584
    v_mfma_f32_16x16x32_bf16 v[52:55], v[116:119], v[160:163], v[52:55]
    ds_read_b64_tr_b16 v[152:153], v31 offset:34816
    ds_read_b64_tr_b16 v[154:155], v31 offset:35584
    v_mfma_f32_16x16x32_bf16 v[60:63], v[120:123], v[160:163], v[60:63]
    ds_read_b128 v[176:179], v23 offset:768
    v_mfma_f32_16x16x32_bf16 v[68:71], v[160:163], v[124:127], v[68:71]
    ds_read_b32 v17, v18 offset:28
    v_cndmask_b32 v164, v164, v104, s[56:57]
    v_mfma_f32_16x16x32_bf16 v[76:79], v[160:163], v[128:131], v[76:79]
    v_cndmask_b32 v165, v165, v104, s[56:57]
    v_mfma_f32_16x16x32_bf16 v[84:87], v[104:107], v[160:163], v[84:87]
    v_cndmask_b32 v166, v166, v104, s[56:57]
    v_mfma_f32_16x16x32_bf16 v[92:95], v[160:163], v[160:163], v[92:95]
    v_cndmask_b32 v167, v167, v104, s[56:57]
    s_nop 1
    v_mfma_f32_16x16x32_bf16 v[96:99], v[164:167], v[124:127], v[96:99]
    v_mfma_f32_16x16x32_bf16 v[100:103], v[164:167], v[128:131], v[100:103]
    s_waitcnt lgkmcnt(0)
    v_mfma_f32_16x16x32_bf16 v[32:35], v[132:135], v[168:171], v[32:35]
    v_mfma_f32_16x16x32_bf16 v[40:43], v[136:139], v[168:171], v[40:43]
    v_readfirstlane_b32 s40, v17
    s_nop 1
    s_cmp_ge_u32 s40, 4
    s_cbranch_scc1 L_sequential_preLN__sliding_local_dilated__geglu_ffn__prompt_kernel_cl2_7x
L_sequential_preLN__sliding_local_dilated__geglu_ffn__prompt_kernel_cl2_7:
    ds_read_b32 v17, v18 offset:28
    s_waitcnt lgkmcnt(0)
    v_readfirstlane_b32 s40, v17
    s_nop 1
    s_cmp_lt_u32 s40, 4
    s_cbranch_scc1 L_sequential_preLN__sliding_local_dilated__geglu_ffn__prompt_kernel_cl2_7
L_sequential_preLN__sliding_local_dilated__geglu_ffn__prompt_kernel_cl2_7x:
    v_mfma_f32_16x16x32_bf16 v[48:51], v[140:143], v[168:171], v[48:51]
    ds_read_b128 v[156:159], v252 offset:0
    ds_read_b128 v[160:163], v252 offset:2048
    v_mfma_f32_16x16x32_bf16 v[56:59], v[144:147], v[168:171], v[56:59]
    ds_read_b64_tr_b16 v[108:109], v240 offset:0
    v_mfma_f32_16x16x32_bf16 v[64:67], v[168:171], v[148:151], v[64:67]
    ds_read_b64_tr_b16 v[110:111], v240 offset:768
    ds_read_b64_tr_b16 v[112:113], v241 offset:0
    v_mfma_f32_16x16x32_bf16 v[72:75], v[168:171], v[152:155], v[72:75]
    ds_read_b64_tr_b16 v[114:115], v241 offset:768
    v_mfma_f32_16x16x32_bf16 v[80:83], v[104:107], v[168:171], v[80:83]
    ds_read_b64_tr_b16 v[116:117], v242 offset:0
    ds_read_b64_tr_b16 v[118:119], v242 offset:768
    v_mfma_f32_16x16x32_bf16 v[88:91], v[168:171], v[168:171], v[88:91]
    ds_read_b64_tr_b16 v[120:121], v243 offset:0
    v_mfma_f32_16x16x32_bf16 v[36:39], v[132:135], v[172:175], v[36:39]
    ds_read_b64_tr_b16 v[122:123], v243 offset:768
    ds_read_b64_tr_b16 v[124:125], v244 offset:0
    v_mfma_f32_16x16x32_bf16 v[44:47], v[136:139], v[172:175], v[44:47]
    ds_read_b64_tr_b16 v[126:127], v244 offset:768
    v_mfma_f32_16x16x32_bf16 v[52:55], v[140:143], v[172:175], v[52:55]
    ds_read_b64_tr_b16 v[128:129], v245 offset:0
    ds_read_b64_tr_b16 v[130:131], v245 offset:768
    v_mfma_f32_16x16x32_bf16 v[60:63], v[144:147], v[172:175], v[60:63]
    ds_read_b128 v[164:167], v24 offset:768
    v_mfma_f32_16x16x32_bf16 v[68:71], v[172:175], v[148:151], v[68:71]
    v_cndmask_b32 v176, v176, v104, s[56:57]
    v_mfma_f32_16x16x32_bf16 v[76:79], v[172:175], v[152:155], v[76:79]
    v_cndmask_b32 v177, v177, v104, s[56:57]
    v_mfma_f32_16x16x32_bf16 v[84:87], v[104:107], v[172:175], v[84:87]
    v_cndmask_b32 v178, v178, v104, s[56:57]
    v_mfma_f32_16x16x32_bf16 v[92:95], v[172:175], v[172:175], v[92:95]
    v_cndmask_b32 v179, v179, v104, s[56:57]
    s_nop 1
    v_mfma_f32_16x16x32_bf16 v[96:99], v[176:179], v[148:151], v[96:99]
    v_mfma_f32_16x16x32_bf16 v[100:103], v[176:179], v[152:155], v[100:103]
    s_waitcnt lgkmcnt(0)
    v_mfma_f32_16x16x32_bf16 v[32:35], v[108:111], v[156:159], v[32:35]
    v_mfma_f32_16x16x32_bf16 v[40:43], v[112:115], v[156:159], v[40:43]
    v_mfma_f32_16x16x32_bf16 v[48:51], v[116:119], v[156:159], v[48:51]
    ds_read_b128 v[168:171], v253 offset:0
    ds_read_b128 v[172:175], v253 offset:2048
    v_mfma_f32_16x16x32_bf16 v[56:59], v[120:123], v[156:159], v[56:59]
    ds_read_b64_tr_b16 v[132:133], v240 offset:6144
    v_mfma_f32_16x16x32_bf16 v[64:67], v[156:159], v[124:127], v[64:67]
    ds_read_b64_tr_b16 v[134:135], v240 offset:6912
    ds_read_b64_tr_b16 v[136:137], v241 offset:6144
    v_mfma_f32_16x16x32_bf16 v[72:75], v[156:159], v[128:131], v[72:75]
    ds_read_b64_tr_b16 v[138:139], v241 offset:6912
    v_mfma_f32_16x16x32_bf16 v[80:83], v[104:107], v[156:159], v[80:83]
    ds_read_b64_tr_b16 v[140:141], v242 offset:6144
    ds_read_b64_tr_b16 v[142:143], v242 offset:6912
    v_mfma_f32_16x16x32_bf16 v[88:91], v[156:159], v[156:159], v[88:91]
    ds_read_b64_tr_b16 v[144:145], v243 offset:6144
    v_mfma_f32_16x16x32_bf16 v[36:39], v[108:111], v[160:163], v[36:39]
    ds_read_b64_tr_b16 v[146:147], v243 offset:6912
    ds_read_b64_tr_b16 v[148:149], v244 offset:6144
    v_mfma_f32_16x16x32_bf16 v[44:47], v[112:115], v[160:163], v[44:47]
    ds_read_b64_tr_b16 v[150:151], v244 offset:6912
    v_mfma_f32_16x16x32_bf16 v[52:55], v[116:119], v[160:163], v[52:55]
    ds_read_b64_tr_b16 v[152:153], v245 offset:6144
    ds_read_b64_tr_b16 v[154:155], v245 offset:6912
    v_mfma_f32_16x16x32_bf16 v[60:63], v[120:123], v[160:163], v[60:63]
    ds_read_b128 v[176:179], v25 offset:768
    v_mfma_f32_16x16x32_bf16 v[68:71], v[160:163], v[124:127], v[68:71]
    v_cndmask_b32 v164, v164, v104, s[56:57]
    v_mfma_f32_16x16x32_bf16 v[76:79], v[160:163], v[128:131], v[76:79]
    v_cndmask_b32 v165, v165, v104, s[56:57]
    v_mfma_f32_16x16x32_bf16 v[84:87], v[104:107], v[160:163], v[84:87]
    v_cndmask_b32 v166, v166, v104, s[56:57]
    v_mfma_f32_16x16x32_bf16 v[92:95], v[160:163], v[160:163], v[92:95]
    v_cndmask_b32 v167, v167, v104, s[56:57]
    s_nop 1
    v_mfma_f32_16x16x32_bf16 v[96:99], v[164:167], v[124:127], v[96:99]
    v_mfma_f32_16x16x32_bf16 v[100:103], v[164:167], v[128:131], v[100:103]
    s_waitcnt lgkmcnt(0)
    v_mfma_f32_16x16x32_bf16 v[32:35], v[132:135], v[168:171], v[32:35]
    v_mfma_f32_16x16x32_bf16 v[40:43], v[136:139], v[168:171], v[40:43]
    v_mfma_f32_16x16x32_bf16 v[48:51], v[140:143], v[168:171], v[48:51]
    v_mfma_f32_16x16x32_bf16 v[56:59], v[144:147], v[168:171], v[56:59]
    v_mfma_f32_16x16x32_bf16 v[64:67], v[168:171], v[148:151], v[64:67]
    v_mfma_f32_16x16x32_bf16 v[72:75], v[168:171], v[152:155], v[72:75]
    v_mfma_f32_16x16x32_bf16 v[80:83], v[104:107], v[168:171], v[80:83]
    v_mfma_f32_16x16x32_bf16 v[88:91], v[168:171], v[168:171], v[88:91]
    v_mfma_f32_16x16x32_bf16 v[36:39], v[132:135], v[172:175], v[36:39]
    v_mfma_f32_16x16x32_bf16 v[44:47], v[136:139], v[172:175], v[44:47]
    v_mfma_f32_16x16x32_bf16 v[52:55], v[140:143], v[172:175], v[52:55]
    v_mfma_f32_16x16x32_bf16 v[60:63], v[144:147], v[172:175], v[60:63]
    v_mfma_f32_16x16x32_bf16 v[68:71], v[172:175], v[148:151], v[68:71]
    v_cndmask_b32 v176, v176, v104, s[56:57]
    v_mfma_f32_16x16x32_bf16 v[76:79], v[172:175], v[152:155], v[76:79]
    v_cndmask_b32 v177, v177, v104, s[56:57]
    v_mfma_f32_16x16x32_bf16 v[84:87], v[104:107], v[172:175], v[84:87]
    v_cndmask_b32 v178, v178, v104, s[56:57]
    v_mfma_f32_16x16x32_bf16 v[92:95], v[172:175], v[172:175], v[92:95]
    v_cndmask_b32 v179, v179, v104, s[56:57]
    s_nop 1
    v_mfma_f32_16x16x32_bf16 v[96:99], v[176:179], v[148:151], v[96:99]
    v_mfma_f32_16x16x32_bf16 v[100:103], v[176:179], v[152:155], v[100:103]
    s_nop 7
L_sequential_preLN__sliding_local_dilated__geglu_ffn__prompt_kernel_cx2:
    ds_read_b32 v17, v18 offset:48
    s_waitcnt lgkmcnt(0)
    v_readfirstlane_b32 s40, v17
    s_nop 1
    s_cmp_lt_u32 s40, 4
    s_nop 1
    s_cbranch_scc1 L_sequential_preLN__sliding_local_dilated__geglu_ffn__prompt_kernel_cx2
    v_lshlrev_b32 v9, 3, v6
    v_add_u32 v9, 137472, v9
    v_lshlrev_b32 v15, 2, v6
    v_add_u32 v15, 137472, v15
    v_add_u32 v14, 131328, v1
    v_cndmask_b32 v10, v88, v89, s[58:59]
    v_cndmask_b32 v10, v10, v90, s[60:61]
    v_cndmask_b32 v10, v10, v91, s[62:63]
    v_mul_f32 v11, 0.001953125, v80
    v_mul_f32 v10, 0.001953125, v10
    v_fma_f32 v10, -v11, v11, v10
    v_max_f32 v10, 0, v10
    v_add_f32 v10, 0x3727c5ac, v10
    v_rsq_f32 v12, v10
    s_nop 0
    v_mul_f32 v13, v11, v12
    v_sub_f32 v13, 0, v13
    s_mov_b64 exec, s[84:85]
    ds_write_b64 v9, v[12:13] offset:0
    ds_write_b32 v15, v12 offset:640
    ds_write_b32 v15, v13 offset:704
    s_mov_b64 exec, -1
    ds_write_b128 v14, v[52:55] offset:20480
    ds_write_b128 v14, v[60:63] offset:21504
    ds_write_b128 v14, v[68:71] offset:22528
    ds_write_b128 v14, v[76:79] offset:23552
    v_cndmask_b32 v10, v92, v93, s[58:59]
    v_cndmask_b32 v10, v10, v94, s[60:61]
    v_cndmask_b32 v10, v10, v95, s[62:63]
    v_mul_f32 v11, 0.001953125, v84
    v_mul_f32 v10, 0.001953125, v10
    v_fma_f32 v10, -v11, v11, v10
    v_max_f32 v10, 0, v10
    v_add_f32 v10, 0x3727c5ac, v10
    v_rsq_f32 v12, v10
    s_nop 0
    v_mul_f32 v13, v11, v12
    v_sub_f32 v13, 0, v13
    s_mov_b64 exec, s[84:85]
    ds_write_b64 v9, v[12:13] offset:128
    ds_write_b32 v15, v12 offset:768
    ds_write_b32 v15, v13 offset:832
    s_mov_b64 exec, -1
    ds_write_b128 v14, v[96:99] offset:7168
    ds_write_b128 v14, v[100:103] offset:8192
    v_lshlrev_b32 v11, 2, v6
    v_add_u32 v11, 137472, v11
    s_mov_b64 exec, 0xffff
    ds_write_b32 v11, v96 offset:512
    ds_write_b32 v11, v100 offset:576
    s_mov_b64 exec, -1
    v_lshlrev_b32 v9, 3, v6
    v_lshlrev_b32 v10, 5, v5
    v_lshlrev_b32 v11, 4, v5
    v_lshlrev_b32 v12, 2, v6
    v_add_u32 v9, 131328, v9
    v_add_u32 v10, 131328, v10
    v_add_u32 v11, 131328, v11
    v_add_u32 v12, 131328, v12
    s_waitcnt lgkmcnt(0)
    s_barrier
    ds_read_b64 v[110:111], v9 offset:6144
    ds_read_b128 v[140:143], v11 offset:576
    ds_read_b128 v[148:151], v11 offset:512
    ds_read_b32 v156, v12 offset:6656
    ds_read_b128 v[144:147], v11 offset:3648
    ds_read_b128 v[152:155], v11 offset:3584
    ds_read_b32 v157, v12 offset:6720
    ds_read_b128 v[124:127], v11 offset:6784
    ds_read_b128 v[128:131], v11 offset:6848
    ds_read_b64 v[108:109], v9 offset:3200
    ds_read_b128 v[116:119], v11 offset:3840
    ds_read_b128 v[120:123], v11 offset:3904
    ds_read_b64 v[112:113], v9 offset:6272
    ds_read_b128 v[132:135], v11 offset:6912
    ds_read_b128 v[136:139], v11 offset:6976
    ds_read_b128 v[160:163], v14 offset:16384
    ds_read_b128 v[164:167], v14 offset:17408
    ds_read_b128 v[168:171], v14 offset:18432
    ds_read_b128 v[172:175], v14 offset:19456
    s_waitcnt lgkmcnt(10)
    v_pk_mul_f32 v[16:17], v[140:141], v[110:111] op_sel:[0,1] op_sel_hi:[1,1]
    v_pk_fma_f32 v[16:17], v[32:33], v[110:111], v[16:17] op_sel_hi:[1,0,1]
    v_pk_mul_f32 v[18:19], v[142:143], v[110:111] op_sel:[0,1] op_sel_hi:[1,1]
    v_pk_fma_f32 v[18:19], v[34:35], v[110:111], v[18:19] op_sel_hi:[1,0,1]
    v_cvt_pk_bf16_f32 v190, v16, v17
    v_cvt_pk_bf16_f32 v191, v18, v19
    v_pk_mul_f32 v[224:225], v[144:145], v[110:111] op_sel:[0,1] op_sel_hi:[1,1]
    v_pk_fma_f32 v[224:225], v[40:41], v[110:111], v[224:225] op_sel_hi:[1,0,1]
    v_pk_mul_f32 v[226:227], v[146:147], v[110:111] op_sel:[0,1] op_sel_hi:[1,1]
    v_pk_fma_f32 v[226:227], v[42:43], v[110:111], v[226:227] op_sel_hi:[1,0,1]
    v_cvt_pk_bf16_f32 v196, v224, v225
    v_cvt_pk_bf16_f32 v197, v226, v227
    v_pk_mul_f32 v[16:17], v[148:149], v[110:111] op_sel:[0,1] op_sel_hi:[1,1]
    v_pk_fma_f32 v[16:17], v[48:49], v[110:111], v[16:17] op_sel_hi:[1,0,1]
    v_pk_mul_f32 v[18:19], v[150:151], v[110:111] op_sel:[0,1] op_sel_hi:[1,1]
    v_pk_fma_f32 v[18:19], v[50:51], v[110:111], v[18:19] op_sel_hi:[1,0,1]
    v_cvt_pk_bf16_f32 v202, v16, v17
    v_cvt_pk_bf16_f32 v203, v18, v19
    v_pk_mul_f32 v[224:225], v[152:153], v[110:111] op_sel:[0,1] op_sel_hi:[1,1]
    v_pk_fma_f32 v[224:225], v[56:57], v[110:111], v[224:225] op_sel_hi:[1,0,1]
    v_pk_mul_f32 v[226:227], v[154:155], v[110:111] op_sel:[0,1] op_sel_hi:[1,1]
    v_pk_fma_f32 v[226:227], v[58:59], v[110:111], v[226:227] op_sel_hi:[1,0,1]
    v_cvt_pk_bf16_f32 v208, v224, v225
    v_cvt_pk_bf16_f32 v209, v226, v227
    v_pk_mul_f32 v[16:17], v[128:129], v[156:157] op_sel_hi:[1,0]
    v_pk_fma_f32 v[16:17], v[64:65], v[124:125], v[16:17]
    v_pk_mul_f32 v[18:19], v[130:131], v[156:157] op_sel_hi:[1,0]
    v_pk_fma_f32 v[18:19], v[66:67], v[126:127], v[18:19]
    v_cvt_pk_bf16_f32 v214, v16, v17
    v_cvt_pk_bf16_f32 v215, v18, v19
    v_pk_mul_f32 v[224:225], v[128:129], v[156:157] op_sel:[0,1] op_sel_hi:[1,1]
    v_pk_fma_f32 v[224:225], v[72:73], v[124:125], v[224:225]
    v_pk_mul_f32 v[226:227], v[130:131], v[156:157] op_sel:[0,1] op_sel_hi:[1,1]
    v_pk_fma_f32 v[226:227], v[74:75], v[126:127], v[226:227]
    v_cvt_pk_bf16_f32 v220, v224, v225
    v_cvt_pk_bf16_f32 v221, v226, v227
    s_waitcnt lgkmcnt(0)
    v_pk_mul_f32 v[16:17], v[140:141], v[112:113] op_sel:[0,1] op_sel_hi:[1,1]
    v_pk_fma_f32 v[16:17], v[36:37], v[112:113], v[16:17] op_sel_hi:[1,0,1]
    v_pk_mul_f32 v[18:19], v[142:143], v[112:113] op_sel:[0,1] op_sel_hi:[1,1]
    v_pk_fma_f32 v[18:19], v[38:39], v[112:113], v[18:19] op_sel_hi:[1,0,1]
    v_cvt_pk_bf16_f32 v192, v16, v17
    v_cvt_pk_bf16_f32 v193, v18, v19
    v_pk_mul_f32 v[224:225], v[144:145], v[112:113] op_sel:[0,1] op_sel_hi:[1,1]
    v_pk_fma_f32 v[224:225], v[44:45], v[112:113], v[224:225] op_sel_hi:[1,0,1]
    v_pk_mul_f32 v[226:227], v[146:147], v[112:113] op_sel:[0,1] op_sel_hi:[1,1]
    v_pk_fma_f32 v[226:227], v[46:47], v[112:113], v[226:227] op_sel_hi:[1,0,1]
    v_cvt_pk_bf16_f32 v198, v224, v225
    v_cvt_pk_bf16_f32 v199, v226, v227
    v_pk_mul_f32 v[16:17], v[148:149], v[112:113] op_sel:[0,1] op_sel_hi:[1,1]
    v_pk_fma_f32 v[16:17], v[52:53], v[112:113], v[16:17] op_sel_hi:[1,0,1]
    v_pk_mul_f32 v[18:19], v[150:151], v[112:113] op_sel:[0,1] op_sel_hi:[1,1]
    v_pk_fma_f32 v[18:19], v[54:55], v[112:113], v[18:19] op_sel_hi:[1,0,1]
    v_cvt_pk_bf16_f32 v204, v16, v17
    v_cvt_pk_bf16_f32 v205, v18, v19
    v_pk_mul_f32 v[224:225], v[152:153], v[112:113] op_sel:[0,1] op_sel_hi:[1,1]
    v_pk_fma_f32 v[224:225], v[60:61], v[112:113], v[224:225] op_sel_hi:[1,0,1]
    v_pk_mul_f32 v[226:227], v[154:155], v[112:113] op_sel:[0,1] op_sel_hi:[1,1]
    v_pk_fma_f32 v[226:227], v[62:63], v[112:113], v[226:227] op_sel_hi:[1,0,1]
    v_cvt_pk_bf16_f32 v210, v224, v225
    v_cvt_pk_bf16_f32 v211, v226, v227
    v_pk_mul_f32 v[16:17], v[136:137], v[156:157] op_sel_hi:[1,0]
    v_pk_fma_f32 v[16:17], v[68:69], v[132:133], v[16:17]
    v_pk_mul_f32 v[18:19], v[138:139], v[156:157] op_sel_hi:[1,0]
    v_pk_fma_f32 v[18:19], v[70:71], v[134:135], v[18:19]
    v_cvt_pk_bf16_f32 v216, v16, v17
    v_cvt_pk_bf16_f32 v217, v18, v19
    v_pk_mul_f32 v[224:225], v[136:137], v[156:157] op_sel:[0,1] op_sel_hi:[1,1]
    v_pk_fma_f32 v[224:225], v[76:77], v[132:133], v[224:225]
    v_pk_mul_f32 v[226:227], v[138:139], v[156:157] op_sel:[0,1] op_sel_hi:[1,1]
    v_pk_fma_f32 v[226:227], v[78:79], v[134:135], v[226:227]
    v_cvt_pk_bf16_f32 v222, v224, v225
    v_cvt_pk_bf16_f32 v223, v226, v227
    v_pk_mul_f32 v[16:17], v[148:149], v[108:109] op_sel:[0,1] op_sel_hi:[1,1]
    v_pk_fma_f32 v[16:17], v[160:161], v[108:109], v[16:17] op_sel_hi:[1,0,1]
    v_pk_mul_f32 v[18:19], v[150:151], v[108:109] op_sel:[0,1] op_sel_hi:[1,1]
    v_pk_fma_f32 v[18:19], v[162:163], v[108:109], v[18:19] op_sel_hi:[1,0,1]
    v_cvt_pk_bf16_f32 v200, v16, v17
    v_cvt_pk_bf16_f32 v201, v18, v19
    v_pk_mul_f32 v[224:225], v[152:153], v[108:109] op_sel:[0,1] op_sel_hi:[1,1]
    v_pk_fma_f32 v[224:225], v[164:165], v[108:109], v[224:225] op_sel_hi:[1,0,1]
    v_pk_mul_f32 v[226:227], v[154:155], v[108:109] op_sel:[0,1] op_sel_hi:[1,1]
    v_pk_fma_f32 v[226:227], v[166:167], v[108:109], v[226:227] op_sel_hi:[1,0,1]
    v_cvt_pk_bf16_f32 v206, v224, v225
    v_cvt_pk_bf16_f32 v207, v226, v227
    v_pk_mul_f32 v[16:17], v[120:121], v[156:157] op_sel_hi:[1,0]
    v_pk_fma_f32 v[16:17], v[168:169], v[116:117], v[16:17]
    v_pk_mul_f32 v[18:19], v[122:123], v[156:157] op_sel_hi:[1,0]
    v_pk_fma_f32 v[18:19], v[170:171], v[118:119], v[18:19]
    v_cvt_pk_bf16_f32 v212, v16, v17
    v_cvt_pk_bf16_f32 v213, v18, v19
    v_pk_mul_f32 v[224:225], v[120:121], v[156:157] op_sel:[0,1] op_sel_hi:[1,1]
    v_pk_fma_f32 v[224:225], v[172:173], v[116:117], v[224:225]
    v_pk_mul_f32 v[226:227], v[122:123], v[156:157] op_sel:[0,1] op_sel_hi:[1,1]
    v_pk_fma_f32 v[226:227], v[174:175], v[118:119], v[226:227]
    v_cvt_pk_bf16_f32 v218, v224, v225
    v_cvt_pk_bf16_f32 v219, v226, v227
    v_mfma_f32_16x16x16_bf16 v[32:35], v[200:201], v[190:191], 0
    v_mfma_f32_16x16x16_bf16 v[36:39], v[202:203], v[190:191], 0
    v_mfma_f32_16x16x16_bf16 v[40:43], v[206:207], v[196:197], 0
    v_mfma_f32_16x16x16_bf16 v[44:47], v[208:209], v[196:197], 0
    v_mfma_f32_16x16x16_bf16 v[48:51], v[202:203], v[192:193], 0
    v_mfma_f32_16x16x16_bf16 v[52:55], v[204:205], v[192:193], 0
    v_mfma_f32_16x16x16_bf16 v[56:59], v[208:209], v[198:199], 0
    v_mfma_f32_16x16x16_bf16 v[60:63], v[210:211], v[198:199], 0
    v_mov_b32 v132, s87
    v_pk_fma_f32 v[32:33], v[32:33], v[132:133], v[232:233] op_sel_hi:[1,0,1]
    v_pk_fma_f32 v[34:35], v[34:35], v[132:133], v[234:235] op_sel_hi:[1,0,1]
    v_pk_fma_f32 v[36:37], v[36:37], v[132:133], v[228:229] op_sel_hi:[1,0,1]
    v_pk_fma_f32 v[38:39], v[38:39], v[132:133], v[230:231] op_sel_hi:[1,0,1]
    v_max3_f32 v108, v32, v33, v34
    v_max3_f32 v108, v108, v35, v36
    v_max3_f32 v108, v108, v37, v38
    v_max_f32 v108, v108, v39
    v_pk_fma_f32 v[40:41], v[40:41], v[132:133], v[232:233] op_sel_hi:[1,0,1]
    v_pk_fma_f32 v[42:43], v[42:43], v[132:133], v[234:235] op_sel_hi:[1,0,1]
    v_pk_fma_f32 v[44:45], v[44:45], v[132:133], v[228:229] op_sel_hi:[1,0,1]
    v_pk_fma_f32 v[46:47], v[46:47], v[132:133], v[230:231] op_sel_hi:[1,0,1]
    v_max3_f32 v110, v40, v41, v42
    v_max3_f32 v110, v110, v43, v44
    v_max3_f32 v110, v110, v45, v46
    v_max_f32 v110, v110, v47
    v_pk_fma_f32 v[48:49], v[48:49], v[132:133], v[232:233] op_sel_hi:[1,0,1]
    v_pk_fma_f32 v[50:51], v[50:51], v[132:133], v[234:235] op_sel_hi:[1,0,1]
    v_pk_fma_f32 v[52:53], v[52:53], v[132:133], v[228:229] op_sel_hi:[1,0,1]
    v_pk_fma_f32 v[54:55], v[54:55], v[132:133], v[230:231] op_sel_hi:[1,0,1]
    v_max3_f32 v112, v48, v49, v50
    v_max3_f32 v112, v112, v51, v52
    v_max3_f32 v112, v112, v53, v54
    v_max_f32 v112, v112, v55
    v_pk_fma_f32 v[56:57], v[56:57], v[132:133], v[232:233] op_sel_hi:[1,0,1]
    v_pk_fma_f32 v[58:59], v[58:59], v[132:133], v[234:235] op_sel_hi:[1,0,1]
    v_pk_fma_f32 v[60:61], v[60:61], v[132:133], v[228:229] op_sel_hi:[1,0,1]
    v_pk_fma_f32 v[62:63], v[62:63], v[132:133], v[230:231] op_sel_hi:[1,0,1]
    v_max3_f32 v114, v56, v57, v58
    v_max3_f32 v114, v114, v59, v60
    v_max3_f32 v114, v114, v61, v62
    v_max_f32 v114, v114, v63
    v_mov_b32 v124, v108
    v_mov_b32 v125, v110
    v_mov_b32 v126, v112
    v_mov_b32 v127, v114
    v_permlane32_swap_b32 v108, v124
    v_permlane32_swap_b32 v110, v125
    v_permlane32_swap_b32 v112, v126
    v_permlane32_swap_b32 v114, v127
    v_max_f32 v108, v108, v124
    v_max_f32 v110, v110, v125
    v_max_f32 v112, v112, v126
    v_max_f32 v114, v114, v127
    v_mov_b32 v124, v108
    v_mov_b32 v125, v110
    v_mov_b32 v126, v112
    v_mov_b32 v127, v114
    v_permlane16_swap_b32 v108, v124
    v_permlane16_swap_b32 v110, v125
    v_permlane16_swap_b32 v112, v126
    v_permlane16_swap_b32 v114, v127
    v_max_f32 v108, v108, v124
    v_max_f32 v110, v110, v125
    v_max_f32 v112, v112, v126
    v_max_f32 v114, v114, v127
    v_pk_add_f32 v[32:33], v[32:33], v[108:109] op_sel_hi:[1,0] neg_lo:[0,1] neg_hi:[0,1]
    v_pk_add_f32 v[34:35], v[34:35], v[108:109] op_sel_hi:[1,0] neg_lo:[0,1] neg_hi:[0,1]
    v_pk_add_f32 v[36:37], v[36:37], v[108:109] op_sel_hi:[1,0] neg_lo:[0,1] neg_hi:[0,1]
    v_pk_add_f32 v[38:39], v[38:39], v[108:109] op_sel_hi:[1,0] neg_lo:[0,1] neg_hi:[0,1]
    v_exp_f32 v32, v32
    v_exp_f32 v33, v33
    v_exp_f32 v34, v34
    v_exp_f32 v35, v35
    v_exp_f32 v36, v36
    v_exp_f32 v37, v37
    v_exp_f32 v38, v38
    v_exp_f32 v39, v39
    v_pk_add_f32 v[40:41], v[40:41], v[110:111] op_sel_hi:[1,0] neg_lo:[0,1] neg_hi:[0,1]
    v_pk_add_f32 v[42:43], v[42:43], v[110:111] op_sel_hi:[1,0] neg_lo:[0,1] neg_hi:[0,1]
    v_pk_add_f32 v[44:45], v[44:45], v[110:111] op_sel_hi:[1,0] neg_lo:[0,1] neg_hi:[0,1]
    v_pk_add_f32 v[46:47], v[46:47], v[110:111] op_sel_hi:[1,0] neg_lo:[0,1] neg_hi:[0,1]
    v_exp_f32 v40, v40
    v_exp_f32 v41, v41
    v_exp_f32 v42, v42
    v_exp_f32 v43, v43
    v_exp_f32 v44, v44
    v_exp_f32 v45, v45
    v_exp_f32 v46, v46
    v_exp_f32 v47, v47
    v_pk_add_f32 v[48:49], v[48:49], v[112:113] op_sel_hi:[1,0] neg_lo:[0,1] neg_hi:[0,1]
    v_pk_add_f32 v[50:51], v[50:51], v[112:113] op_sel_hi:[1,0] neg_lo:[0,1] neg_hi:[0,1]
    v_pk_add_f32 v[52:53], v[52:53], v[112:113] op_sel_hi:[1,0] neg_lo:[0,1] neg_hi:[0,1]
    v_pk_add_f32 v[54:55], v[54:55], v[112:113] op_sel_hi:[1,0] neg_lo:[0,1] neg_hi:[0,1]
    v_exp_f32 v48, v48
    v_exp_f32 v49, v49
    v_exp_f32 v50, v50
    v_exp_f32 v51, v51
    v_exp_f32 v52, v52
    v_exp_f32 v53, v53
    v_exp_f32 v54, v54
    v_exp_f32 v55, v55
    v_pk_add_f32 v[56:57], v[56:57], v[114:115] op_sel_hi:[1,0] neg_lo:[0,1] neg_hi:[0,1]
    v_pk_add_f32 v[58:59], v[58:59], v[114:115] op_sel_hi:[1,0] neg_lo:[0,1] neg_hi:[0,1]
    v_pk_add_f32 v[60:61], v[60:61], v[114:115] op_sel_hi:[1,0] neg_lo:[0,1] neg_hi:[0,1]
    v_pk_add_f32 v[62:63], v[62:63], v[114:115] op_sel_hi:[1,0] neg_lo:[0,1] neg_hi:[0,1]
    v_exp_f32 v56, v56
    v_exp_f32 v57, v57
    v_exp_f32 v58, v58
    v_exp_f32 v59, v59
    v_exp_f32 v60, v60
    v_exp_f32 v61, v61
    v_exp_f32 v62, v62
    v_exp_f32 v63, v63
    v_cvt_pk_bf16_f32 v80, v32, v33
    v_cvt_pk_bf16_f32 v81, v34, v35
    v_cvt_pk_bf16_f32 v82, v36, v37
    v_cvt_pk_bf16_f32 v83, v38, v39
    v_cvt_pk_bf16_f32 v84, v40, v41
    v_cvt_pk_bf16_f32 v85, v42, v43
    v_cvt_pk_bf16_f32 v86, v44, v45
    v_cvt_pk_bf16_f32 v87, v46, v47
    v_cvt_pk_bf16_f32 v88, v48, v49
    v_cvt_pk_bf16_f32 v89, v50, v51
    v_cvt_pk_bf16_f32 v90, v52, v53
    v_cvt_pk_bf16_f32 v91, v54, v55
    v_cvt_pk_bf16_f32 v92, v56, v57
    v_cvt_pk_bf16_f32 v93, v58, v59
    v_cvt_pk_bf16_f32 v94, v60, v61
    v_cvt_pk_bf16_f32 v95, v62, v63
    v_mfma_f32_16x16x16_bf16 v[64:67], v[212:213], v[80:81], 0
    v_mfma_f32_16x16x16_bf16 v[68:71], v[218:219], v[84:85], 0
    v_mfma_f32_16x16x16_bf16 v[72:75], v[214:215], v[88:89], 0
    v_mfma_f32_16x16x16_bf16 v[76:79], v[220:221], v[92:93], 0
    v_mfma_f32_16x16x16_bf16 v[64:67], v[214:215], v[82:83], v[64:67]
    v_mfma_f32_16x16x16_bf16 v[68:71], v[220:221], v[86:87], v[68:71]
    v_mfma_f32_16x16x16_bf16 v[72:75], v[216:217], v[90:91], v[72:75]
    v_mfma_f32_16x16x16_bf16 v[76:79], v[222:223], v[94:95], v[76:79]
    v_lshlrev_b32 v32, 16, v80
    v_and_b32 v33, 0xffff0000, v80
    v_lshlrev_b32 v34, 16, v81
    v_and_b32 v35, 0xffff0000, v81
    v_lshlrev_b32 v36, 16, v82
    v_and_b32 v37, 0xffff0000, v82
    v_lshlrev_b32 v38, 16, v83
    v_and_b32 v39, 0xffff0000, v83
    v_pk_add_f32 v[32:33], v[32:33], v[34:35]
    v_pk_add_f32 v[36:37], v[36:37], v[38:39]
    v_pk_add_f32 v[32:33], v[32:33], v[36:37]
    v_add_f32 v116, v32, v33
    v_lshlrev_b32 v40, 16, v84
    v_and_b32 v41, 0xffff0000, v84
    v_lshlrev_b32 v42, 16, v85
    v_and_b32 v43, 0xffff0000, v85
    v_lshlrev_b32 v44, 16, v86
    v_and_b32 v45, 0xffff0000, v86
    v_lshlrev_b32 v46, 16, v87
    v_and_b32 v47, 0xffff0000, v87
    v_pk_add_f32 v[40:41], v[40:41], v[42:43]
    v_pk_add_f32 v[44:45], v[44:45], v[46:47]
    v_pk_add_f32 v[40:41], v[40:41], v[44:45]
    v_add_f32 v118, v40, v41
    v_lshlrev_b32 v48, 16, v88
    v_and_b32 v49, 0xffff0000, v88
    v_lshlrev_b32 v50, 16, v89
    v_and_b32 v51, 0xffff0000, v89
    v_lshlrev_b32 v52, 16, v90
    v_and_b32 v53, 0xffff0000, v90
    v_lshlrev_b32 v54, 16, v91
    v_and_b32 v55, 0xffff0000, v91
    v_pk_add_f32 v[48:49], v[48:49], v[50:51]
    v_pk_add_f32 v[52:53], v[52:53], v[54:55]
    v_pk_add_f32 v[48:49], v[48:49], v[52:53]
    v_add_f32 v120, v48, v49
    v_lshlrev_b32 v56, 16, v92
    v_and_b32 v57, 0xffff0000, v92
    v_lshlrev_b32 v58, 16, v93
    v_and_b32 v59, 0xffff0000, v93
    v_lshlrev_b32 v60, 16, v94
    v_and_b32 v61, 0xffff0000, v94
    v_lshlrev_b32 v62, 16, v95
    v_and_b32 v63, 0xffff0000, v95
    v_pk_add_f32 v[56:57], v[56:57], v[58:59]
    v_pk_add_f32 v[60:61], v[60:61], v[62:63]
    v_pk_add_f32 v[56:57], v[56:57], v[60:61]
    v_add_f32 v122, v56, v57
    v_mov_b32 v124, v116
    v_mov_b32 v125, v118
    v_mov_b32 v126, v120
    v_mov_b32 v127, v122
    v_permlane32_swap_b32 v116, v124
    v_permlane32_swap_b32 v118, v125
    v_permlane32_swap_b32 v120, v126
    v_permlane32_swap_b32 v122, v127
    v_add_f32 v116, v116, v124
    v_add_f32 v118, v118, v125
    v_add_f32 v120, v120, v126
    v_add_f32 v122, v122, v127
    v_mov_b32 v124, v116
    v_mov_b32 v125, v118
    v_mov_b32 v126, v120
    v_mov_b32 v127, v122
    v_permlane16_swap_b32 v116, v124
    v_permlane16_swap_b32 v118, v125
    v_permlane16_swap_b32 v120, v126
    v_permlane16_swap_b32 v122, v127
    v_add_f32 v116, v116, v124
    v_add_f32 v118, v118, v125
    v_add_f32 v120, v120, v126
    v_add_f32 v122, v122, v127
    v_rcp_f32 v116, v116
    v_rcp_f32 v118, v118
    v_rcp_f32 v120, v120
    v_rcp_f32 v122, v122
    v_pk_mul_f32 v[64:65], v[64:65], v[116:117] op_sel_hi:[1,0]
    v_pk_mul_f32 v[66:67], v[66:67], v[116:117] op_sel_hi:[1,0]
    v_pk_mul_f32 v[68:69], v[68:69], v[118:119] op_sel_hi:[1,0]
    v_pk_mul_f32 v[70:71], v[70:71], v[118:119] op_sel_hi:[1,0]
    v_pk_mul_f32 v[72:73], v[72:73], v[120:121] op_sel_hi:[1,0]
    v_pk_mul_f32 v[74:75], v[74:75], v[120:121] op_sel_hi:[1,0]
    v_pk_mul_f32 v[76:77], v[76:77], v[122:123] op_sel_hi:[1,0]
    v_pk_mul_f32 v[78:79], v[78:79], v[122:123] op_sel_hi:[1,0]
    s_lshl_b32 s38, s29, 17
    s_lshl_b32 s39, s43, 10
    s_add_u32 s38, s38, s39
    s_add_u32 s38, s38, 65536
    s_add_u32 s39, s38, 16384
    v_cvt_pk_bf16_f32 v96, v64, v65
    v_cvt_pk_bf16_f32 v97, v66, v67
    v_cvt_pk_bf16_f32 v98, v68, v69
    v_cvt_pk_bf16_f32 v99, v70, v71
    v_cvt_pk_bf16_f32 v100, v72, v73
    v_cvt_pk_bf16_f32 v101, v74, v75
    v_cvt_pk_bf16_f32 v102, v76, v77
    v_cvt_pk_bf16_f32 v103, v78, v79
    buffer_store_dwordx4 v[96:99], v1, s[4:7], s38 offen sc1
    buffer_store_dwordx4 v[100:103], v1, s[4:7], s39 offen sc1
    s_nop 1
    s_branch L_sequential_preLN__sliding_local_dilated__geglu_ffn__prompt_kernel_p1join
L_sequential_preLN__sliding_local_dilated__geglu_ffn__prompt_kernel_w3:
L_sequential_preLN__sliding_local_dilated__geglu_ffn__prompt_kernel_cl3_0:
    ds_read_b32 v17, v18 offset:0
    s_waitcnt lgkmcnt(0)
    v_readfirstlane_b32 s40, v17
    s_nop 1
    s_cmp_lt_u32 s40, 4
    s_cbranch_scc1 L_sequential_preLN__sliding_local_dilated__geglu_ffn__prompt_kernel_cl3_0
L_sequential_preLN__sliding_local_dilated__geglu_ffn__prompt_kernel_cl3_0x:
    ds_read_b128 v[156:159], v20 offset:0
    ds_read_b128 v[160:163], v20 offset:2048
    ds_read_b64_tr_b16 v[108:109], v26 offset:0
    ds_read_b64_tr_b16 v[110:111], v26 offset:768
    ds_read_b64_tr_b16 v[112:113], v27 offset:0
    ds_read_b64_tr_b16 v[114:115], v27 offset:768
    ds_read_b64_tr_b16 v[116:117], v28 offset:0
    ds_read_b64_tr_b16 v[118:119], v28 offset:768
    ds_read_b64_tr_b16 v[120:121], v29 offset:0
    ds_read_b64_tr_b16 v[122:123], v29 offset:768
    ds_read_b64_tr_b16 v[124:125], v30 offset:0
    ds_read_b64_tr_b16 v[126:127], v30 offset:768
    ds_read_b64_tr_b16 v[128:129], v31 offset:0
    ds_read_b64_tr_b16 v[130:131], v31 offset:768
    ds_read_b128 v[164:167], v22 offset:0
    s_waitcnt lgkmcnt(0)
    v_mfma_f32_16x16x32_bf16 v[32:35], v[108:111], v[156:159], v[32:35]
    v_mfma_f32_16x16x32_bf16 v[40:43], v[112:115], v[156:159], v[40:43]
    v_mfma_f32_16x16x32_bf16 v[48:51], v[116:119], v[156:159], v[48:51]
    ds_read_b128 v[168:171], v21 offset:0
    ds_read_b128 v[172:175], v21 offset:2048
    v_mfma_f32_16x16x32_bf16 v[56:59], v[120:123], v[156:159], v[56:59]
    ds_read_b64_tr_b16 v[132:133], v26 offset:6144
    v_mfma_f32_16x16x32_bf16 v[64:67], v[156:159], v[124:127], v[64:67]
    ds_read_b64_tr_b16 v[134:135], v26 offset:6912
    ds_read_b64_tr_b16 v[136:137], v27 offset:6144
    v_mfma_f32_16x16x32_bf16 v[72:75], v[156:159], v[128:131], v[72:75]
    ds_read_b64_tr_b16 v[138:139], v27 offset:6912
    v_mfma_f32_16x16x32_bf16 v[80:83], v[104:107], v[156:159], v[80:83]
    ds_read_b64_tr_b16 v[140:141], v28 offset:6144
    ds_read_b64_tr_b16 v[142:143], v28 offset:6912
    v_mfma_f32_16x16x32_bf16 v[88:91], v[156:159], v[156:159], v[88:91]
    ds_read_b64_tr_b16 v[144:145], v29 offset:6144
    v_mfma_f32_16x16x32_bf16 v[36:39], v[108:111], v[160:163], v[36:39]
    ds_read_b64_tr_b16 v[146:147], v29 offset:6912
    ds_read_b64_tr_b16 v[148:149], v30 offset:6144
    v_mfma_f32_16x16x32_bf16 v[44:47], v[112:115], v[160:163], v[44:47]
    ds_read_b64_tr_b16 v[150:151], v30 offset:6912
    v_mfma_f32_16x16x32_bf16 v[52:55], v[116:119], v[160:163], v[52:55]
    ds_read_b64_tr_b16 v[152:153], v31 offset:6144
    ds_read_b64_tr_b16 v[154:155], v31 offset:6912
    v_mfma_f32_16x16x32_bf16 v[60:63], v[120:123], v[160:163], v[60:63]
    ds_read_b128 v[176:179], v23 offset:0
    v_mfma_f32_16x16x32_bf16 v[68:71], v[160:163], v[124:127], v[68:71]
    ds_read_b32 v17, v18 offset:4
    v_cndmask_b32 v164, v164, v104, s[56:57]
    v_mfma_f32_16x16x32_bf16 v[76:79], v[160:163], v[128:131], v[76:79]
    v_cndmask_b32 v165, v165, v104, s[56:57]
    v_mfma_f32_16x16x32_bf16 v[84:87], v[104:107], v[160:163], v[84:87]
    v_cndmask_b32 v166, v166, v104, s[56:57]
    v_mfma_f32_16x16x32_bf16 v[92:95], v[160:163], v[160:163], v[92:95]
    v_cndmask_b32 v167, v167, v104, s[56:57]
    s_nop 1
    v_mfma_f32_16x16x32_bf16 v[96:99], v[104:107], v[164:167], v[96:99]
    v_mfma_f32_16x16x32_bf16 v[100:103], v[164:167], v[164:167], v[100:103]
    s_waitcnt lgkmcnt(0)
    v_mfma_f32_16x16x32_bf16 v[32:35], v[132:135], v[168:171], v[32:35]
    v_mfma_f32_16x16x32_bf16 v[40:43], v[136:139], v[168:171], v[40:43]
    s_mov_b64 exec, 1
    ds_add_u32 v18, v19 offset:32
    s_mov_b64 exec, -1
    v_readfirstlane_b32 s40, v17
    s_nop 1
    s_cmp_ge_u32 s40, 4
    s_cbranch_scc1 L_sequential_preLN__sliding_local_dilated__geglu_ffn__prompt_kernel_cl3_1x
L_sequential_preLN__sliding_local_dilated__geglu_ffn__prompt_kernel_cl3_1:
    ds_read_b32 v17, v18 offset:4
    s_waitcnt lgkmcnt(0)
    v_readfirstlane_b32 s40, v17
    s_nop 1
    s_cmp_lt_u32 s40, 4
    s_cbranch_scc1 L_sequential_preLN__sliding_local_dilated__geglu_ffn__prompt_kernel_cl3_1
L_sequential_preLN__sliding_local_dilated__geglu_ffn__prompt_kernel_cl3_1x:
    v_mfma_f32_16x16x32_bf16 v[48:51], v[140:143], v[168:171], v[48:51]
    ds_read_b128 v[156:159], v20 offset:28672
    ds_read_b128 v[160:163], v20 offset:30720
    v_mfma_f32_16x16x32_bf16 v[56:59], v[144:147], v[168:171], v[56:59]
    ds_read_b64_tr_b16 v[108:109], v26 offset:28672
    v_mfma_f32_16x16x32_bf16 v[64:67], v[168:171], v[148:151], v[64:67]
    ds_read_b64_tr_b16 v[110:111], v26 offset:29440
    ds_read_b64_tr_b16 v[112:113], v27 offset:28672
    v_mfma_f32_16x16x32_bf16 v[72:75], v[168:171], v[152:155], v[72:75]
    ds_read_b64_tr_b16 v[114:115], v27 offset:29440
    v_mfma_f32_16x16x32_bf16 v[80:83], v[104:107], v[168:171], v[80:83]
    ds_read_b64_tr_b16 v[116:117], v28 offset:28672
    ds_read_b64_tr_b16 v[118:119], v28 offset:29440
    v_mfma_f32_16x16x32_bf16 v[88:91], v[168:171], v[168:171], v[88:91]
    ds_read_b64_tr_b16 v[120:121], v29 offset:28672
    v_mfma_f32_16x16x32_bf16 v[36:39], v[132:135], v[172:175], v[36:39]
    ds_read_b64_tr_b16 v[122:123], v29 offset:29440
    ds_read_b64_tr_b16 v[124:125], v30 offset:28672
    v_mfma_f32_16x16x32_bf16 v[44:47], v[136:139], v[172:175], v[44:47]
    ds_read_b64_tr_b16 v[126:127], v30 offset:29440
    v_mfma_f32_16x16x32_bf16 v[52:55], v[140:143], v[172:175], v[52:55]
    ds_read_b64_tr_b16 v[128:129], v31 offset:28672
    ds_read_b64_tr_b16 v[130:131], v31 offset:29440
    v_mfma_f32_16x16x32_bf16 v[60:63], v[144:147], v[172:175], v[60:63]
    ds_read_b128 v[164:167], v24 offset:0
    v_mfma_f32_16x16x32_bf16 v[68:71], v[172:175], v[148:151], v[68:71]
    v_cndmask_b32 v176, v176, v104, s[56:57]
    v_mfma_f32_16x16x32_bf16 v[76:79], v[172:175], v[152:155], v[76:79]
    v_cndmask_b32 v177, v177, v104, s[56:57]
    v_mfma_f32_16x16x32_bf16 v[84:87], v[104:107], v[172:175], v[84:87]
    v_cndmask_b32 v178, v178, v104, s[56:57]
    v_mfma_f32_16x16x32_bf16 v[92:95], v[172:175], v[172:175], v[92:95]
    v_cndmask_b32 v179, v179, v104, s[56:57]
    s_nop 1
    v_mfma_f32_16x16x32_bf16 v[96:99], v[104:107], v[176:179], v[96:99]
    v_mfma_f32_16x16x32_bf16 v[100:103], v[176:179], v[176:179], v[100:103]
    s_waitcnt lgkmcnt(0)
    v_mfma_f32_16x16x32_bf16 v[32:35], v[108:111], v[156:159], v[32:35]
    v_mfma_f32_16x16x32_bf16 v[40:43], v[112:115], v[156:159], v[40:43]
    v_mfma_f32_16x16x32_bf16 v[48:51], v[116:119], v[156:159], v[48:51]
    ds_read_b128 v[168:171], v21 offset:28672
    ds_read_b128 v[172:175], v21 offset:30720
    v_mfma_f32_16x16x32_bf16 v[56:59], v[120:123], v[156:159], v[56:59]
    ds_read_b64_tr_b16 v[132:133], v26 offset:34816
    v_mfma_f32_16x16x32_bf16 v[64:67], v[156:159], v[124:127], v[64:67]
    ds_read_b64_tr_b16 v[134:135], v26 offset:35584
    ds_read_b64_tr_b16 v[136:137], v27 offset:34816
    v_mfma_f32_16x16x32_bf16 v[72:75], v[156:159], v[128:131], v[72:75]
    ds_read_b64_tr_b16 v[138:139], v27 offset:35584
    v_mfma_f32_16x16x32_bf16 v[80:83], v[104:107], v[156:159], v[80:83]
    ds_read_b64_tr_b16 v[140:141], v28 offset:34816
    ds_read_b64_tr_b16 v[142:143], v28 offset:35584
    v_mfma_f32_16x16x32_bf16 v[88:91], v[156:159], v[156:159], v[88:91]
    ds_read_b64_tr_b16 v[144:145], v29 offset:34816
    v_mfma_f32_16x16x32_bf16 v[36:39], v[108:111], v[160:163], v[36:39]
    ds_read_b64_tr_b16 v[146:147], v29 offset:35584
    ds_read_b64_tr_b16 v[148:149], v30 offset:34816
    v_mfma_f32_16x16x32_bf16 v[44:47], v[112:115], v[160:163], v[44:47]
    ds_read_b64_tr_b16 v[150:151], v30 offset:35584
    v_mfma_f32_16x16x32_bf16 v[52:55], v[116:119], v[160:163], v[52:55]
    ds_read_b64_tr_b16 v[152:153], v31 offset:34816
    ds_read_b64_tr_b16 v[154:155], v31 offset:35584
    v_mfma_f32_16x16x32_bf16 v[60:63], v[120:123], v[160:163], v[60:63]
    ds_read_b128 v[176:179], v25 offset:0
    v_mfma_f32_16x16x32_bf16 v[68:71], v[160:163], v[124:127], v[68:71]
    ds_read_b32 v17, v18 offset:8
    v_cndmask_b32 v164, v164, v104, s[56:57]
    v_mfma_f32_16x16x32_bf16 v[76:79], v[160:163], v[128:131], v[76:79]
    v_cndmask_b32 v165, v165, v104, s[56:57]
    v_mfma_f32_16x16x32_bf16 v[84:87], v[104:107], v[160:163], v[84:87]
    v_cndmask_b32 v166, v166, v104, s[56:57]
    v_mfma_f32_16x16x32_bf16 v[92:95], v[160:163], v[160:163], v[92:95]
    v_cndmask_b32 v167, v167, v104, s[56:57]
    s_nop 1
    v_mfma_f32_16x16x32_bf16 v[96:99], v[104:107], v[164:167], v[96:99]
    v_mfma_f32_16x16x32_bf16 v[100:103], v[164:167], v[164:167], v[100:103]
    s_waitcnt lgkmcnt(0)
    v_mfma_f32_16x16x32_bf16 v[32:35], v[132:135], v[168:171], v[32:35]
    v_mfma_f32_16x16x32_bf16 v[40:43], v[136:139], v[168:171], v[40:43]
    s_mov_b64 exec, 1
    ds_add_u32 v18, v19 offset:36
    s_mov_b64 exec, -1
    v_readfirstlane_b32 s40, v17
    s_nop 1
    s_cmp_ge_u32 s40, 4
    s_cbranch_scc1 L_sequential_preLN__sliding_local_dilated__geglu_ffn__prompt_kernel_cl3_2x
L_sequential_preLN__sliding_local_dilated__geglu_ffn__prompt_kernel_cl3_2:
    ds_read_b32 v17, v18 offset:8
    s_waitcnt lgkmcnt(0)
    v_readfirstlane_b32 s40, v17
    s_nop 1
    s_cmp_lt_u32 s40, 4
    s_cbranch_scc1 L_sequential_preLN__sliding_local_dilated__geglu_ffn__prompt_kernel_cl3_2
L_sequential_preLN__sliding_local_dilated__geglu_ffn__prompt_kernel_cl3_2x:
    v_mfma_f32_16x16x32_bf16 v[48:51], v[140:143], v[168:171], v[48:51]
    ds_read_b128 v[156:159], v252 offset:0
    ds_read_b128 v[160:163], v252 offset:2048
    v_mfma_f32_16x16x32_bf16 v[56:59], v[144:147], v[168:171], v[56:59]
    ds_read_b64_tr_b16 v[108:109], v240 offset:0
    v_mfma_f32_16x16x32_bf16 v[64:67], v[168:171], v[148:151], v[64:67]
    ds_read_b64_tr_b16 v[110:111], v240 offset:768
    ds_read_b64_tr_b16 v[112:113], v241 offset:0
    v_mfma_f32_16x16x32_bf16 v[72:75], v[168:171], v[152:155], v[72:75]
    ds_read_b64_tr_b16 v[114:115], v241 offset:768
    v_mfma_f32_16x16x32_bf16 v[80:83], v[104:107], v[168:171], v[80:83]
    ds_read_b64_tr_b16 v[116:117], v242 offset:0
    ds_read_b64_tr_b16 v[118:119], v242 offset:768
    v_mfma_f32_16x16x32_bf16 v[88:91], v[168:171], v[168:171], v[88:91]
    ds_read_b64_tr_b16 v[120:121], v243 offset:0
    v_mfma_f32_16x16x32_bf16 v[36:39], v[132:135], v[172:175], v[36:39]
    ds_read_b64_tr_b16 v[122:123], v243 offset:768
    ds_read_b64_tr_b16 v[124:125], v244 offset:0
    v_mfma_f32_16x16x32_bf16 v[44:47], v[136:139], v[172:175], v[44:47]
    ds_read_b64_tr_b16 v[126:127], v244 offset:768
    v_mfma_f32_16x16x32_bf16 v[52:55], v[140:143], v[172:175], v[52:55]
    ds_read_b64_tr_b16 v[128:129], v245 offset:0
    ds_read_b64_tr_b16 v[130:131], v245 offset:768
    v_mfma_f32_16x16x32_bf16 v[60:63], v[144:147], v[172:175], v[60:63]
    ds_read_b128 v[164:167], v22 offset:256
    v_mfma_f32_16x16x32_bf16 v[68:71], v[172:175], v[148:151], v[68:71]
    v_cndmask_b32 v176, v176, v104, s[56:57]
    v_mfma_f32_16x16x32_bf16 v[76:79], v[172:175], v[152:155], v[76:79]
    v_cndmask_b32 v177, v177, v104, s[56:57]
    v_mfma_f32_16x16x32_bf16 v[84:87], v[104:107], v[172:175], v[84:87]
    v_cndmask_b32 v178, v178, v104, s[56:57]
    v_mfma_f32_16x16x32_bf16 v[92:95], v[172:175], v[172:175], v[92:95]
    v_cndmask_b32 v179, v179, v104, s[56:57]
    s_nop 1
    v_mfma_f32_16x16x32_bf16 v[96:99], v[104:107], v[176:179], v[96:99]
    v_mfma_f32_16x16x32_bf16 v[100:103], v[176:179], v[176:179], v[100:103]
    s_waitcnt lgkmcnt(0)
    v_mfma_f32_16x16x32_bf16 v[32:35], v[108:111], v[156:159], v[32:35]
    v_mfma_f32_16x16x32_bf16 v[40:43], v[112:115], v[156:159], v[40:43]
    v_mfma_f32_16x16x32_bf16 v[48:51], v[116:119], v[156:159], v[48:51]
    ds_read_b128 v[168:171], v253 offset:0
    ds_read_b128 v[172:175], v253 offset:2048
    v_mfma_f32_16x16x32_bf16 v[56:59], v[120:123], v[156:159], v[56:59]
    ds_read_b64_tr_b16 v[132:133], v240 offset:6144
    v_mfma_f32_16x16x32_bf16 v[64:67], v[156:159], v[124:127], v[64:67]
    ds_read_b64_tr_b16 v[134:135], v240 offset:6912
    ds_read_b64_tr_b16 v[136:137], v241 offset:6144
    v_mfma_f32_16x16x32_bf16 v[72:75], v[156:159], v[128:131], v[72:75]
    ds_read_b64_tr_b16 v[138:139], v241 offset:6912
    v_mfma_f32_16x16x32_bf16 v[80:83], v[104:107], v[156:159], v[80:83]
    ds_read_b64_tr_b16 v[140:141], v242 offset:6144
    ds_read_b64_tr_b16 v[142:143], v242 offset:6912
    v_mfma_f32_16x16x32_bf16 v[88:91], v[156:159], v[156:159], v[88:91]
    ds_read_b64_tr_b16 v[144:145], v243 offset:6144
    v_mfma_f32_16x16x32_bf16 v[36:39], v[108:111], v[160:163], v[36:39]
    ds_read_b64_tr_b16 v[146:147], v243 offset:6912
    ds_read_b64_tr_b16 v[148:149], v244 offset:6144
    v_mfma_f32_16x16x32_bf16 v[44:47], v[112:115], v[160:163], v[44:47]
    ds_read_b64_tr_b16 v[150:151], v244 offset:6912
    v_mfma_f32_16x16x32_bf16 v[52:55], v[116:119], v[160:163], v[52:55]
    ds_read_b64_tr_b16 v[152:153], v245 offset:6144
    ds_read_b64_tr_b16 v[154:155], v245 offset:6912
    v_mfma_f32_16x16x32_bf16 v[60:63], v[120:123], v[160:163], v[60:63]
    ds_read_b128 v[176:179], v23 offset:256
    v_mfma_f32_16x16x32_bf16 v[68:71], v[160:163], v[124:127], v[68:71]
    ds_read_b32 v17, v18 offset:12
    v_cndmask_b32 v164, v164, v104, s[56:57]
    v_mfma_f32_16x16x32_bf16 v[76:79], v[160:163], v[128:131], v[76:79]
    v_cndmask_b32 v165, v165, v104, s[56:57]
    v_mfma_f32_16x16x32_bf16 v[84:87], v[104:107], v[160:163], v[84:87]
    v_cndmask_b32 v166, v166, v104, s[56:57]
    v_mfma_f32_16x16x32_bf16 v[92:95], v[160:163], v[160:163], v[92:95]
    v_cndmask_b32 v167, v167, v104, s[56:57]
    s_nop 1
    v_mfma_f32_16x16x32_bf16 v[96:99], v[104:107], v[164:167], v[96:99]
    v_mfma_f32_16x16x32_bf16 v[100:103], v[164:167], v[164:167], v[100:103]
    s_waitcnt lgkmcnt(0)
    v_mfma_f32_16x16x32_bf16 v[32:35], v[132:135], v[168:171], v[32:35]
    v_mfma_f32_16x16x32_bf16 v[40:43], v[136:139], v[168:171], v[40:43]
    s_mov_b64 exec, 1
    ds_add_u32 v18, v19 offset:40
    s_mov_b64 exec, -1
    v_readfirstlane_b32 s40, v17
    s_nop 1
    s_cmp_ge_u32 s40, 4
    s_cbranch_scc1 L_sequential_preLN__sliding_local_dilated__geglu_ffn__prompt_kernel_cl3_3x
L_sequential_preLN__sliding_local_dilated__geglu_ffn__prompt_kernel_cl3_3:
    ds_read_b32 v17, v18 offset:12
    s_waitcnt lgkmcnt(0)
    v_readfirstlane_b32 s40, v17
    s_nop 1
    s_cmp_lt_u32 s40, 4
    s_cbranch_scc1 L_sequential_preLN__sliding_local_dilated__geglu_ffn__prompt_kernel_cl3_3
L_sequential_preLN__sliding_local_dilated__geglu_ffn__prompt_kernel_cl3_3x:
    v_mfma_f32_16x16x32_bf16 v[48:51], v[140:143], v[168:171], v[48:51]
    ds_read_b128 v[156:159], v252 offset:28672
    ds_read_b128 v[160:163], v252 offset:30720
    v_mfma_f32_16x16x32_bf16 v[56:59], v[144:147], v[168:171], v[56:59]
    ds_read_b64_tr_b16 v[108:109], v240 offset:28672
    v_mfma_f32_16x16x32_bf16 v[64:67], v[168:171], v[148:151], v[64:67]
    ds_read_b64_tr_b16 v[110:111], v240 offset:29440
    ds_read_b64_tr_b16 v[112:113], v241 offset:28672
    v_mfma_f32_16x16x32_bf16 v[72:75], v[168:171], v[152:155], v[72:75]
    ds_read_b64_tr_b16 v[114:115], v241 offset:29440
    v_mfma_f32_16x16x32_bf16 v[80:83], v[104:107], v[168:171], v[80:83]
    ds_read_b64_tr_b16 v[116:117], v242 offset:28672
    ds_read_b64_tr_b16 v[118:119], v242 offset:29440
    v_mfma_f32_16x16x32_bf16 v[88:91], v[168:171], v[168:171], v[88:91]
    ds_read_b64_tr_b16 v[120:121], v243 offset:28672
    v_mfma_f32_16x16x32_bf16 v[36:39], v[132:135], v[172:175], v[36:39]
    ds_read_b64_tr_b16 v[122:123], v243 offset:29440
    ds_read_b64_tr_b16 v[124:125], v244 offset:28672
    v_mfma_f32_16x16x32_bf16 v[44:47], v[136:139], v[172:175], v[44:47]
    ds_read_b64_tr_b16 v[126:127], v244 offset:29440
    v_mfma_f32_16x16x32_bf16 v[52:55], v[140:143], v[172:175], v[52:55]
    ds_read_b64_tr_b16 v[128:129], v245 offset:28672
    ds_read_b64_tr_b16 v[130:131], v245 offset:29440
    v_mfma_f32_16x16x32_bf16 v[60:63], v[144:147], v[172:175], v[60:63]
    ds_read_b128 v[164:167], v24 offset:256
    v_mfma_f32_16x16x32_bf16 v[68:71], v[172:175], v[148:151], v[68:71]
    v_cndmask_b32 v176, v176, v104, s[56:57]
    v_mfma_f32_16x16x32_bf16 v[76:79], v[172:175], v[152:155], v[76:79]
    v_cndmask_b32 v177, v177, v104, s[56:57]
    v_mfma_f32_16x16x32_bf16 v[84:87], v[104:107], v[172:175], v[84:87]
    v_cndmask_b32 v178, v178, v104, s[56:57]
    v_mfma_f32_16x16x32_bf16 v[92:95], v[172:175], v[172:175], v[92:95]
    v_cndmask_b32 v179, v179, v104, s[56:57]
    s_nop 1
    v_mfma_f32_16x16x32_bf16 v[96:99], v[104:107], v[176:179], v[96:99]
    v_mfma_f32_16x16x32_bf16 v[100:103], v[176:179], v[176:179], v[100:103]
    s_waitcnt lgkmcnt(0)
    v_mfma_f32_16x16x32_bf16 v[32:35], v[108:111], v[156:159], v[32:35]
    v_mfma_f32_16x16x32_bf16 v[40:43], v[112:115], v[156:159], v[40:43]
    v_mfma_f32_16x16x32_bf16 v[48:51], v[116:119], v[156:159], v[48:51]
    ds_read_b128 v[168:171], v253 offset:28672
    ds_read_b128 v[172:175], v253 offset:30720
    v_mfma_f32_16x16x32_bf16 v[56:59], v[120:123], v[156:159], v[56:59]
    ds_read_b64_tr_b16 v[132:133], v240 offset:34816
    v_mfma_f32_16x16x32_bf16 v[64:67], v[156:159], v[124:127], v[64:67]
    ds_read_b64_tr_b16 v[134:135], v240 offset:35584
    ds_read_b64_tr_b16 v[136:137], v241 offset:34816
    v_mfma_f32_16x16x32_bf16 v[72:75], v[156:159], v[128:131], v[72:75]
    ds_read_b64_tr_b16 v[138:139], v241 offset:35584
    v_mfma_f32_16x16x32_bf16 v[80:83], v[104:107], v[156:159], v[80:83]
    ds_read_b64_tr_b16 v[140:141], v242 offset:34816
    ds_read_b64_tr_b16 v[142:143], v242 offset:35584
    v_mfma_f32_16x16x32_bf16 v[88:91], v[156:159], v[156:159], v[88:91]
    ds_read_b64_tr_b16 v[144:145], v243 offset:34816
    v_mfma_f32_16x16x32_bf16 v[36:39], v[108:111], v[160:163], v[36:39]
    ds_read_b64_tr_b16 v[146:147], v243 offset:35584
    ds_read_b64_tr_b16 v[148:149], v244 offset:34816
    v_mfma_f32_16x16x32_bf16 v[44:47], v[112:115], v[160:163], v[44:47]
    ds_read_b64_tr_b16 v[150:151], v244 offset:35584
    v_mfma_f32_16x16x32_bf16 v[52:55], v[116:119], v[160:163], v[52:55]
    ds_read_b64_tr_b16 v[152:153], v245 offset:34816
    ds_read_b64_tr_b16 v[154:155], v245 offset:35584
    v_mfma_f32_16x16x32_bf16 v[60:63], v[120:123], v[160:163], v[60:63]
    ds_read_b128 v[176:179], v25 offset:256
    v_mfma_f32_16x16x32_bf16 v[68:71], v[160:163], v[124:127], v[68:71]
    ds_read_b32 v17, v18 offset:16
    v_cndmask_b32 v164, v164, v104, s[56:57]
    v_mfma_f32_16x16x32_bf16 v[76:79], v[160:163], v[128:131], v[76:79]
    v_cndmask_b32 v165, v165, v104, s[56:57]
    v_mfma_f32_16x16x32_bf16 v[84:87], v[104:107], v[160:163], v[84:87]
    v_cndmask_b32 v166, v166, v104, s[56:57]
    v_mfma_f32_16x16x32_bf16 v[92:95], v[160:163], v[160:163], v[92:95]
    v_cndmask_b32 v167, v167, v104, s[56:57]
    s_nop 1
    v_mfma_f32_16x16x32_bf16 v[96:99], v[104:107], v[164:167], v[96:99]
    v_mfma_f32_16x16x32_bf16 v[100:103], v[164:167], v[164:167], v[100:103]
    s_waitcnt lgkmcnt(0)
    v_mfma_f32_16x16x32_bf16 v[32:35], v[132:135], v[168:171], v[32:35]
    v_mfma_f32_16x16x32_bf16 v[40:43], v[136:139], v[168:171], v[40:43]
    v_readfirstlane_b32 s40, v17
    s_nop 1
    s_cmp_ge_u32 s40, 4
    s_cbranch_scc1 L_sequential_preLN__sliding_local_dilated__geglu_ffn__prompt_kernel_cl3_4x
L_sequential_preLN__sliding_local_dilated__geglu_ffn__prompt_kernel_cl3_4:
    ds_read_b32 v17, v18 offset:16
    s_waitcnt lgkmcnt(0)
    v_readfirstlane_b32 s40, v17
    s_nop 1
    s_cmp_lt_u32 s40, 4
    s_cbranch_scc1 L_sequential_preLN__sliding_local_dilated__geglu_ffn__prompt_kernel_cl3_4
L_sequential_preLN__sliding_local_dilated__geglu_ffn__prompt_kernel_cl3_4x:
    v_mfma_f32_16x16x32_bf16 v[48:51], v[140:143], v[168:171], v[48:51]
    ds_read_b128 v[156:159], v254 offset:0
    ds_read_b128 v[160:163], v254 offset:2048
    v_mfma_f32_16x16x32_bf16 v[56:59], v[144:147], v[168:171], v[56:59]
    ds_read_b64_tr_b16 v[108:109], v246 offset:0
    v_mfma_f32_16x16x32_bf16 v[64:67], v[168:171], v[148:151], v[64:67]
    ds_read_b64_tr_b16 v[110:111], v246 offset:768
    ds_read_b64_tr_b16 v[112:113], v247 offset:0
    v_mfma_f32_16x16x32_bf16 v[72:75], v[168:171], v[152:155], v[72:75]
    ds_read_b64_tr_b16 v[114:115], v247 offset:768
    v_mfma_f32_16x16x32_bf16 v[80:83], v[104:107], v[168:171], v[80:83]
    ds_read_b64_tr_b16 v[116:117], v248 offset:0
    ds_read_b64_tr_b16 v[118:119], v248 offset:768
    v_mfma_f32_16x16x32_bf16 v[88:91], v[168:171], v[168:171], v[88:91]
    ds_read_b64_tr_b16 v[120:121], v249 offset:0
    v_mfma_f32_16x16x32_bf16 v[36:39], v[132:135], v[172:175], v[36:39]
    ds_read_b64_tr_b16 v[122:123], v249 offset:768
    ds_read_b64_tr_b16 v[124:125], v250 offset:0
    v_mfma_f32_16x16x32_bf16 v[44:47], v[136:139], v[172:175], v[44:47]
    ds_read_b64_tr_b16 v[126:127], v250 offset:768
    v_mfma_f32_16x16x32_bf16 v[52:55], v[140:143], v[172:175], v[52:55]
    ds_read_b64_tr_b16 v[128:129], v251 offset:0
    ds_read_b64_tr_b16 v[130:131], v251 offset:768
    v_mfma_f32_16x16x32_bf16 v[60:63], v[144:147], v[172:175], v[60:63]
    ds_read_b128 v[164:167], v22 offset:512
    v_mfma_f32_16x16x32_bf16 v[68:71], v[172:175], v[148:151], v[68:71]
    v_cndmask_b32 v176, v176, v104, s[56:57]
    v_mfma_f32_16x16x32_bf16 v[76:79], v[172:175], v[152:155], v[76:79]
    v_cndmask_b32 v177, v177, v104, s[56:57]
    v_mfma_f32_16x16x32_bf16 v[84:87], v[104:107], v[172:175], v[84:87]
    v_cndmask_b32 v178, v178, v104, s[56:57]
    v_mfma_f32_16x16x32_bf16 v[92:95], v[172:175], v[172:175], v[92:95]
    v_cndmask_b32 v179, v179, v104, s[56:57]
    s_nop 1
    v_mfma_f32_16x16x32_bf16 v[96:99], v[104:107], v[176:179], v[96:99]
    v_mfma_f32_16x16x32_bf16 v[100:103], v[176:179], v[176:179], v[100:103]
    s_waitcnt lgkmcnt(0)
    v_mfma_f32_16x16x32_bf16 v[32:35], v[108:111], v[156:159], v[32:35]
    v_mfma_f32_16x16x32_bf16 v[40:43], v[112:115], v[156:159], v[40:43]
    v_mfma_f32_16x16x32_bf16 v[48:51], v[116:119], v[156:159], v[48:51]
    ds_read_b128 v[168:171], v255 offset:0
    ds_read_b128 v[172:175], v255 offset:2048
    v_mfma_f32_16x16x32_bf16 v[56:59], v[120:123], v[156:159], v[56:59]
    ds_read_b64_tr_b16 v[132:133], v246 offset:6144
    v_mfma_f32_16x16x32_bf16 v[64:67], v[156:159], v[124:127], v[64:67]
    ds_read_b64_tr_b16 v[134:135], v246 offset:6912
    ds_read_b64_tr_b16 v[136:137], v247 offset:6144
    v_mfma_f32_16x16x32_bf16 v[72:75], v[156:159], v[128:131], v[72:75]
    ds_read_b64_tr_b16 v[138:139], v247 offset:6912
    v_mfma_f32_16x16x32_bf16 v[80:83], v[104:107], v[156:159], v[80:83]
    ds_read_b64_tr_b16 v[140:141], v248 offset:6144
    ds_read_b64_tr_b16 v[142:143], v248 offset:6912
    v_mfma_f32_16x16x32_bf16 v[88:91], v[156:159], v[156:159], v[88:91]
    ds_read_b64_tr_b16 v[144:145], v249 offset:6144
    v_mfma_f32_16x16x32_bf16 v[36:39], v[108:111], v[160:163], v[36:39]
    ds_read_b64_tr_b16 v[146:147], v249 offset:6912
    ds_read_b64_tr_b16 v[148:149], v250 offset:6144
    v_mfma_f32_16x16x32_bf16 v[44:47], v[112:115], v[160:163], v[44:47]
    ds_read_b64_tr_b16 v[150:151], v250 offset:6912
    v_mfma_f32_16x16x32_bf16 v[52:55], v[116:119], v[160:163], v[52:55]
    ds_read_b64_tr_b16 v[152:153], v251 offset:6144
    ds_read_b64_tr_b16 v[154:155], v251 offset:6912
    v_mfma_f32_16x16x32_bf16 v[60:63], v[120:123], v[160:163], v[60:63]
    ds_read_b128 v[176:179], v23 offset:512
    v_mfma_f32_16x16x32_bf16 v[68:71], v[160:163], v[124:127], v[68:71]
    ds_read_b32 v17, v18 offset:20
    v_cndmask_b32 v164, v164, v104, s[56:57]
    v_mfma_f32_16x16x32_bf16 v[76:79], v[160:163], v[128:131], v[76:79]
    v_cndmask_b32 v165, v165, v104, s[56:57]
    v_mfma_f32_16x16x32_bf16 v[84:87], v[104:107], v[160:163], v[84:87]
    v_cndmask_b32 v166, v166, v104, s[56:57]
    v_mfma_f32_16x16x32_bf16 v[92:95], v[160:163], v[160:163], v[92:95]
    v_cndmask_b32 v167, v167, v104, s[56:57]
    s_nop 1
    v_mfma_f32_16x16x32_bf16 v[96:99], v[104:107], v[164:167], v[96:99]
    v_mfma_f32_16x16x32_bf16 v[100:103], v[164:167], v[164:167], v[100:103]
    s_waitcnt lgkmcnt(0)
    v_mfma_f32_16x16x32_bf16 v[32:35], v[132:135], v[168:171], v[32:35]
    v_mfma_f32_16x16x32_bf16 v[40:43], v[136:139], v[168:171], v[40:43]
    s_mov_b64 exec, 1
    ds_add_u32 v18, v19 offset:48
    s_mov_b64 exec, -1
    v_readfirstlane_b32 s40, v17
    s_nop 1
    s_cmp_ge_u32 s40, 4
    s_cbranch_scc1 L_sequential_preLN__sliding_local_dilated__geglu_ffn__prompt_kernel_cl3_5x
L_sequential_preLN__sliding_local_dilated__geglu_ffn__prompt_kernel_cl3_5:
    ds_read_b32 v17, v18 offset:20
    s_waitcnt lgkmcnt(0)
    v_readfirstlane_b32 s40, v17
    s_nop 1
    s_cmp_lt_u32 s40, 4
    s_cbranch_scc1 L_sequential_preLN__sliding_local_dilated__geglu_ffn__prompt_kernel_cl3_5
L_sequential_preLN__sliding_local_dilated__geglu_ffn__prompt_kernel_cl3_5x:
    v_mfma_f32_16x16x32_bf16 v[48:51], v[140:143], v[168:171], v[48:51]
    ds_read_b128 v[156:159], v20 offset:0
    ds_read_b128 v[160:163], v20 offset:2048
    v_mfma_f32_16x16x32_bf16 v[56:59], v[144:147], v[168:171], v[56:59]
    ds_read_b64_tr_b16 v[108:109], v26 offset:0
    v_mfma_f32_16x16x32_bf16 v[64:67], v[168:171], v[148:151], v[64:67]
    ds_read_b64_tr_b16 v[110:111], v26 offset:768
    ds_read_b64_tr_b16 v[112:113], v27 offset:0
    v_mfma_f32_16x16x32_bf16 v[72:75], v[168:171], v[152:155], v[72:75]
    ds_read_b64_tr_b16 v[114:115], v27 offset:768
    v_mfma_f32_16x16x32_bf16 v[80:83], v[104:107], v[168:171], v[80:83]
    ds_read_b64_tr_b16 v[116:117], v28 offset:0
    ds_read_b64_tr_b16 v[118:119], v28 offset:768
    v_mfma_f32_16x16x32_bf16 v[88:91], v[168:171], v[168:171], v[88:91]
    ds_read_b64_tr_b16 v[120:121], v29 offset:0
    v_mfma_f32_16x16x32_bf16 v[36:39], v[132:135], v[172:175], v[36:39]
    ds_read_b64_tr_b16 v[122:123], v29 offset:768
    ds_read_b64_tr_b16 v[124:125], v30 offset:0
    v_mfma_f32_16x16x32_bf16 v[44:47], v[136:139], v[172:175], v[44:47]
    ds_read_b64_tr_b16 v[126:127], v30 offset:768
    v_mfma_f32_16x16x32_bf16 v[52:55], v[140:143], v[172:175], v[52:55]
    ds_read_b64_tr_b16 v[128:129], v31 offset:0
    ds_read_b64_tr_b16 v[130:131], v31 offset:768
    v_mfma_f32_16x16x32_bf16 v[60:63], v[144:147], v[172:175], v[60:63]
    ds_read_b128 v[164:167], v24 offset:512
    v_mfma_f32_16x16x32_bf16 v[68:71], v[172:175], v[148:151], v[68:71]
    v_cndmask_b32 v176, v176, v104, s[56:57]
    v_mfma_f32_16x16x32_bf16 v[76:79], v[172:175], v[152:155], v[76:79]
    v_cndmask_b32 v177, v177, v104, s[56:57]
    v_mfma_f32_16x16x32_bf16 v[84:87], v[104:107], v[172:175], v[84:87]
    v_cndmask_b32 v178, v178, v104, s[56:57]
    v_mfma_f32_16x16x32_bf16 v[92:95], v[172:175], v[172:175], v[92:95]
    v_cndmask_b32 v179, v179, v104, s[56:57]
    s_nop 1
    v_mfma_f32_16x16x32_bf16 v[96:99], v[104:107], v[176:179], v[96:99]
    v_mfma_f32_16x16x32_bf16 v[100:103], v[176:179], v[176:179], v[100:103]
    s_waitcnt lgkmcnt(0)
    v_mfma_f32_16x16x32_bf16 v[32:35], v[108:111], v[156:159], v[32:35]
    v_mfma_f32_16x16x32_bf16 v[40:43], v[112:115], v[156:159], v[40:43]
    v_mfma_f32_16x16x32_bf16 v[48:51], v[116:119], v[156:159], v[48:51]
    ds_read_b128 v[168:171], v21 offset:0
    ds_read_b128 v[172:175], v21 offset:2048
    v_mfma_f32_16x16x32_bf16 v[56:59], v[120:123], v[156:159], v[56:59]
    ds_read_b64_tr_b16 v[132:133], v26 offset:6144
    v_mfma_f32_16x16x32_bf16 v[64:67], v[156:159], v[124:127], v[64:67]
    ds_read_b64_tr_b16 v[134:135], v26 offset:6912
    ds_read_b64_tr_b16 v[136:137], v27 offset:6144
    v_mfma_f32_16x16x32_bf16 v[72:75], v[156:159], v[128:131], v[72:75]
    ds_read_b64_tr_b16 v[138:139], v27 offset:6912
    v_mfma_f32_16x16x32_bf16 v[80:83], v[104:107], v[156:159], v[80:83]
    ds_read_b64_tr_b16 v[140:141], v28 offset:6144
    ds_read_b64_tr_b16 v[142:143], v28 offset:6912
    v_mfma_f32_16x16x32_bf16 v[88:91], v[156:159], v[156:159], v[88:91]
    ds_read_b64_tr_b16 v[144:145], v29 offset:6144
    v_mfma_f32_16x16x32_bf16 v[36:39], v[108:111], v[160:163], v[36:39]
    ds_read_b64_tr_b16 v[146:147], v29 offset:6912
    ds_read_b64_tr_b16 v[148:149], v30 offset:6144
    v_mfma_f32_16x16x32_bf16 v[44:47], v[112:115], v[160:163], v[44:47]
    ds_read_b64_tr_b16 v[150:151], v30 offset:6912
    v_mfma_f32_16x16x32_bf16 v[52:55], v[116:119], v[160:163], v[52:55]
    ds_read_b64_tr_b16 v[152:153], v31 offset:6144
    ds_read_b64_tr_b16 v[154:155], v31 offset:6912
    v_mfma_f32_16x16x32_bf16 v[60:63], v[120:123], v[160:163], v[60:63]
    ds_read_b128 v[176:179], v25 offset:512
    v_mfma_f32_16x16x32_bf16 v[68:71], v[160:163], v[124:127], v[68:71]
    ds_read_b32 v17, v18 offset:24
    v_cndmask_b32 v164, v164, v104, s[56:57]
    v_mfma_f32_16x16x32_bf16 v[76:79], v[160:163], v[128:131], v[76:79]
    v_cndmask_b32 v165, v165, v104, s[56:57]
    v_mfma_f32_16x16x32_bf16 v[84:87], v[104:107], v[160:163], v[84:87]
    v_cndmask_b32 v166, v166, v104, s[56:57]
    v_mfma_f32_16x16x32_bf16 v[92:95], v[160:163], v[160:163], v[92:95]
    v_cndmask_b32 v167, v167, v104, s[56:57]
    s_nop 1
    v_mfma_f32_16x16x32_bf16 v[96:99], v[104:107], v[164:167], v[96:99]
    v_mfma_f32_16x16x32_bf16 v[100:103], v[164:167], v[164:167], v[100:103]
    s_waitcnt lgkmcnt(0)
    v_mfma_f32_16x16x32_bf16 v[32:35], v[132:135], v[168:171], v[32:35]
    v_mfma_f32_16x16x32_bf16 v[40:43], v[136:139], v[168:171], v[40:43]
    v_readfirstlane_b32 s40, v17
    s_nop 1
    s_cmp_ge_u32 s40, 4
    s_cbranch_scc1 L_sequential_preLN__sliding_local_dilated__geglu_ffn__prompt_kernel_cl3_6x
L_sequential_preLN__sliding_local_dilated__geglu_ffn__prompt_kernel_cl3_6:
    ds_read_b32 v17, v18 offset:24
    s_waitcnt lgkmcnt(0)
    v_readfirstlane_b32 s40, v17
    s_nop 1
    s_cmp_lt_u32 s40, 4
    s_cbranch_scc1 L_sequential_preLN__sliding_local_dilated__geglu_ffn__prompt_kernel_cl3_6
L_sequential_preLN__sliding_local_dilated__geglu_ffn__prompt_kernel_cl3_6x:
    v_mfma_f32_16x16x32_bf16 v[48:51], v[140:143], v[168:171], v[48:51]
    ds_read_b128 v[156:159], v20 offset:28672
    ds_read_b128 v[160:163], v20 offset:30720
    v_mfma_f32_16x16x32_bf16 v[56:59], v[144:147], v[168:171], v[56:59]
    ds_read_b64_tr_b16 v[108:109], v26 offset:28672
    v_mfma_f32_16x16x32_bf16 v[64:67], v[168:171], v[148:151], v[64:67]
    ds_read_b64_tr_b16 v[110:111], v26 offset:29440
    ds_read_b64_tr_b16 v[112:113], v27 offset:28672
    v_mfma_f32_16x16x32_bf16 v[72:75], v[168:171], v[152:155], v[72:75]
    ds_read_b64_tr_b16 v[114:115], v27 offset:29440
    v_mfma_f32_16x16x32_bf16 v[80:83], v[104:107], v[168:171], v[80:83]
    ds_read_b64_tr_b16 v[116:117], v28 offset:28672
    ds_read_b64_tr_b16 v[118:119], v28 offset:29440
    v_mfma_f32_16x16x32_bf16 v[88:91], v[168:171], v[168:171], v[88:91]
    ds_read_b64_tr_b16 v[120:121], v29 offset:28672
    v_mfma_f32_16x16x32_bf16 v[36:39], v[132:135], v[172:175], v[36:39]
    ds_read_b64_tr_b16 v[122:123], v29 offset:29440
    ds_read_b64_tr_b16 v[124:125], v30 offset:28672
    v_mfma_f32_16x16x32_bf16 v[44:47], v[136:139], v[172:175], v[44:47]
    ds_read_b64_tr_b16 v[126:127], v30 offset:29440
    v_mfma_f32_16x16x32_bf16 v[52:55], v[140:143], v[172:175], v[52:55]
    ds_read_b64_tr_b16 v[128:129], v31 offset:28672
    ds_read_b64_tr_b16 v[130:131], v31 offset:29440
    v_mfma_f32_16x16x32_bf16 v[60:63], v[144:147], v[172:175], v[60:63]
    ds_read_b128 v[164:167], v22 offset:768
    v_mfma_f32_16x16x32_bf16 v[68:71], v[172:175], v[148:151], v[68:71]
    v_cndmask_b32 v176, v176, v104, s[56:57]
    v_mfma_f32_16x16x32_bf16 v[76:79], v[172:175], v[152:155], v[76:79]
    v_cndmask_b32 v177, v177, v104, s[56:57]
    v_mfma_f32_16x16x32_bf16 v[84:87], v[104:107], v[172:175], v[84:87]
    v_cndmask_b32 v178, v178, v104, s[56:57]
    v_mfma_f32_16x16x32_bf16 v[92:95], v[172:175], v[172:175], v[92:95]
    v_cndmask_b32 v179, v179, v104, s[56:57]
    s_nop 1
    v_mfma_f32_16x16x32_bf16 v[96:99], v[104:107], v[176:179], v[96:99]
    v_mfma_f32_16x16x32_bf16 v[100:103], v[176:179], v[176:179], v[100:103]
    s_waitcnt lgkmcnt(0)
    v_mfma_f32_16x16x32_bf16 v[32:35], v[108:111], v[156:159], v[32:35]
    v_mfma_f32_16x16x32_bf16 v[40:43], v[112:115], v[156:159], v[40:43]
    v_mfma_f32_16x16x32_bf16 v[48:51], v[116:119], v[156:159], v[48:51]
    ds_read_b128 v[168:171], v21 offset:28672
    ds_read_b128 v[172:175], v21 offset:30720
    v_mfma_f32_16x16x32_bf16 v[56:59], v[120:123], v[156:159], v[56:59]
    ds_read_b64_tr_b16 v[132:133], v26 offset:34816
    v_mfma_f32_16x16x32_bf16 v[64:67], v[156:159], v[124:127], v[64:67]
    ds_read_b64_tr_b16 v[134:135], v26 offset:35584
    ds_read_b64_tr_b16 v[136:137], v27 offset:34816
    v_mfma_f32_16x16x32_bf16 v[72:75], v[156:159], v[128:131], v[72:75]
    ds_read_b64_tr_b16 v[138:139], v27 offset:35584
    v_mfma_f32_16x16x32_bf16 v[80:83], v[104:107], v[156:159], v[80:83]
    ds_read_b64_tr_b16 v[140:141], v28 offset:34816
    ds_read_b64_tr_b16 v[142:143], v28 offset:35584
    v_mfma_f32_16x16x32_bf16 v[88:91], v[156:159], v[156:159], v[88:91]
    ds_read_b64_tr_b16 v[144:145], v29 offset:34816
    v_mfma_f32_16x16x32_bf16 v[36:39], v[108:111], v[160:163], v[36:39]
    ds_read_b64_tr_b16 v[146:147], v29 offset:35584
    ds_read_b64_tr_b16 v[148:149], v30 offset:34816
    v_mfma_f32_16x16x32_bf16 v[44:47], v[112:115], v[160:163], v[44:47]
    ds_read_b64_tr_b16 v[150:151], v30 offset:35584
    v_mfma_f32_16x16x32_bf16 v[52:55], v[116:119], v[160:163], v[52:55]
    ds_read_b64_tr_b16 v[152:153], v31 offset:34816
    ds_read_b64_tr_b16 v[154:155], v31 offset:35584
    v_mfma_f32_16x16x32_bf16 v[60:63], v[120:123], v[160:163], v[60:63]
    ds_read_b128 v[176:179], v23 offset:768
    v_mfma_f32_16x16x32_bf16 v[68:71], v[160:163], v[124:127], v[68:71]
    ds_read_b32 v17, v18 offset:28
    v_cndmask_b32 v164, v164, v104, s[56:57]
    v_mfma_f32_16x16x32_bf16 v[76:79], v[160:163], v[128:131], v[76:79]
    v_cndmask_b32 v165, v165, v104, s[56:57]
    v_mfma_f32_16x16x32_bf16 v[84:87], v[104:107], v[160:163], v[84:87]
    v_cndmask_b32 v166, v166, v104, s[56:57]
    v_mfma_f32_16x16x32_bf16 v[92:95], v[160:163], v[160:163], v[92:95]
    v_cndmask_b32 v167, v167, v104, s[56:57]
    s_nop 1
    v_mfma_f32_16x16x32_bf16 v[96:99], v[104:107], v[164:167], v[96:99]
    v_mfma_f32_16x16x32_bf16 v[100:103], v[164:167], v[164:167], v[100:103]
    s_waitcnt lgkmcnt(0)
    v_mfma_f32_16x16x32_bf16 v[32:35], v[132:135], v[168:171], v[32:35]
    v_mfma_f32_16x16x32_bf16 v[40:43], v[136:139], v[168:171], v[40:43]
    v_readfirstlane_b32 s40, v17
    s_nop 1
    s_cmp_ge_u32 s40, 4
    s_cbranch_scc1 L_sequential_preLN__sliding_local_dilated__geglu_ffn__prompt_kernel_cl3_7x
L_sequential_preLN__sliding_local_dilated__geglu_ffn__prompt_kernel_cl3_7:
    ds_read_b32 v17, v18 offset:28
    s_waitcnt lgkmcnt(0)
    v_readfirstlane_b32 s40, v17
    s_nop 1
    s_cmp_lt_u32 s40, 4
    s_cbranch_scc1 L_sequential_preLN__sliding_local_dilated__geglu_ffn__prompt_kernel_cl3_7
L_sequential_preLN__sliding_local_dilated__geglu_ffn__prompt_kernel_cl3_7x:
    v_mfma_f32_16x16x32_bf16 v[48:51], v[140:143], v[168:171], v[48:51]
    ds_read_b128 v[156:159], v252 offset:0
    ds_read_b128 v[160:163], v252 offset:2048
    v_mfma_f32_16x16x32_bf16 v[56:59], v[144:147], v[168:171], v[56:59]
    ds_read_b64_tr_b16 v[108:109], v240 offset:0
    v_mfma_f32_16x16x32_bf16 v[64:67], v[168:171], v[148:151], v[64:67]
    ds_read_b64_tr_b16 v[110:111], v240 offset:768
    ds_read_b64_tr_b16 v[112:113], v241 offset:0
    v_mfma_f32_16x16x32_bf16 v[72:75], v[168:171], v[152:155], v[72:75]
    ds_read_b64_tr_b16 v[114:115], v241 offset:768
    v_mfma_f32_16x16x32_bf16 v[80:83], v[104:107], v[168:171], v[80:83]
    ds_read_b64_tr_b16 v[116:117], v242 offset:0
    ds_read_b64_tr_b16 v[118:119], v242 offset:768
    v_mfma_f32_16x16x32_bf16 v[88:91], v[168:171], v[168:171], v[88:91]
    ds_read_b64_tr_b16 v[120:121], v243 offset:0
    v_mfma_f32_16x16x32_bf16 v[36:39], v[132:135], v[172:175], v[36:39]
    ds_read_b64_tr_b16 v[122:123], v243 offset:768
    ds_read_b64_tr_b16 v[124:125], v244 offset:0
    v_mfma_f32_16x16x32_bf16 v[44:47], v[136:139], v[172:175], v[44:47]
    ds_read_b64_tr_b16 v[126:127], v244 offset:768
    v_mfma_f32_16x16x32_bf16 v[52:55], v[140:143], v[172:175], v[52:55]
    ds_read_b64_tr_b16 v[128:129], v245 offset:0
    ds_read_b64_tr_b16 v[130:131], v245 offset:768
    v_mfma_f32_16x16x32_bf16 v[60:63], v[144:147], v[172:175], v[60:63]
    ds_read_b128 v[164:167], v24 offset:768
    v_mfma_f32_16x16x32_bf16 v[68:71], v[172:175], v[148:151], v[68:71]
    v_cndmask_b32 v176, v176, v104, s[56:57]
    v_mfma_f32_16x16x32_bf16 v[76:79], v[172:175], v[152:155], v[76:79]
    v_cndmask_b32 v177, v177, v104, s[56:57]
    v_mfma_f32_16x16x32_bf16 v[84:87], v[104:107], v[172:175], v[84:87]
    v_cndmask_b32 v178, v178, v104, s[56:57]
    v_mfma_f32_16x16x32_bf16 v[92:95], v[172:175], v[172:175], v[92:95]
    v_cndmask_b32 v179, v179, v104, s[56:57]
    s_nop 1
    v_mfma_f32_16x16x32_bf16 v[96:99], v[104:107], v[176:179], v[96:99]
    v_mfma_f32_16x16x32_bf16 v[100:103], v[176:179], v[176:179], v[100:103]
    s_waitcnt lgkmcnt(0)
    v_mfma_f32_16x16x32_bf16 v[32:35], v[108:111], v[156:159], v[32:35]
    v_mfma_f32_16x16x32_bf16 v[40:43], v[112:115], v[156:159], v[40:43]
    v_mfma_f32_16x16x32_bf16 v[48:51], v[116:119], v[156:159], v[48:51]
    ds_read_b128 v[168:171], v253 offset:0
    ds_read_b128 v[172:175], v253 offset:2048
    v_mfma_f32_16x16x32_bf16 v[56:59], v[120:123], v[156:159], v[56:59]
    ds_read_b64_tr_b16 v[132:133], v240 offset:6144
    v_mfma_f32_16x16x32_bf16 v[64:67], v[156:159], v[124:127], v[64:67]
    ds_read_b64_tr_b16 v[134:135], v240 offset:6912
    ds_read_b64_tr_b16 v[136:137], v241 offset:6144
    v_mfma_f32_16x16x32_bf16 v[72:75], v[156:159], v[128:131], v[72:75]
    ds_read_b64_tr_b16 v[138:139], v241 offset:6912
    v_mfma_f32_16x16x32_bf16 v[80:83], v[104:107], v[156:159], v[80:83]
    ds_read_b64_tr_b16 v[140:141], v242 offset:6144
    ds_read_b64_tr_b16 v[142:143], v242 offset:6912
    v_mfma_f32_16x16x32_bf16 v[88:91], v[156:159], v[156:159], v[88:91]
    ds_read_b64_tr_b16 v[144:145], v243 offset:6144
    v_mfma_f32_16x16x32_bf16 v[36:39], v[108:111], v[160:163], v[36:39]
    ds_read_b64_tr_b16 v[146:147], v243 offset:6912
    ds_read_b64_tr_b16 v[148:149], v244 offset:6144
    v_mfma_f32_16x16x32_bf16 v[44:47], v[112:115], v[160:163], v[44:47]
    ds_read_b64_tr_b16 v[150:151], v244 offset:6912
    v_mfma_f32_16x16x32_bf16 v[52:55], v[116:119], v[160:163], v[52:55]
    ds_read_b64_tr_b16 v[152:153], v245 offset:6144
    ds_read_b64_tr_b16 v[154:155], v245 offset:6912
    v_mfma_f32_16x16x32_bf16 v[60:63], v[120:123], v[160:163], v[60:63]
    ds_read_b128 v[176:179], v25 offset:768
    v_mfma_f32_16x16x32_bf16 v[68:71], v[160:163], v[124:127], v[68:71]
    v_cndmask_b32 v164, v164, v104, s[56:57]
    v_mfma_f32_16x16x32_bf16 v[76:79], v[160:163], v[128:131], v[76:79]
    v_cndmask_b32 v165, v165, v104, s[56:57]
    v_mfma_f32_16x16x32_bf16 v[84:87], v[104:107], v[160:163], v[84:87]
    v_cndmask_b32 v166, v166, v104, s[56:57]
    v_mfma_f32_16x16x32_bf16 v[92:95], v[160:163], v[160:163], v[92:95]
    v_cndmask_b32 v167, v167, v104, s[56:57]
    s_nop 1
    v_mfma_f32_16x16x32_bf16 v[96:99], v[104:107], v[164:167], v[96:99]
    v_mfma_f32_16x16x32_bf16 v[100:103], v[164:167], v[164:167], v[100:103]
    s_waitcnt lgkmcnt(0)
    v_mfma_f32_16x16x32_bf16 v[32:35], v[132:135], v[168:171], v[32:35]
    v_mfma_f32_16x16x32_bf16 v[40:43], v[136:139], v[168:171], v[40:43]
    v_mfma_f32_16x16x32_bf16 v[48:51], v[140:143], v[168:171], v[48:51]
    v_mfma_f32_16x16x32_bf16 v[56:59], v[144:147], v[168:171], v[56:59]
    v_mfma_f32_16x16x32_bf16 v[64:67], v[168:171], v[148:151], v[64:67]
    v_mfma_f32_16x16x32_bf16 v[72:75], v[168:171], v[152:155], v[72:75]
    v_mfma_f32_16x16x32_bf16 v[80:83], v[104:107], v[168:171], v[80:83]
    v_mfma_f32_16x16x32_bf16 v[88:91], v[168:171], v[168:171], v[88:91]
    v_mfma_f32_16x16x32_bf16 v[36:39], v[132:135], v[172:175], v[36:39]
    v_mfma_f32_16x16x32_bf16 v[44:47], v[136:139], v[172:175], v[44:47]
    v_mfma_f32_16x16x32_bf16 v[52:55], v[140:143], v[172:175], v[52:55]
    v_mfma_f32_16x16x32_bf16 v[60:63], v[144:147], v[172:175], v[60:63]
    v_mfma_f32_16x16x32_bf16 v[68:71], v[172:175], v[148:151], v[68:71]
    v_cndmask_b32 v176, v176, v104, s[56:57]
    v_mfma_f32_16x16x32_bf16 v[76:79], v[172:175], v[152:155], v[76:79]
    v_cndmask_b32 v177, v177, v104, s[56:57]
    v_mfma_f32_16x16x32_bf16 v[84:87], v[104:107], v[172:175], v[84:87]
    v_cndmask_b32 v178, v178, v104, s[56:57]
    v_mfma_f32_16x16x32_bf16 v[92:95], v[172:175], v[172:175], v[92:95]
    v_cndmask_b32 v179, v179, v104, s[56:57]
    s_nop 1
    v_mfma_f32_16x16x32_bf16 v[96:99], v[104:107], v[176:179], v[96:99]
    v_mfma_f32_16x16x32_bf16 v[100:103], v[176:179], v[176:179], v[100:103]
    s_nop 7
L_sequential_preLN__sliding_local_dilated__geglu_ffn__prompt_kernel_cx3:
    ds_read_b32 v17, v18 offset:48
    s_waitcnt lgkmcnt(0)
    v_readfirstlane_b32 s40, v17
    s_nop 1
    s_cmp_lt_u32 s40, 4
    s_nop 1
    s_cbranch_scc1 L_sequential_preLN__sliding_local_dilated__geglu_ffn__prompt_kernel_cx3
    v_lshlrev_b32 v9, 3, v6
    v_add_u32 v9, 140544, v9
    v_lshlrev_b32 v15, 2, v6
    v_add_u32 v15, 140544, v15
    v_add_u32 v14, 131328, v1
    v_cndmask_b32 v10, v88, v89, s[58:59]
    v_cndmask_b32 v10, v10, v90, s[60:61]
    v_cndmask_b32 v10, v10, v91, s[62:63]
    v_mul_f32 v11, 0.001953125, v80
    v_mul_f32 v10, 0.001953125, v10
    v_fma_f32 v10, -v11, v11, v10
    v_max_f32 v10, 0, v10
    v_add_f32 v10, 0x3727c5ac, v10
    v_rsq_f32 v12, v10
    s_nop 0
    v_mul_f32 v13, v11, v12
    v_sub_f32 v13, 0, v13
    s_mov_b64 exec, s[84:85]
    ds_write_b64 v9, v[12:13] offset:0
    ds_write_b32 v15, v12 offset:640
    ds_write_b32 v15, v13 offset:704
    s_mov_b64 exec, -1
    ds_write_b128 v14, v[52:55] offset:24576
    ds_write_b128 v14, v[60:63] offset:25600
    ds_write_b128 v14, v[68:71] offset:26624
    ds_write_b128 v14, v[76:79] offset:27648
    v_cndmask_b32 v10, v92, v93, s[58:59]
    v_cndmask_b32 v10, v10, v94, s[60:61]
    v_cndmask_b32 v10, v10, v95, s[62:63]
    v_mul_f32 v11, 0.001953125, v84
    v_mul_f32 v10, 0.001953125, v10
    v_fma_f32 v10, -v11, v11, v10
    v_max_f32 v10, 0, v10
    v_add_f32 v10, 0x3727c5ac, v10
    v_rsq_f32 v12, v10
    s_nop 0
    v_mul_f32 v13, v11, v12
    v_sub_f32 v13, 0, v13
    s_mov_b64 exec, s[84:85]
    ds_write_b64 v9, v[12:13] offset:128
    ds_write_b32 v15, v12 offset:768
    ds_write_b32 v15, v13 offset:832
    s_mov_b64 exec, -1
    v_cndmask_b32 v10, v100, v101, s[58:59]
    v_cndmask_b32 v10, v10, v102, s[60:61]
    v_cndmask_b32 v10, v10, v103, s[62:63]
    v_mul_f32 v11, 0.001953125, v96
    v_mul_f32 v10, 0.001953125, v10
    v_fma_f32 v10, -v11, v11, v10
    v_max_f32 v10, 0, v10
    v_add_f32 v10, 0x3727c5ac, v10
    v_rsq_f32 v12, v10
    s_nop 0
    v_mul_f32 v13, v11, v12
    v_sub_f32 v13, 0, v13
    s_mov_b64 exec, s[84:85]
    ds_write_b64 v9, v[12:13] offset:256
    ds_write_b32 v15, v12 offset:896
    ds_write_b32 v15, v13 offset:960
    s_mov_b64 exec, -1
    v_lshlrev_b32 v9, 3, v6
    v_lshlrev_b32 v10, 5, v5
    v_lshlrev_b32 v11, 4, v5
    v_lshlrev_b32 v12, 2, v6
    v_add_u32 v9, 131328, v9
    v_add_u32 v10, 131328, v10
    v_add_u32 v11, 131328, v11
    v_add_u32 v12, 131328, v12
    s_waitcnt lgkmcnt(0)
    s_barrier
    ds_read_b64 v[110:111], v9 offset:9216
    ds_read_b128 v[140:143], v11 offset:576
    ds_read_b128 v[148:151], v11 offset:512
    ds_read_b32 v156, v12 offset:6656
    ds_read_b128 v[144:147], v11 offset:3648
    ds_read_b128 v[152:155], v11 offset:3584
    ds_read_b32 v157, v12 offset:6720
    ds_read_b128 v[124:127], v11 offset:9856
    ds_read_b128 v[128:131], v11 offset:9920
    ds_read_b64 v[108:109], v9 offset:6272
    ds_read_b128 v[116:119], v11 offset:6912
    ds_read_b128 v[120:123], v11 offset:6976
    ds_read_b64 v[112:113], v9 offset:9344
    ds_read_b128 v[132:135], v11 offset:9984
    ds_read_b128 v[136:139], v11 offset:10048
    ds_read_b128 v[160:163], v14 offset:20480
    ds_read_b128 v[164:167], v14 offset:21504
    ds_read_b128 v[168:171], v14 offset:22528
    ds_read_b128 v[172:175], v14 offset:23552
    s_waitcnt lgkmcnt(10)
    v_pk_mul_f32 v[16:17], v[140:141], v[110:111] op_sel:[0,1] op_sel_hi:[1,1]
    v_pk_fma_f32 v[16:17], v[32:33], v[110:111], v[16:17] op_sel_hi:[1,0,1]
    v_pk_mul_f32 v[18:19], v[142:143], v[110:111] op_sel:[0,1] op_sel_hi:[1,1]
    v_pk_fma_f32 v[18:19], v[34:35], v[110:111], v[18:19] op_sel_hi:[1,0,1]
    v_cvt_pk_bf16_f32 v190, v16, v17
    v_cvt_pk_bf16_f32 v191, v18, v19
    v_pk_mul_f32 v[224:225], v[144:145], v[110:111] op_sel:[0,1] op_sel_hi:[1,1]
    v_pk_fma_f32 v[224:225], v[40:41], v[110:111], v[224:225] op_sel_hi:[1,0,1]
    v_pk_mul_f32 v[226:227], v[146:147], v[110:111] op_sel:[0,1] op_sel_hi:[1,1]
    v_pk_fma_f32 v[226:227], v[42:43], v[110:111], v[226:227] op_sel_hi:[1,0,1]
    v_cvt_pk_bf16_f32 v196, v224, v225
    v_cvt_pk_bf16_f32 v197, v226, v227
    v_pk_mul_f32 v[16:17], v[148:149], v[110:111] op_sel:[0,1] op_sel_hi:[1,1]
    v_pk_fma_f32 v[16:17], v[48:49], v[110:111], v[16:17] op_sel_hi:[1,0,1]
    v_pk_mul_f32 v[18:19], v[150:151], v[110:111] op_sel:[0,1] op_sel_hi:[1,1]
    v_pk_fma_f32 v[18:19], v[50:51], v[110:111], v[18:19] op_sel_hi:[1,0,1]
    v_cvt_pk_bf16_f32 v202, v16, v17
    v_cvt_pk_bf16_f32 v203, v18, v19
    v_pk_mul_f32 v[224:225], v[152:153], v[110:111] op_sel:[0,1] op_sel_hi:[1,1]
    v_pk_fma_f32 v[224:225], v[56:57], v[110:111], v[224:225] op_sel_hi:[1,0,1]
    v_pk_mul_f32 v[226:227], v[154:155], v[110:111] op_sel:[0,1] op_sel_hi:[1,1]
    v_pk_fma_f32 v[226:227], v[58:59], v[110:111], v[226:227] op_sel_hi:[1,0,1]
    v_cvt_pk_bf16_f32 v208, v224, v225
    v_cvt_pk_bf16_f32 v209, v226, v227
    v_pk_mul_f32 v[16:17], v[128:129], v[156:157] op_sel_hi:[1,0]
    v_pk_fma_f32 v[16:17], v[64:65], v[124:125], v[16:17]
    v_pk_mul_f32 v[18:19], v[130:131], v[156:157] op_sel_hi:[1,0]
    v_pk_fma_f32 v[18:19], v[66:67], v[126:127], v[18:19]
    v_cvt_pk_bf16_f32 v214, v16, v17
    v_cvt_pk_bf16_f32 v215, v18, v19
    v_pk_mul_f32 v[224:225], v[128:129], v[156:157] op_sel:[0,1] op_sel_hi:[1,1]
    v_pk_fma_f32 v[224:225], v[72:73], v[124:125], v[224:225]
    v_pk_mul_f32 v[226:227], v[130:131], v[156:157] op_sel:[0,1] op_sel_hi:[1,1]
    v_pk_fma_f32 v[226:227], v[74:75], v[126:127], v[226:227]
    v_cvt_pk_bf16_f32 v220, v224, v225
    v_cvt_pk_bf16_f32 v221, v226, v227
    s_waitcnt lgkmcnt(0)
    v_pk_mul_f32 v[16:17], v[140:141], v[112:113] op_sel:[0,1] op_sel_hi:[1,1]
    v_pk_fma_f32 v[16:17], v[36:37], v[112:113], v[16:17] op_sel_hi:[1,0,1]
    v_pk_mul_f32 v[18:19], v[142:143], v[112:113] op_sel:[0,1] op_sel_hi:[1,1]
    v_pk_fma_f32 v[18:19], v[38:39], v[112:113], v[18:19] op_sel_hi:[1,0,1]
    v_cvt_pk_bf16_f32 v192, v16, v17
    v_cvt_pk_bf16_f32 v193, v18, v19
    v_pk_mul_f32 v[224:225], v[144:145], v[112:113] op_sel:[0,1] op_sel_hi:[1,1]
    v_pk_fma_f32 v[224:225], v[44:45], v[112:113], v[224:225] op_sel_hi:[1,0,1]
    v_pk_mul_f32 v[226:227], v[146:147], v[112:113] op_sel:[0,1] op_sel_hi:[1,1]
    v_pk_fma_f32 v[226:227], v[46:47], v[112:113], v[226:227] op_sel_hi:[1,0,1]
    v_cvt_pk_bf16_f32 v198, v224, v225
    v_cvt_pk_bf16_f32 v199, v226, v227
    v_pk_mul_f32 v[16:17], v[148:149], v[112:113] op_sel:[0,1] op_sel_hi:[1,1]
    v_pk_fma_f32 v[16:17], v[52:53], v[112:113], v[16:17] op_sel_hi:[1,0,1]
    v_pk_mul_f32 v[18:19], v[150:151], v[112:113] op_sel:[0,1] op_sel_hi:[1,1]
    v_pk_fma_f32 v[18:19], v[54:55], v[112:113], v[18:19] op_sel_hi:[1,0,1]
    v_cvt_pk_bf16_f32 v204, v16, v17
    v_cvt_pk_bf16_f32 v205, v18, v19
    v_pk_mul_f32 v[224:225], v[152:153], v[112:113] op_sel:[0,1] op_sel_hi:[1,1]
    v_pk_fma_f32 v[224:225], v[60:61], v[112:113], v[224:225] op_sel_hi:[1,0,1]
    v_pk_mul_f32 v[226:227], v[154:155], v[112:113] op_sel:[0,1] op_sel_hi:[1,1]
    v_pk_fma_f32 v[226:227], v[62:63], v[112:113], v[226:227] op_sel_hi:[1,0,1]
    v_cvt_pk_bf16_f32 v210, v224, v225
    v_cvt_pk_bf16_f32 v211, v226, v227
    v_pk_mul_f32 v[16:17], v[136:137], v[156:157] op_sel_hi:[1,0]
    v_pk_fma_f32 v[16:17], v[68:69], v[132:133], v[16:17]
    v_pk_mul_f32 v[18:19], v[138:139], v[156:157] op_sel_hi:[1,0]
    v_pk_fma_f32 v[18:19], v[70:71], v[134:135], v[18:19]
    v_cvt_pk_bf16_f32 v216, v16, v17
    v_cvt_pk_bf16_f32 v217, v18, v19
    v_pk_mul_f32 v[224:225], v[136:137], v[156:157] op_sel:[0,1] op_sel_hi:[1,1]
    v_pk_fma_f32 v[224:225], v[76:77], v[132:133], v[224:225]
    v_pk_mul_f32 v[226:227], v[138:139], v[156:157] op_sel:[0,1] op_sel_hi:[1,1]
    v_pk_fma_f32 v[226:227], v[78:79], v[134:135], v[226:227]
    v_cvt_pk_bf16_f32 v222, v224, v225
    v_cvt_pk_bf16_f32 v223, v226, v227
    v_pk_mul_f32 v[16:17], v[148:149], v[108:109] op_sel:[0,1] op_sel_hi:[1,1]
    v_pk_fma_f32 v[16:17], v[160:161], v[108:109], v[16:17] op_sel_hi:[1,0,1]
    v_pk_mul_f32 v[18:19], v[150:151], v[108:109] op_sel:[0,1] op_sel_hi:[1,1]
    v_pk_fma_f32 v[18:19], v[162:163], v[108:109], v[18:19] op_sel_hi:[1,0,1]
    v_cvt_pk_bf16_f32 v200, v16, v17
    v_cvt_pk_bf16_f32 v201, v18, v19
    v_pk_mul_f32 v[224:225], v[152:153], v[108:109] op_sel:[0,1] op_sel_hi:[1,1]
    v_pk_fma_f32 v[224:225], v[164:165], v[108:109], v[224:225] op_sel_hi:[1,0,1]
    v_pk_mul_f32 v[226:227], v[154:155], v[108:109] op_sel:[0,1] op_sel_hi:[1,1]
    v_pk_fma_f32 v[226:227], v[166:167], v[108:109], v[226:227] op_sel_hi:[1,0,1]
    v_cvt_pk_bf16_f32 v206, v224, v225
    v_cvt_pk_bf16_f32 v207, v226, v227
    v_pk_mul_f32 v[16:17], v[120:121], v[156:157] op_sel_hi:[1,0]
    v_pk_fma_f32 v[16:17], v[168:169], v[116:117], v[16:17]
    v_pk_mul_f32 v[18:19], v[122:123], v[156:157] op_sel_hi:[1,0]
    v_pk_fma_f32 v[18:19], v[170:171], v[118:119], v[18:19]
    v_cvt_pk_bf16_f32 v212, v16, v17
    v_cvt_pk_bf16_f32 v213, v18, v19
    v_pk_mul_f32 v[224:225], v[120:121], v[156:157] op_sel:[0,1] op_sel_hi:[1,1]
    v_pk_fma_f32 v[224:225], v[172:173], v[116:117], v[224:225]
    v_pk_mul_f32 v[226:227], v[122:123], v[156:157] op_sel:[0,1] op_sel_hi:[1,1]
    v_pk_fma_f32 v[226:227], v[174:175], v[118:119], v[226:227]
    v_cvt_pk_bf16_f32 v218, v224, v225
    v_cvt_pk_bf16_f32 v219, v226, v227
    v_mfma_f32_16x16x16_bf16 v[32:35], v[200:201], v[190:191], 0
    v_mfma_f32_16x16x16_bf16 v[36:39], v[202:203], v[190:191], 0
    v_mfma_f32_16x16x16_bf16 v[40:43], v[206:207], v[196:197], 0
    v_mfma_f32_16x16x16_bf16 v[44:47], v[208:209], v[196:197], 0
    v_mfma_f32_16x16x16_bf16 v[48:51], v[202:203], v[192:193], 0
    v_mfma_f32_16x16x16_bf16 v[52:55], v[204:205], v[192:193], 0
    v_mfma_f32_16x16x16_bf16 v[56:59], v[208:209], v[198:199], 0
    v_mfma_f32_16x16x16_bf16 v[60:63], v[210:211], v[198:199], 0
    v_mov_b32 v132, s87
    v_pk_fma_f32 v[32:33], v[32:33], v[132:133], v[232:233] op_sel_hi:[1,0,1]
    v_pk_fma_f32 v[34:35], v[34:35], v[132:133], v[234:235] op_sel_hi:[1,0,1]
    v_pk_fma_f32 v[36:37], v[36:37], v[132:133], v[228:229] op_sel_hi:[1,0,1]
    v_pk_fma_f32 v[38:39], v[38:39], v[132:133], v[230:231] op_sel_hi:[1,0,1]
    v_max3_f32 v108, v32, v33, v34
    v_max3_f32 v108, v108, v35, v36
    v_max3_f32 v108, v108, v37, v38
    v_max_f32 v108, v108, v39
    v_pk_fma_f32 v[40:41], v[40:41], v[132:133], v[232:233] op_sel_hi:[1,0,1]
    v_pk_fma_f32 v[42:43], v[42:43], v[132:133], v[234:235] op_sel_hi:[1,0,1]
    v_pk_fma_f32 v[44:45], v[44:45], v[132:133], v[228:229] op_sel_hi:[1,0,1]
    v_pk_fma_f32 v[46:47], v[46:47], v[132:133], v[230:231] op_sel_hi:[1,0,1]
    v_max3_f32 v110, v40, v41, v42
    v_max3_f32 v110, v110, v43, v44
    v_max3_f32 v110, v110, v45, v46
    v_max_f32 v110, v110, v47
    v_pk_fma_f32 v[48:49], v[48:49], v[132:133], v[232:233] op_sel_hi:[1,0,1]
    v_pk_fma_f32 v[50:51], v[50:51], v[132:133], v[234:235] op_sel_hi:[1,0,1]
    v_pk_fma_f32 v[52:53], v[52:53], v[132:133], v[228:229] op_sel_hi:[1,0,1]
    v_pk_fma_f32 v[54:55], v[54:55], v[132:133], v[230:231] op_sel_hi:[1,0,1]
    v_max3_f32 v112, v48, v49, v50
    v_max3_f32 v112, v112, v51, v52
    v_max3_f32 v112, v112, v53, v54
    v_max_f32 v112, v112, v55
    v_pk_fma_f32 v[56:57], v[56:57], v[132:133], v[232:233] op_sel_hi:[1,0,1]
    v_pk_fma_f32 v[58:59], v[58:59], v[132:133], v[234:235] op_sel_hi:[1,0,1]
    v_pk_fma_f32 v[60:61], v[60:61], v[132:133], v[228:229] op_sel_hi:[1,0,1]
    v_pk_fma_f32 v[62:63], v[62:63], v[132:133], v[230:231] op_sel_hi:[1,0,1]
    v_max3_f32 v114, v56, v57, v58
    v_max3_f32 v114, v114, v59, v60
    v_max3_f32 v114, v114, v61, v62
    v_max_f32 v114, v114, v63
    v_mov_b32 v124, v108
    v_mov_b32 v125, v110
    v_mov_b32 v126, v112
    v_mov_b32 v127, v114
    v_permlane32_swap_b32 v108, v124
    v_permlane32_swap_b32 v110, v125
    v_permlane32_swap_b32 v112, v126
    v_permlane32_swap_b32 v114, v127
    v_max_f32 v108, v108, v124
    v_max_f32 v110, v110, v125
    v_max_f32 v112, v112, v126
    v_max_f32 v114, v114, v127
    v_mov_b32 v124, v108
    v_mov_b32 v125, v110
    v_mov_b32 v126, v112
    v_mov_b32 v127, v114
    v_permlane16_swap_b32 v108, v124
    v_permlane16_swap_b32 v110, v125
    v_permlane16_swap_b32 v112, v126
    v_permlane16_swap_b32 v114, v127
    v_max_f32 v108, v108, v124
    v_max_f32 v110, v110, v125
    v_max_f32 v112, v112, v126
    v_max_f32 v114, v114, v127
    v_pk_add_f32 v[32:33], v[32:33], v[108:109] op_sel_hi:[1,0] neg_lo:[0,1] neg_hi:[0,1]
    v_pk_add_f32 v[34:35], v[34:35], v[108:109] op_sel_hi:[1,0] neg_lo:[0,1] neg_hi:[0,1]
    v_pk_add_f32 v[36:37], v[36:37], v[108:109] op_sel_hi:[1,0] neg_lo:[0,1] neg_hi:[0,1]
    v_pk_add_f32 v[38:39], v[38:39], v[108:109] op_sel_hi:[1,0] neg_lo:[0,1] neg_hi:[0,1]
    v_exp_f32 v32, v32
    v_exp_f32 v33, v33
    v_exp_f32 v34, v34
    v_exp_f32 v35, v35
    v_exp_f32 v36, v36
    v_exp_f32 v37, v37
    v_exp_f32 v38, v38
    v_exp_f32 v39, v39
    v_pk_add_f32 v[40:41], v[40:41], v[110:111] op_sel_hi:[1,0] neg_lo:[0,1] neg_hi:[0,1]
    v_pk_add_f32 v[42:43], v[42:43], v[110:111] op_sel_hi:[1,0] neg_lo:[0,1] neg_hi:[0,1]
    v_pk_add_f32 v[44:45], v[44:45], v[110:111] op_sel_hi:[1,0] neg_lo:[0,1] neg_hi:[0,1]
    v_pk_add_f32 v[46:47], v[46:47], v[110:111] op_sel_hi:[1,0] neg_lo:[0,1] neg_hi:[0,1]
    v_exp_f32 v40, v40
    v_exp_f32 v41, v41
    v_exp_f32 v42, v42
    v_exp_f32 v43, v43
    v_exp_f32 v44, v44
    v_exp_f32 v45, v45
    v_exp_f32 v46, v46
    v_exp_f32 v47, v47
    v_pk_add_f32 v[48:49], v[48:49], v[112:113] op_sel_hi:[1,0] neg_lo:[0,1] neg_hi:[0,1]
    v_pk_add_f32 v[50:51], v[50:51], v[112:113] op_sel_hi:[1,0] neg_lo:[0,1] neg_hi:[0,1]
    v_pk_add_f32 v[52:53], v[52:53], v[112:113] op_sel_hi:[1,0] neg_lo:[0,1] neg_hi:[0,1]
    v_pk_add_f32 v[54:55], v[54:55], v[112:113] op_sel_hi:[1,0] neg_lo:[0,1] neg_hi:[0,1]
    v_exp_f32 v48, v48
    v_exp_f32 v49, v49
    v_exp_f32 v50, v50
    v_exp_f32 v51, v51
    v_exp_f32 v52, v52
    v_exp_f32 v53, v53
    v_exp_f32 v54, v54
    v_exp_f32 v55, v55
    v_pk_add_f32 v[56:57], v[56:57], v[114:115] op_sel_hi:[1,0] neg_lo:[0,1] neg_hi:[0,1]
    v_pk_add_f32 v[58:59], v[58:59], v[114:115] op_sel_hi:[1,0] neg_lo:[0,1] neg_hi:[0,1]
    v_pk_add_f32 v[60:61], v[60:61], v[114:115] op_sel_hi:[1,0] neg_lo:[0,1] neg_hi:[0,1]
    v_pk_add_f32 v[62:63], v[62:63], v[114:115] op_sel_hi:[1,0] neg_lo:[0,1] neg_hi:[0,1]
    v_exp_f32 v56, v56
    v_exp_f32 v57, v57
    v_exp_f32 v58, v58
    v_exp_f32 v59, v59
    v_exp_f32 v60, v60
    v_exp_f32 v61, v61
    v_exp_f32 v62, v62
    v_exp_f32 v63, v63
    v_cvt_pk_bf16_f32 v80, v32, v33
    v_cvt_pk_bf16_f32 v81, v34, v35
    v_cvt_pk_bf16_f32 v82, v36, v37
    v_cvt_pk_bf16_f32 v83, v38, v39
    v_cvt_pk_bf16_f32 v84, v40, v41
    v_cvt_pk_bf16_f32 v85, v42, v43
    v_cvt_pk_bf16_f32 v86, v44, v45
    v_cvt_pk_bf16_f32 v87, v46, v47
    v_cvt_pk_bf16_f32 v88, v48, v49
    v_cvt_pk_bf16_f32 v89, v50, v51
    v_cvt_pk_bf16_f32 v90, v52, v53
    v_cvt_pk_bf16_f32 v91, v54, v55
    v_cvt_pk_bf16_f32 v92, v56, v57
    v_cvt_pk_bf16_f32 v93, v58, v59
    v_cvt_pk_bf16_f32 v94, v60, v61
    v_cvt_pk_bf16_f32 v95, v62, v63
    v_mfma_f32_16x16x16_bf16 v[64:67], v[212:213], v[80:81], 0
    v_mfma_f32_16x16x16_bf16 v[68:71], v[218:219], v[84:85], 0
    v_mfma_f32_16x16x16_bf16 v[72:75], v[214:215], v[88:89], 0
    v_mfma_f32_16x16x16_bf16 v[76:79], v[220:221], v[92:93], 0
    v_mfma_f32_16x16x16_bf16 v[64:67], v[214:215], v[82:83], v[64:67]
    v_mfma_f32_16x16x16_bf16 v[68:71], v[220:221], v[86:87], v[68:71]
    v_mfma_f32_16x16x16_bf16 v[72:75], v[216:217], v[90:91], v[72:75]
    v_mfma_f32_16x16x16_bf16 v[76:79], v[222:223], v[94:95], v[76:79]
    v_lshlrev_b32 v32, 16, v80
    v_and_b32 v33, 0xffff0000, v80
    v_lshlrev_b32 v34, 16, v81
    v_and_b32 v35, 0xffff0000, v81
    v_lshlrev_b32 v36, 16, v82
    v_and_b32 v37, 0xffff0000, v82
    v_lshlrev_b32 v38, 16, v83
    v_and_b32 v39, 0xffff0000, v83
    v_pk_add_f32 v[32:33], v[32:33], v[34:35]
    v_pk_add_f32 v[36:37], v[36:37], v[38:39]
    v_pk_add_f32 v[32:33], v[32:33], v[36:37]
    v_add_f32 v116, v32, v33
    v_lshlrev_b32 v40, 16, v84
    v_and_b32 v41, 0xffff0000, v84
    v_lshlrev_b32 v42, 16, v85
    v_and_b32 v43, 0xffff0000, v85
    v_lshlrev_b32 v44, 16, v86
    v_and_b32 v45, 0xffff0000, v86
    v_lshlrev_b32 v46, 16, v87
    v_and_b32 v47, 0xffff0000, v87
    v_pk_add_f32 v[40:41], v[40:41], v[42:43]
    v_pk_add_f32 v[44:45], v[44:45], v[46:47]
    v_pk_add_f32 v[40:41], v[40:41], v[44:45]
    v_add_f32 v118, v40, v41
    v_lshlrev_b32 v48, 16, v88
    v_and_b32 v49, 0xffff0000, v88
    v_lshlrev_b32 v50, 16, v89
    v_and_b32 v51, 0xffff0000, v89
    v_lshlrev_b32 v52, 16, v90
    v_and_b32 v53, 0xffff0000, v90
    v_lshlrev_b32 v54, 16, v91
    v_and_b32 v55, 0xffff0000, v91
    v_pk_add_f32 v[48:49], v[48:49], v[50:51]
    v_pk_add_f32 v[52:53], v[52:53], v[54:55]
    v_pk_add_f32 v[48:49], v[48:49], v[52:53]
    v_add_f32 v120, v48, v49
    v_lshlrev_b32 v56, 16, v92
    v_and_b32 v57, 0xffff0000, v92
    v_lshlrev_b32 v58, 16, v93
    v_and_b32 v59, 0xffff0000, v93
    v_lshlrev_b32 v60, 16, v94
    v_and_b32 v61, 0xffff0000, v94
    v_lshlrev_b32 v62, 16, v95
    v_and_b32 v63, 0xffff0000, v95
    v_pk_add_f32 v[56:57], v[56:57], v[58:59]
    v_pk_add_f32 v[60:61], v[60:61], v[62:63]
    v_pk_add_f32 v[56:57], v[56:57], v[60:61]
    v_add_f32 v122, v56, v57
    v_mov_b32 v124, v116
    v_mov_b32 v125, v118
    v_mov_b32 v126, v120
    v_mov_b32 v127, v122
    v_permlane32_swap_b32 v116, v124
    v_permlane32_swap_b32 v118, v125
    v_permlane32_swap_b32 v120, v126
    v_permlane32_swap_b32 v122, v127
    v_add_f32 v116, v116, v124
    v_add_f32 v118, v118, v125
    v_add_f32 v120, v120, v126
    v_add_f32 v122, v122, v127
    v_mov_b32 v124, v116
    v_mov_b32 v125, v118
    v_mov_b32 v126, v120
    v_mov_b32 v127, v122
    v_permlane16_swap_b32 v116, v124
    v_permlane16_swap_b32 v118, v125
    v_permlane16_swap_b32 v120, v126
    v_permlane16_swap_b32 v122, v127
    v_add_f32 v116, v116, v124
    v_add_f32 v118, v118, v125
    v_add_f32 v120, v120, v126
    v_add_f32 v122, v122, v127
    v_rcp_f32 v116, v116
    v_rcp_f32 v118, v118
    v_rcp_f32 v120, v120
    v_rcp_f32 v122, v122
    v_pk_mul_f32 v[64:65], v[64:65], v[116:117] op_sel_hi:[1,0]
    v_pk_mul_f32 v[66:67], v[66:67], v[116:117] op_sel_hi:[1,0]
    v_pk_mul_f32 v[68:69], v[68:69], v[118:119] op_sel_hi:[1,0]
    v_pk_mul_f32 v[70:71], v[70:71], v[118:119] op_sel_hi:[1,0]
    v_pk_mul_f32 v[72:73], v[72:73], v[120:121] op_sel_hi:[1,0]
    v_pk_mul_f32 v[74:75], v[74:75], v[120:121] op_sel_hi:[1,0]
    v_pk_mul_f32 v[76:77], v[76:77], v[122:123] op_sel_hi:[1,0]
    v_pk_mul_f32 v[78:79], v[78:79], v[122:123] op_sel_hi:[1,0]
    s_lshl_b32 s38, s29, 17
    s_lshl_b32 s39, s43, 10
    s_add_u32 s38, s38, s39
    s_add_u32 s38, s38, 98304
    s_add_u32 s39, s38, 16384
    v_cvt_pk_bf16_f32 v96, v64, v65
    v_cvt_pk_bf16_f32 v97, v66, v67
    v_cvt_pk_bf16_f32 v98, v68, v69
    v_cvt_pk_bf16_f32 v99, v70, v71
    v_cvt_pk_bf16_f32 v100, v72, v73
    v_cvt_pk_bf16_f32 v101, v74, v75
    v_cvt_pk_bf16_f32 v102, v76, v77
    v_cvt_pk_bf16_f32 v103, v78, v79
    buffer_store_dwordx4 v[96:99], v1, s[4:7], s38 offen sc1
    buffer_store_dwordx4 v[100:103], v1, s[4:7], s39 offen sc1
    s_nop 1
L_sequential_preLN__sliding_local_dilated__geglu_ffn__prompt_kernel_p1join:
    s_lshl_b32 s40, s25, 8
    s_or_b32 s40, s40, s24
    s_and_b32 s24, s40, 7
    s_bfe_u32 s25, s40, 0x50008
    s_lshr_b32 s28, s25, 3
    s_and_b32 s93, s25, 7
    s_lshl_b32 s92, s24, 2
    s_add_u32 s92, s92, s28
    s_and_b32 s94, s24, 4
    s_add_u32 s94, s94, s28
    s_and_b32 s95, s24, 3
    s_lshl_b32 s95, s95, 3
    s_add_u32 s95, s95, s93
    s_and_b32 s30, s26, 1
    s_lshr_b32 s31, s26, 1
    s_lshl_b32 s29, s92, 2
    s_lshl_b32 s32, s30, 1
    s_add_u32 s29, s29, s32
    s_add_u32 s33, s29, s31
    s_xor_b32 s32, s31, 1
    s_add_u32 s34, s29, s32
    s_mov_b32 s29, s33
    v_bfe_u32 v8, v4, 2, 2
    v_lshl_add_u32 v9, v5, 2, v8
    v_lshlrev_b32 v9, 7, v9
    v_and_b32 v10, 3, v4
    v_lshrrev_b32 v8, 1, v8
    v_and_b32 v11, 1, v5
    v_lshl_add_u32 v8, v11, 1, v8
    v_lshl_add_u32 v12, v10, 3, v9
    s_lshl_b32 s36, s31, 12
    v_add_u32 v12, s36, v12
    v_xor_b32 v11, 0, v8
    v_lshl_add_u32 v248, v11, 5, v12
    v_xor_b32 v11, 1, v8
    v_lshl_add_u32 v249, v11, 5, v12
    v_xor_b32 v11, 2, v8
    v_lshl_add_u32 v250, v11, 5, v12
    v_xor_b32 v11, 3, v8
    v_lshl_add_u32 v251, v11, 5, v12
    s_waitcnt vmcnt(0)
    s_barrier
    ds_read_b64_tr_b16 v[112:113], v248 offset:0
    ds_read_b64_tr_b16 v[114:115], v248 offset:2048
    ds_read_b64_tr_b16 v[116:117], v249 offset:0
    ds_read_b64_tr_b16 v[118:119], v249 offset:2048
    ds_read_b64_tr_b16 v[120:121], v250 offset:0
    ds_read_b64_tr_b16 v[122:123], v250 offset:2048
    ds_read_b64_tr_b16 v[124:125], v251 offset:0
    ds_read_b64_tr_b16 v[126:127], v251 offset:2048
    ds_read_b64_tr_b16 v[128:129], v248 offset:8192
    ds_read_b64_tr_b16 v[130:131], v248 offset:10240
    ds_read_b64_tr_b16 v[132:133], v249 offset:8192
    ds_read_b64_tr_b16 v[134:135], v249 offset:10240
    ds_read_b64_tr_b16 v[136:137], v250 offset:8192
    ds_read_b64_tr_b16 v[138:139], v250 offset:10240
    ds_read_b64_tr_b16 v[140:141], v251 offset:8192
    ds_read_b64_tr_b16 v[142:143], v251 offset:10240
    ds_read_b64_tr_b16 v[144:145], v248 offset:16384
    ds_read_b64_tr_b16 v[146:147], v248 offset:18432
    ds_read_b64_tr_b16 v[148:149], v249 offset:16384
    ds_read_b64_tr_b16 v[150:151], v249 offset:18432
    ds_read_b64_tr_b16 v[152:153], v250 offset:16384
    ds_read_b64_tr_b16 v[154:155], v250 offset:18432
    ds_read_b64_tr_b16 v[156:157], v251 offset:16384
    ds_read_b64_tr_b16 v[158:159], v251 offset:18432
    ds_read_b64_tr_b16 v[160:161], v248 offset:24576
    ds_read_b64_tr_b16 v[162:163], v248 offset:26624
    ds_read_b64_tr_b16 v[164:165], v249 offset:24576
    ds_read_b64_tr_b16 v[166:167], v249 offset:26624
    ds_read_b64_tr_b16 v[168:169], v250 offset:24576
    ds_read_b64_tr_b16 v[170:171], v250 offset:26624
    ds_read_b64_tr_b16 v[172:173], v251 offset:24576
    ds_read_b64_tr_b16 v[174:175], v251 offset:26624
    ds_read_b64_tr_b16 v[176:177], v248 offset:32768
    ds_read_b64_tr_b16 v[178:179], v248 offset:34816
    ds_read_b64_tr_b16 v[180:181], v249 offset:32768
    ds_read_b64_tr_b16 v[182:183], v249 offset:34816
    ds_read_b64_tr_b16 v[184:185], v250 offset:32768
    ds_read_b64_tr_b16 v[186:187], v250 offset:34816
    ds_read_b64_tr_b16 v[188:189], v251 offset:32768
    ds_read_b64_tr_b16 v[190:191], v251 offset:34816
    ds_read_b64_tr_b16 v[192:193], v248 offset:40960
    ds_read_b64_tr_b16 v[194:195], v248 offset:43008
    ds_read_b64_tr_b16 v[196:197], v249 offset:40960
    ds_read_b64_tr_b16 v[198:199], v249 offset:43008
    ds_read_b64_tr_b16 v[200:201], v250 offset:40960
    ds_read_b64_tr_b16 v[202:203], v250 offset:43008
    ds_read_b64_tr_b16 v[204:205], v251 offset:40960
    ds_read_b64_tr_b16 v[206:207], v251 offset:43008
    ds_read_b64_tr_b16 v[208:209], v248 offset:49152
    ds_read_b64_tr_b16 v[210:211], v248 offset:51200
    ds_read_b64_tr_b16 v[212:213], v249 offset:49152
    ds_read_b64_tr_b16 v[214:215], v249 offset:51200
    ds_read_b64_tr_b16 v[216:217], v250 offset:49152
    ds_read_b64_tr_b16 v[218:219], v250 offset:51200
    ds_read_b64_tr_b16 v[220:221], v251 offset:49152
    ds_read_b64_tr_b16 v[222:223], v251 offset:51200
    ds_read_b64_tr_b16 v[224:225], v248 offset:57344
    ds_read_b64_tr_b16 v[226:227], v248 offset:59392
    ds_read_b64_tr_b16 v[228:229], v249 offset:57344
    ds_read_b64_tr_b16 v[230:231], v249 offset:59392
    ds_read_b64_tr_b16 v[232:233], v250 offset:57344
    ds_read_b64_tr_b16 v[234:235], v250 offset:59392
    ds_read_b64_tr_b16 v[236:237], v251 offset:57344
    ds_read_b64_tr_b16 v[238:239], v251 offset:59392
    v_mov_b32 v16, 0
    v_mov_b32 v17, 0
    v_mov_b32 v18, 0
    v_mov_b32 v19, 0
    v_mov_b32 v20, 0
    v_mov_b32 v21, 0
    v_mov_b32 v22, 0
    v_mov_b32 v23, 0
    v_mov_b32 v24, 0
    v_mov_b32 v25, 0
    v_mov_b32 v26, 0
    v_mov_b32 v27, 0
    v_mov_b32 v28, 0
    v_mov_b32 v29, 0
    v_mov_b32 v30, 0
    v_mov_b32 v31, 0
    v_mov_b32 v32, 0
    v_mov_b32 v33, 0
    v_mov_b32 v34, 0
    v_mov_b32 v35, 0
    v_mov_b32 v36, 0
    v_mov_b32 v37, 0
    v_mov_b32 v38, 0
    v_mov_b32 v39, 0
    v_mov_b32 v40, 0
    v_mov_b32 v41, 0
    v_mov_b32 v42, 0
    v_mov_b32 v43, 0
    v_mov_b32 v44, 0
    v_mov_b32 v45, 0
    v_mov_b32 v46, 0
    v_mov_b32 v47, 0
    v_lshlrev_b32 v7, 10, v6
    v_lshl_add_u32 v7, v5, 3, v7
    s_lshl_b32 s32, s29, 14
    s_lshl_b32 s35, s93, 7
    s_add_u32 s32, s32, s35
    s_lshl_b32 s37, s31, 10
    s_lshl_b32 s33, s33, 14
    s_lshl_b32 s34, s34, 14
    s_add_u32 s35, s33, 2097152
    s_lshl_b32 s36, s93, 11
    s_add_u32 s35, s35, s36
    s_add_u32 s33, s33, s37
    s_add_u32 s34, s34, s37
    s_waitcnt lgkmcnt(0)
    s_barrier
    buffer_load_dwordx2 v[240:241], v7, s[8:11], s32 offen offset:0
    buffer_load_dwordx2 v[242:243], v7, s[8:11], s32 offen offset:32
    buffer_load_dwordx2 v[244:245], v7, s[8:11], s32 offen offset:64
    buffer_load_dwordx2 v[246:247], v7, s[8:11], s32 offen offset:96
    v_mov_b32 v14, 163584
    s_nop 1
L_sequential_preLN__sliding_local_dilated__geglu_ffn__prompt_kernel_cf1:
    ds_read_b32 v15, v14 offset:68
    s_waitcnt lgkmcnt(0)
    v_readfirstlane_b32 s40, v15
    s_nop 1
    s_cmp_lt_u32 s40, 1
    s_nop 1
    s_cbranch_scc1 L_sequential_preLN__sliding_local_dilated__geglu_ffn__prompt_kernel_cf1
    buffer_load_dwordx4 v[48:51], v1, s[4:7], s33 offen offset:0 sc1
    buffer_load_dwordx4 v[52:55], v1, s[4:7], s34 offen offset:0 sc1
    buffer_load_dwordx4 v[56:59], v1, s[4:7], s33 offen offset:2048 sc1
    buffer_load_dwordx4 v[60:63], v1, s[4:7], s34 offen offset:2048 sc1
    s_add_u32 s33, s33, 4096
    buffer_load_dwordx4 v[64:67], v1, s[4:7], s33 offen offset:0 sc1
    s_add_u32 s34, s34, 4096
    buffer_load_dwordx4 v[68:71], v1, s[4:7], s34 offen offset:0 sc1
    buffer_load_dwordx4 v[72:75], v1, s[4:7], s33 offen offset:2048 sc1
    buffer_load_dwordx4 v[76:79], v1, s[4:7], s34 offen offset:2048 sc1
    s_add_u32 s33, s33, 4096
    buffer_load_dwordx4 v[80:83], v1, s[4:7], s33 offen offset:0 sc1
    s_add_u32 s34, s34, 4096
    buffer_load_dwordx4 v[84:87], v1, s[4:7], s34 offen offset:0 sc1
    buffer_load_dwordx4 v[88:91], v1, s[4:7], s33 offen offset:2048 sc1
    buffer_load_dwordx4 v[92:95], v1, s[4:7], s34 offen offset:2048 sc1
    s_add_u32 s33, s33, 4096
    buffer_load_dwordx4 v[96:99], v1, s[4:7], s33 offen offset:0 sc1
    s_add_u32 s34, s34, 4096
    buffer_load_dwordx4 v[100:103], v1, s[4:7], s34 offen offset:0 sc1
    buffer_load_dwordx4 v[104:107], v1, s[4:7], s33 offen offset:2048 sc1
    buffer_load_dwordx4 v[108:111], v1, s[4:7], s34 offen offset:2048 sc1
    s_waitcnt vmcnt(14)
    v_mfma_f32_16x16x32_bf16 v[32:35], v[112:115], v[52:55], v[32:35]
    v_mfma_f32_16x16x32_bf16 v[36:39], v[116:119], v[52:55], v[36:39]
    v_mfma_f32_16x16x32_bf16 v[40:43], v[120:123], v[52:55], v[40:43]
    v_mfma_f32_16x16x32_bf16 v[44:47], v[124:127], v[52:55], v[44:47]
    v_mfma_f32_16x16x32_bf16 v[16:19], v[112:115], v[48:51], v[16:19]
    v_mfma_f32_16x16x32_bf16 v[20:23], v[116:119], v[48:51], v[20:23]
    v_mfma_f32_16x16x32_bf16 v[24:27], v[120:123], v[48:51], v[24:27]
    v_mfma_f32_16x16x32_bf16 v[28:31], v[124:127], v[48:51], v[28:31]
    s_waitcnt vmcnt(12)
    v_mfma_f32_16x16x32_bf16 v[32:35], v[128:131], v[60:63], v[32:35]
    v_mfma_f32_16x16x32_bf16 v[36:39], v[132:135], v[60:63], v[36:39]
    v_mfma_f32_16x16x32_bf16 v[40:43], v[136:139], v[60:63], v[40:43]
    v_mfma_f32_16x16x32_bf16 v[44:47], v[140:143], v[60:63], v[44:47]
    v_mfma_f32_16x16x32_bf16 v[16:19], v[128:131], v[56:59], v[16:19]
    v_mfma_f32_16x16x32_bf16 v[20:23], v[132:135], v[56:59], v[20:23]
    v_mfma_f32_16x16x32_bf16 v[24:27], v[136:139], v[56:59], v[24:27]
    v_mfma_f32_16x16x32_bf16 v[28:31], v[140:143], v[56:59], v[28:31]
    s_waitcnt vmcnt(10)
    v_mfma_f32_16x16x32_bf16 v[32:35], v[144:147], v[68:71], v[32:35]
    v_mfma_f32_16x16x32_bf16 v[36:39], v[148:151], v[68:71], v[36:39]
    v_mfma_f32_16x16x32_bf16 v[40:43], v[152:155], v[68:71], v[40:43]
    v_mfma_f32_16x16x32_bf16 v[44:47], v[156:159], v[68:71], v[44:47]
    v_mfma_f32_16x16x32_bf16 v[16:19], v[144:147], v[64:67], v[16:19]
    v_mfma_f32_16x16x32_bf16 v[20:23], v[148:151], v[64:67], v[20:23]
    v_mfma_f32_16x16x32_bf16 v[24:27], v[152:155], v[64:67], v[24:27]
    v_mfma_f32_16x16x32_bf16 v[28:31], v[156:159], v[64:67], v[28:31]
    s_waitcnt vmcnt(8)
    v_mfma_f32_16x16x32_bf16 v[32:35], v[160:163], v[76:79], v[32:35]
    v_mfma_f32_16x16x32_bf16 v[36:39], v[164:167], v[76:79], v[36:39]
    v_mfma_f32_16x16x32_bf16 v[40:43], v[168:171], v[76:79], v[40:43]
    v_mfma_f32_16x16x32_bf16 v[44:47], v[172:175], v[76:79], v[44:47]
    v_mfma_f32_16x16x32_bf16 v[16:19], v[160:163], v[72:75], v[16:19]
    v_mfma_f32_16x16x32_bf16 v[20:23], v[164:167], v[72:75], v[20:23]
    v_mfma_f32_16x16x32_bf16 v[24:27], v[168:171], v[72:75], v[24:27]
    v_mfma_f32_16x16x32_bf16 v[28:31], v[172:175], v[72:75], v[28:31]
    s_waitcnt vmcnt(6)
    v_mfma_f32_16x16x32_bf16 v[32:35], v[176:179], v[84:87], v[32:35]
    v_mfma_f32_16x16x32_bf16 v[36:39], v[180:183], v[84:87], v[36:39]
    v_mfma_f32_16x16x32_bf16 v[40:43], v[184:187], v[84:87], v[40:43]
    v_mfma_f32_16x16x32_bf16 v[44:47], v[188:191], v[84:87], v[44:47]
    v_mfma_f32_16x16x32_bf16 v[16:19], v[176:179], v[80:83], v[16:19]
    v_mfma_f32_16x16x32_bf16 v[20:23], v[180:183], v[80:83], v[20:23]
    v_mfma_f32_16x16x32_bf16 v[24:27], v[184:187], v[80:83], v[24:27]
    v_mfma_f32_16x16x32_bf16 v[28:31], v[188:191], v[80:83], v[28:31]
    s_waitcnt vmcnt(4)
    v_mfma_f32_16x16x32_bf16 v[32:35], v[192:195], v[92:95], v[32:35]
    v_mfma_f32_16x16x32_bf16 v[36:39], v[196:199], v[92:95], v[36:39]
    v_mfma_f32_16x16x32_bf16 v[40:43], v[200:203], v[92:95], v[40:43]
    v_mfma_f32_16x16x32_bf16 v[44:47], v[204:207], v[92:95], v[44:47]
    v_mfma_f32_16x16x32_bf16 v[16:19], v[192:195], v[88:91], v[16:19]
    v_mfma_f32_16x16x32_bf16 v[20:23], v[196:199], v[88:91], v[20:23]
    v_mfma_f32_16x16x32_bf16 v[24:27], v[200:203], v[88:91], v[24:27]
    v_mfma_f32_16x16x32_bf16 v[28:31], v[204:207], v[88:91], v[28:31]
    s_waitcnt vmcnt(2)
    v_mfma_f32_16x16x32_bf16 v[32:35], v[208:211], v[100:103], v[32:35]
    v_mfma_f32_16x16x32_bf16 v[36:39], v[212:215], v[100:103], v[36:39]
    v_mfma_f32_16x16x32_bf16 v[40:43], v[216:219], v[100:103], v[40:43]
    v_mfma_f32_16x16x32_bf16 v[44:47], v[220:223], v[100:103], v[44:47]
    v_mfma_f32_16x16x32_bf16 v[16:19], v[208:211], v[96:99], v[16:19]
    v_mfma_f32_16x16x32_bf16 v[20:23], v[212:215], v[96:99], v[20:23]
    v_mfma_f32_16x16x32_bf16 v[24:27], v[216:219], v[96:99], v[24:27]
    v_mfma_f32_16x16x32_bf16 v[28:31], v[220:223], v[96:99], v[28:31]
    s_waitcnt vmcnt(0)
    v_mfma_f32_16x16x32_bf16 v[32:35], v[224:227], v[108:111], v[32:35]
    v_mfma_f32_16x16x32_bf16 v[36:39], v[228:231], v[108:111], v[36:39]
    v_mfma_f32_16x16x32_bf16 v[40:43], v[232:235], v[108:111], v[40:43]
    v_mfma_f32_16x16x32_bf16 v[44:47], v[236:239], v[108:111], v[44:47]
    v_mfma_f32_16x16x32_bf16 v[16:19], v[224:227], v[104:107], v[16:19]
    v_mfma_f32_16x16x32_bf16 v[20:23], v[228:231], v[104:107], v[20:23]
    v_mfma_f32_16x16x32_bf16 v[24:27], v[232:235], v[104:107], v[24:27]
    v_mfma_f32_16x16x32_bf16 v[28:31], v[236:239], v[104:107], v[28:31]
    s_xor_b32 s36, s26, 2
    s_lshl_b32 s36, s36, 12
    s_add_u32 s36, s36, 131328
    v_add_u32 v14, s36, v1
    s_lshl_b32 s36, s26, 12
    s_add_u32 s36, s36, 131328
    v_add_u32 v15, s36, v1
    ds_write_b128 v14, v[32:35] offset:0
    ds_write_b128 v14, v[36:39] offset:1024
    ds_write_b128 v14, v[40:43] offset:2048
    ds_write_b128 v14, v[44:47] offset:3072
    s_waitcnt lgkmcnt(0)
    s_barrier
    ds_read_b128 v[32:35], v15 offset:0
    ds_read_b128 v[36:39], v15 offset:1024
    ds_read_b128 v[40:43], v15 offset:2048
    ds_read_b128 v[44:47], v15 offset:3072
    v_lshlrev_b32 v48, 16, v240
    v_and_b32 v49, 0xffff0000, v240
    v_lshlrev_b32 v50, 16, v241
    v_and_b32 v51, 0xffff0000, v241
    v_lshlrev_b32 v52, 16, v242
    v_and_b32 v53, 0xffff0000, v242
    v_lshlrev_b32 v54, 16, v243
    v_and_b32 v55, 0xffff0000, v243
    v_lshlrev_b32 v56, 16, v244
    v_and_b32 v57, 0xffff0000, v244
    v_lshlrev_b32 v58, 16, v245
    v_and_b32 v59, 0xffff0000, v245
    v_lshlrev_b32 v60, 16, v246
    v_and_b32 v61, 0xffff0000, v246
    v_lshlrev_b32 v62, 16, v247
    v_and_b32 v63, 0xffff0000, v247
    v_pk_add_f32 v[16:17], v[16:17], v[48:49]
    v_pk_add_f32 v[18:19], v[18:19], v[50:51]
    v_pk_add_f32 v[20:21], v[20:21], v[52:53]
    v_pk_add_f32 v[22:23], v[22:23], v[54:55]
    v_pk_add_f32 v[24:25], v[24:25], v[56:57]
    v_pk_add_f32 v[26:27], v[26:27], v[58:59]
    v_pk_add_f32 v[28:29], v[28:29], v[60:61]
    v_pk_add_f32 v[30:31], v[30:31], v[62:63]
    s_waitcnt lgkmcnt(0)
    v_pk_add_f32 v[16:17], v[16:17], v[32:33]
    v_pk_add_f32 v[18:19], v[18:19], v[34:35]
    v_pk_add_f32 v[20:21], v[20:21], v[36:37]
    v_pk_add_f32 v[22:23], v[22:23], v[38:39]
    v_pk_add_f32 v[24:25], v[24:25], v[40:41]
    v_pk_add_f32 v[26:27], v[26:27], v[42:43]
    v_pk_add_f32 v[28:29], v[28:29], v[44:45]
    v_pk_add_f32 v[30:31], v[30:31], v[46:47]
    v_cvt_pk_bf16_f32 v64, v16, v17
    v_cvt_pk_bf16_f32 v65, v18, v19
    v_cvt_pk_bf16_f32 v66, v20, v21
    v_cvt_pk_bf16_f32 v67, v22, v23
    v_cvt_pk_bf16_f32 v68, v24, v25
    v_cvt_pk_bf16_f32 v69, v26, v27
    v_cvt_pk_bf16_f32 v70, v28, v29
    v_cvt_pk_bf16_f32 v71, v30, v31
    buffer_store_dwordx4 v[64:67], v1, s[4:7], s35 offen offset:0 sc1
    buffer_store_dwordx4 v[68:71], v1, s[4:7], s35 offen offset:1024 sc1
    v_lshlrev_b32 v48, 16, v64
    v_and_b32 v49, 0xffff0000, v64
    v_lshlrev_b32 v50, 16, v65
    v_and_b32 v51, 0xffff0000, v65
    v_lshlrev_b32 v52, 16, v66
    v_and_b32 v53, 0xffff0000, v66
    v_lshlrev_b32 v54, 16, v67
    v_and_b32 v55, 0xffff0000, v67
    v_lshlrev_b32 v56, 16, v68
    v_and_b32 v57, 0xffff0000, v68
    v_lshlrev_b32 v58, 16, v69
    v_and_b32 v59, 0xffff0000, v69
    v_lshlrev_b32 v60, 16, v70
    v_and_b32 v61, 0xffff0000, v70
    v_lshlrev_b32 v62, 16, v71
    v_and_b32 v63, 0xffff0000, v71
    v_add_f32 v72, v48, v49
    v_mul_f32 v73, v48, v48
    v_fmac_f32 v73, v49, v49
    v_add_f32 v72, v72, v50
    v_fmac_f32 v73, v50, v50
    v_add_f32 v72, v72, v51
    v_fmac_f32 v73, v51, v51
    v_add_f32 v72, v72, v52
    v_fmac_f32 v73, v52, v52
    v_add_f32 v72, v72, v53
    v_fmac_f32 v73, v53, v53
    v_add_f32 v72, v72, v54
    v_fmac_f32 v73, v54, v54
    v_add_f32 v72, v72, v55
    v_fmac_f32 v73, v55, v55
    v_add_f32 v72, v72, v56
    v_fmac_f32 v73, v56, v56
    v_add_f32 v72, v72, v57
    v_fmac_f32 v73, v57, v57
    v_add_f32 v72, v72, v58
    v_fmac_f32 v73, v58, v58
    v_add_f32 v72, v72, v59
    v_fmac_f32 v73, v59, v59
    v_add_f32 v72, v72, v60
    v_fmac_f32 v73, v60, v60
    v_add_f32 v72, v72, v61
    v_fmac_f32 v73, v61, v61
    v_add_f32 v72, v72, v62
    v_fmac_f32 v73, v62, v62
    v_add_f32 v72, v72, v63
    v_fmac_f32 v73, v63, v63
    v_mov_b32 v74, v72
    v_mov_b32 v75, v73
    s_nop 0
    v_permlane32_swap_b32 v72, v74
    v_permlane32_swap_b32 v73, v75
    v_add_f32 v72, v72, v74
    v_add_f32 v73, v73, v75
    v_mov_b32 v74, v72
    v_mov_b32 v75, v73
    s_nop 0
    v_permlane16_swap_b32 v72, v74
    v_permlane16_swap_b32 v73, v75
    v_add_f32 v72, v72, v74
    v_add_f32 v73, v73, v75
    v_lshlrev_b32 v14, 3, v6
    s_lshl_b32 s39, s29, 10
    s_lshl_b32 s40, s93, 7
    s_add_u32 s39, s39, s40
    s_add_u32 s39, s39, 12582912
    s_mov_b64 exec, 0xffff
    buffer_store_dwordx2 v[72:73], v14, s[4:7], s39 offen sc1
    s_mov_b64 exec, -1
    s_waitcnt vmcnt(0)
    s_barrier
    v_bfe_u32 v8, v4, 2, 2
    v_lshl_add_u32 v9, v5, 2, v8
    v_lshlrev_b32 v9, 7, v9
    v_and_b32 v10, 3, v4
    v_lshrrev_b32 v8, 1, v8
    v_and_b32 v11, 1, v5
    v_lshl_add_u32 v8, v11, 1, v8
    v_lshl_add_u32 v12, v10, 3, v9
    v_xor_b32 v11, 0, v8
    v_lshl_add_u32 v243, v11, 5, v12
    v_add_u32 v240, 65552, v243
    v_xor_b32 v11, 1, v8
    v_lshl_add_u32 v244, v11, 5, v12
    v_add_u32 v241, 65552, v244
    v_xor_b32 v11, 2, v8
    v_lshl_add_u32 v245, v11, 5, v12
    v_add_u32 v242, 65552, v245
    v_xor_b32 v11, 3, v8
    v_lshl_add_u32 v12, v11, 5, v9
    v_and_b32 v11, 1, v10
    v_lshl_add_u32 v12, v11, 3, v12
    v_lshrrev_b32 v11, 1, v10
    v_xor_b32 v11, 1, v11
    v_mul_u32_u24 v11, 65552, v11
    v_add_u32 v246, v11, v12
    v_mov_b32 v7, v240
    v_mov_b32 v8, v241
    v_mov_b32 v9, v242
    v_mov_b32 v10, v243
    v_mov_b32 v11, v244
    v_mov_b32 v12, v245
    v_mov_b32 v13, v246
    v_mov_b32 v14, v7
    v_mov_b32 v15, v11
    s_cmp_eq_u32 s26, 1
    s_cselect_b64 vcc, -1, 0
    v_cndmask_b32 v14, v14, v8, vcc
    v_cndmask_b32 v15, v15, v12, vcc
    s_cmp_eq_u32 s26, 2
    s_cselect_b64 vcc, -1, 0
    v_cndmask_b32 v14, v14, v9, vcc
    v_cndmask_b32 v15, v15, v13, vcc
    s_cmp_eq_u32 s26, 3
    s_cselect_b64 vcc, -1, 0
    v_cndmask_b32 v14, v14, v10, vcc
    v_cndmask_b32 v15, v15, v13, vcc
    ds_read_b64_tr_b16 v[112:113], v14 offset:0
    ds_read_b64_tr_b16 v[114:115], v14 offset:2048
    ds_read_b64_tr_b16 v[116:117], v15 offset:0
    ds_read_b64_tr_b16 v[118:119], v15 offset:2048
    ds_read_b64_tr_b16 v[120:121], v14 offset:4096
    ds_read_b64_tr_b16 v[122:123], v14 offset:6144
    ds_read_b64_tr_b16 v[124:125], v15 offset:4096
    ds_read_b64_tr_b16 v[126:127], v15 offset:6144
    ds_read_b64_tr_b16 v[128:129], v14 offset:8192
    ds_read_b64_tr_b16 v[130:131], v14 offset:10240
    ds_read_b64_tr_b16 v[132:133], v15 offset:8192
    ds_read_b64_tr_b16 v[134:135], v15 offset:10240
    ds_read_b64_tr_b16 v[136:137], v14 offset:12288
    ds_read_b64_tr_b16 v[138:139], v14 offset:14336
    ds_read_b64_tr_b16 v[140:141], v15 offset:12288
    ds_read_b64_tr_b16 v[142:143], v15 offset:14336
    ds_read_b64_tr_b16 v[144:145], v14 offset:16384
    ds_read_b64_tr_b16 v[146:147], v14 offset:18432
    ds_read_b64_tr_b16 v[148:149], v15 offset:16384
    ds_read_b64_tr_b16 v[150:151], v15 offset:18432
    ds_read_b64_tr_b16 v[152:153], v14 offset:20480
    ds_read_b64_tr_b16 v[154:155], v14 offset:22528
    ds_read_b64_tr_b16 v[156:157], v15 offset:20480
    ds_read_b64_tr_b16 v[158:159], v15 offset:22528
    ds_read_b64_tr_b16 v[160:161], v14 offset:24576
    ds_read_b64_tr_b16 v[162:163], v14 offset:26624
    ds_read_b64_tr_b16 v[164:165], v15 offset:24576
    ds_read_b64_tr_b16 v[166:167], v15 offset:26624
    ds_read_b64_tr_b16 v[168:169], v14 offset:28672
    ds_read_b64_tr_b16 v[170:171], v14 offset:30720
    ds_read_b64_tr_b16 v[172:173], v15 offset:28672
    ds_read_b64_tr_b16 v[174:175], v15 offset:30720
    ds_read_b64_tr_b16 v[176:177], v14 offset:32768
    ds_read_b64_tr_b16 v[178:179], v14 offset:34816
    ds_read_b64_tr_b16 v[180:181], v15 offset:32768
    ds_read_b64_tr_b16 v[182:183], v15 offset:34816
    ds_read_b64_tr_b16 v[184:185], v14 offset:36864
    ds_read_b64_tr_b16 v[186:187], v14 offset:38912
    ds_read_b64_tr_b16 v[188:189], v15 offset:36864
    ds_read_b64_tr_b16 v[190:191], v15 offset:38912
    ds_read_b64_tr_b16 v[192:193], v14 offset:40960
    ds_read_b64_tr_b16 v[194:195], v14 offset:43008
    ds_read_b64_tr_b16 v[196:197], v15 offset:40960
    ds_read_b64_tr_b16 v[198:199], v15 offset:43008
    ds_read_b64_tr_b16 v[200:201], v14 offset:45056
    ds_read_b64_tr_b16 v[202:203], v14 offset:47104
    ds_read_b64_tr_b16 v[204:205], v15 offset:45056
    ds_read_b64_tr_b16 v[206:207], v15 offset:47104
    ds_read_b64_tr_b16 v[208:209], v14 offset:49152
    ds_read_b64_tr_b16 v[210:211], v14 offset:51200
    ds_read_b64_tr_b16 v[212:213], v15 offset:49152
    ds_read_b64_tr_b16 v[214:215], v15 offset:51200
    ds_read_b64_tr_b16 v[216:217], v14 offset:53248
    ds_read_b64_tr_b16 v[218:219], v14 offset:55296
    ds_read_b64_tr_b16 v[220:221], v15 offset:53248
    ds_read_b64_tr_b16 v[222:223], v15 offset:55296
    ds_read_b64_tr_b16 v[224:225], v14 offset:57344
    ds_read_b64_tr_b16 v[226:227], v14 offset:59392
    ds_read_b64_tr_b16 v[228:229], v15 offset:57344
    ds_read_b64_tr_b16 v[230:231], v15 offset:59392
    ds_read_b64_tr_b16 v[232:233], v14 offset:61440
    ds_read_b64_tr_b16 v[234:235], v14 offset:63488
    ds_read_b64_tr_b16 v[236:237], v15 offset:61440
    ds_read_b64_tr_b16 v[238:239], v15 offset:63488
    v_mov_b32 v16, 0
    v_mov_b32 v17, 0
    v_mov_b32 v18, 0
    v_mov_b32 v19, 0
    v_mov_b32 v20, 0
    v_mov_b32 v21, 0
    v_mov_b32 v22, 0
    v_mov_b32 v23, 0
    v_mov_b32 v24, 0x3f803f80
    v_mov_b32 v25, 0x3f803f80
    v_mov_b32 v26, 0x3f803f80
    v_mov_b32 v27, 0x3f803f80
    s_waitcnt lgkmcnt(0)
    s_nop 0
    v_mfma_f32_16x16x32_bf16 v[16:19], v[112:115], v[24:27], v[16:19]
    v_mfma_f32_16x16x32_bf16 v[20:23], v[116:119], v[24:27], v[20:23]
    v_mfma_f32_16x16x32_bf16 v[16:19], v[120:123], v[24:27], v[16:19]
    v_mfma_f32_16x16x32_bf16 v[20:23], v[124:127], v[24:27], v[20:23]
    v_mfma_f32_16x16x32_bf16 v[16:19], v[128:131], v[24:27], v[16:19]
    v_mfma_f32_16x16x32_bf16 v[20:23], v[132:135], v[24:27], v[20:23]
    v_mfma_f32_16x16x32_bf16 v[16:19], v[136:139], v[24:27], v[16:19]
    v_mfma_f32_16x16x32_bf16 v[20:23], v[140:143], v[24:27], v[20:23]
    v_mfma_f32_16x16x32_bf16 v[16:19], v[144:147], v[24:27], v[16:19]
    v_mfma_f32_16x16x32_bf16 v[20:23], v[148:151], v[24:27], v[20:23]
    v_mfma_f32_16x16x32_bf16 v[16:19], v[152:155], v[24:27], v[16:19]
    v_mfma_f32_16x16x32_bf16 v[20:23], v[156:159], v[24:27], v[20:23]
    v_mfma_f32_16x16x32_bf16 v[16:19], v[160:163], v[24:27], v[16:19]
    v_mfma_f32_16x16x32_bf16 v[20:23], v[164:167], v[24:27], v[20:23]
    v_mfma_f32_16x16x32_bf16 v[16:19], v[168:171], v[24:27], v[16:19]
    v_mfma_f32_16x16x32_bf16 v[20:23], v[172:175], v[24:27], v[20:23]
    v_mfma_f32_16x16x32_bf16 v[16:19], v[176:179], v[24:27], v[16:19]
    v_mfma_f32_16x16x32_bf16 v[20:23], v[180:183], v[24:27], v[20:23]
    v_mfma_f32_16x16x32_bf16 v[16:19], v[184:187], v[24:27], v[16:19]
    v_mfma_f32_16x16x32_bf16 v[20:23], v[188:191], v[24:27], v[20:23]
    v_mfma_f32_16x16x32_bf16 v[16:19], v[192:195], v[24:27], v[16:19]
    v_mfma_f32_16x16x32_bf16 v[20:23], v[196:199], v[24:27], v[20:23]
    v_mfma_f32_16x16x32_bf16 v[16:19], v[200:203], v[24:27], v[16:19]
    v_mfma_f32_16x16x32_bf16 v[20:23], v[204:207], v[24:27], v[20:23]
    v_mfma_f32_16x16x32_bf16 v[16:19], v[208:211], v[24:27], v[16:19]
    v_mfma_f32_16x16x32_bf16 v[20:23], v[212:215], v[24:27], v[20:23]
    v_mfma_f32_16x16x32_bf16 v[16:19], v[216:219], v[24:27], v[16:19]
    v_mfma_f32_16x16x32_bf16 v[20:23], v[220:223], v[24:27], v[20:23]
    v_mfma_f32_16x16x32_bf16 v[16:19], v[224:227], v[24:27], v[16:19]
    v_mfma_f32_16x16x32_bf16 v[20:23], v[228:231], v[24:27], v[20:23]
    v_mfma_f32_16x16x32_bf16 v[16:19], v[232:235], v[24:27], v[16:19]
    v_mfma_f32_16x16x32_bf16 v[20:23], v[236:239], v[24:27], v[20:23]
    s_lshl_b32 s35, s26, 6
    s_add_u32 s35, s35, 148480
    v_lshlrev_b32 v14, 4, v5
    v_add_u32 v15, s35, v14
    v_add_u32 v14, 148480, v14
    s_mov_b32 exec_lo, 0x00010001
    s_mov_b32 exec_hi, 0x00010001
    ds_write_b128 v15, v[16:19]
    ds_write_b128 v15, v[20:23] offset:256
    s_mov_b64 exec, -1
    ds_read_b64_tr_b16 v[128:129], v7 offset:0
    ds_read_b64_tr_b16 v[130:131], v7 offset:2048
    ds_read_b64_tr_b16 v[132:133], v8 offset:0
    ds_read_b64_tr_b16 v[134:135], v8 offset:2048
    ds_read_b64_tr_b16 v[136:137], v9 offset:0
    ds_read_b64_tr_b16 v[138:139], v9 offset:2048
    ds_read_b64_tr_b16 v[140:141], v10 offset:0
    ds_read_b64_tr_b16 v[142:143], v10 offset:2048
    ds_read_b64_tr_b16 v[144:145], v11 offset:0
    ds_read_b64_tr_b16 v[146:147], v11 offset:2048
    ds_read_b64_tr_b16 v[148:149], v12 offset:0
    ds_read_b64_tr_b16 v[150:151], v12 offset:2048
    ds_read_b64_tr_b16 v[152:153], v13 offset:0
    ds_read_b64_tr_b16 v[154:155], v13 offset:2048
    s_lshl_b32 s29, s94, 18
    s_lshl_b32 s30, s26, 16
    s_add_u32 s29, s29, s30
    s_add_u32 s30, s29, 2097152
    v_lshlrev_b32 v15, 3, v6
    v_lshl_add_u32 v15, v5, 7, v15
    s_lshl_b32 s33, s94, 14
    s_lshl_b32 s34, s26, 12
    s_add_u32 s33, s33, s34
    s_add_u32 s33, s33, 12582912
    s_waitcnt lgkmcnt(0)
    v_mov_b32 v248, 163584
    v_mov_b32 v249, 1
    s_mov_b64 exec, 1
    ds_add_u32 v248, v249 offset:96
    s_mov_b64 exec, -1
L_sequential_preLN__sliding_local_dilated__geglu_ffn__prompt_kernel_cf2:
    ds_read_b32 v249, v248 offset:72
    s_waitcnt lgkmcnt(0)
    v_readfirstlane_b32 s40, v249
    s_nop 1
    s_cmp_lt_u32 s40, 1
    s_nop 1
    s_cbranch_scc1 L_sequential_preLN__sliding_local_dilated__geglu_ffn__prompt_kernel_cf2
    s_add_u32 s32, s30, 0
    buffer_load_dwordx4 v[184:187], v1, s[4:7], s32 offen offset:0 sc1
    s_add_u32 s32, s30, 16384
    buffer_load_dwordx4 v[188:191], v1, s[4:7], s32 offen offset:0 sc1
    s_add_u32 s32, s30, 32768
    buffer_load_dwordx4 v[192:195], v1, s[4:7], s32 offen offset:0 sc1
    s_add_u32 s32, s30, 49152
    buffer_load_dwordx4 v[196:199], v1, s[4:7], s32 offen offset:0 sc1
    s_add_u32 s32, s30, 0
    buffer_load_dwordx4 v[200:203], v1, s[4:7], s32 offen offset:1024 sc1
    s_add_u32 s32, s30, 16384
    buffer_load_dwordx4 v[204:207], v1, s[4:7], s32 offen offset:1024 sc1
    s_add_u32 s32, s30, 32768
    buffer_load_dwordx4 v[208:211], v1, s[4:7], s32 offen offset:1024 sc1
    s_add_u32 s32, s30, 49152
    buffer_load_dwordx4 v[212:215], v1, s[4:7], s32 offen offset:1024 sc1
    s_add_u32 s32, s30, 0
    buffer_load_dwordx4 v[216:219], v1, s[4:7], s32 offen offset:2048 sc1
    s_add_u32 s32, s30, 16384
    buffer_load_dwordx4 v[220:223], v1, s[4:7], s32 offen offset:2048 sc1
    s_add_u32 s32, s30, 32768
    buffer_load_dwordx4 v[224:227], v1, s[4:7], s32 offen offset:2048 sc1
    s_add_u32 s32, s30, 49152
    buffer_load_dwordx4 v[228:231], v1, s[4:7], s32 offen offset:2048 sc1
    s_add_u32 s32, s30, 0
    buffer_load_dwordx4 v[232:235], v1, s[4:7], s32 offen offset:3072 sc1
    s_add_u32 s32, s30, 16384
    buffer_load_dwordx4 v[236:239], v1, s[4:7], s32 offen offset:3072 sc1
    s_add_u32 s32, s30, 32768
    buffer_load_dwordx4 v[240:243], v1, s[4:7], s32 offen offset:3072 sc1
    s_add_u32 s32, s30, 49152
    buffer_load_dwordx4 v[244:247], v1, s[4:7], s32 offen offset:3072 sc1
    s_waitcnt lgkmcnt(0)
    s_waitcnt vmcnt(12)
    v_mfma_f32_16x16x32_bf16 v[16:19], v[128:131], v[184:187], 0
    ds_read_b64_tr_b16 v[156:157], v7 offset:4096
    v_mfma_f32_16x16x32_bf16 v[32:35], v[132:135], v[184:187], 0
    ds_read_b64_tr_b16 v[158:159], v7 offset:6144
    v_mfma_f32_16x16x32_bf16 v[48:51], v[136:139], v[184:187], 0
    ds_read_b64_tr_b16 v[160:161], v8 offset:4096
    v_mfma_f32_16x16x32_bf16 v[64:67], v[140:143], v[184:187], 0
    ds_read_b64_tr_b16 v[162:163], v8 offset:6144
    v_mfma_f32_16x16x32_bf16 v[80:83], v[144:147], v[184:187], 0
    ds_read_b64_tr_b16 v[164:165], v9 offset:4096
    v_mfma_f32_16x16x32_bf16 v[96:99], v[148:151], v[184:187], 0
    ds_read_b64_tr_b16 v[166:167], v9 offset:6144
    v_mfma_f32_16x16x32_bf16 v[112:115], v[152:155], v[184:187], 0
    ds_read_b64_tr_b16 v[168:169], v10 offset:4096
    s_add_u32 s32, s30, 4096
    buffer_load_dwordx4 v[184:187], v1, s[4:7], s32 offen offset:0 sc1
    v_mfma_f32_16x16x32_bf16 v[20:23], v[128:131], v[188:191], 0
    ds_read_b64_tr_b16 v[170:171], v10 offset:6144
    v_mfma_f32_16x16x32_bf16 v[36:39], v[132:135], v[188:191], 0
    ds_read_b64_tr_b16 v[172:173], v11 offset:4096
    v_mfma_f32_16x16x32_bf16 v[52:55], v[136:139], v[188:191], 0
    ds_read_b64_tr_b16 v[174:175], v11 offset:6144
    v_mfma_f32_16x16x32_bf16 v[68:71], v[140:143], v[188:191], 0
    ds_read_b64_tr_b16 v[176:177], v12 offset:4096
    v_mfma_f32_16x16x32_bf16 v[84:87], v[144:147], v[188:191], 0
    ds_read_b64_tr_b16 v[178:179], v12 offset:6144
    v_mfma_f32_16x16x32_bf16 v[100:103], v[148:151], v[188:191], 0
    ds_read_b64_tr_b16 v[180:181], v13 offset:4096
    v_mfma_f32_16x16x32_bf16 v[116:119], v[152:155], v[188:191], 0
    ds_read_b64_tr_b16 v[182:183], v13 offset:6144
    s_add_u32 s32, s30, 20480
    buffer_load_dwordx4 v[188:191], v1, s[4:7], s32 offen offset:0 sc1
    v_mfma_f32_16x16x32_bf16 v[24:27], v[128:131], v[192:195], 0
    v_mfma_f32_16x16x32_bf16 v[40:43], v[132:135], v[192:195], 0
    v_mfma_f32_16x16x32_bf16 v[56:59], v[136:139], v[192:195], 0
    v_mfma_f32_16x16x32_bf16 v[72:75], v[140:143], v[192:195], 0
    v_mfma_f32_16x16x32_bf16 v[88:91], v[144:147], v[192:195], 0
    v_mfma_f32_16x16x32_bf16 v[104:107], v[148:151], v[192:195], 0
    v_mfma_f32_16x16x32_bf16 v[120:123], v[152:155], v[192:195], 0
    s_add_u32 s32, s30, 36864
    buffer_load_dwordx4 v[192:195], v1, s[4:7], s32 offen offset:0 sc1
    v_mfma_f32_16x16x32_bf16 v[28:31], v[128:131], v[196:199], 0
    v_mfma_f32_16x16x32_bf16 v[44:47], v[132:135], v[196:199], 0
    v_mfma_f32_16x16x32_bf16 v[60:63], v[136:139], v[196:199], 0
    v_mfma_f32_16x16x32_bf16 v[76:79], v[140:143], v[196:199], 0
    v_mfma_f32_16x16x32_bf16 v[92:95], v[144:147], v[196:199], 0
    v_mfma_f32_16x16x32_bf16 v[108:111], v[148:151], v[196:199], 0
    v_mfma_f32_16x16x32_bf16 v[124:127], v[152:155], v[196:199], 0
    s_add_u32 s32, s30, 53248
    buffer_load_dwordx4 v[196:199], v1, s[4:7], s32 offen offset:0 sc1
    s_waitcnt lgkmcnt(0)
    s_waitcnt vmcnt(12)
    v_mfma_f32_16x16x32_bf16 v[16:19], v[156:159], v[200:203], v[16:19]
    ds_read_b64_tr_b16 v[128:129], v7 offset:8192
    v_mfma_f32_16x16x32_bf16 v[32:35], v[160:163], v[200:203], v[32:35]
    ds_read_b64_tr_b16 v[130:131], v7 offset:10240
    v_mfma_f32_16x16x32_bf16 v[48:51], v[164:167], v[200:203], v[48:51]
    ds_read_b64_tr_b16 v[132:133], v8 offset:8192
    v_mfma_f32_16x16x32_bf16 v[64:67], v[168:171], v[200:203], v[64:67]
    ds_read_b64_tr_b16 v[134:135], v8 offset:10240
    v_mfma_f32_16x16x32_bf16 v[80:83], v[172:175], v[200:203], v[80:83]
    ds_read_b64_tr_b16 v[136:137], v9 offset:8192
    v_mfma_f32_16x16x32_bf16 v[96:99], v[176:179], v[200:203], v[96:99]
    ds_read_b64_tr_b16 v[138:139], v9 offset:10240
    v_mfma_f32_16x16x32_bf16 v[112:115], v[180:183], v[200:203], v[112:115]
    ds_read_b64_tr_b16 v[140:141], v10 offset:8192
    s_add_u32 s32, s30, 4096
    buffer_load_dwordx4 v[200:203], v1, s[4:7], s32 offen offset:1024 sc1
    v_mfma_f32_16x16x32_bf16 v[20:23], v[156:159], v[204:207], v[20:23]
    ds_read_b64_tr_b16 v[142:143], v10 offset:10240
    v_mfma_f32_16x16x32_bf16 v[36:39], v[160:163], v[204:207], v[36:39]
    ds_read_b64_tr_b16 v[144:145], v11 offset:8192
    v_mfma_f32_16x16x32_bf16 v[52:55], v[164:167], v[204:207], v[52:55]
    ds_read_b64_tr_b16 v[146:147], v11 offset:10240
    v_mfma_f32_16x16x32_bf16 v[68:71], v[168:171], v[204:207], v[68:71]
    ds_read_b64_tr_b16 v[148:149], v12 offset:8192
    v_mfma_f32_16x16x32_bf16 v[84:87], v[172:175], v[204:207], v[84:87]
    ds_read_b64_tr_b16 v[150:151], v12 offset:10240
    v_mfma_f32_16x16x32_bf16 v[100:103], v[176:179], v[204:207], v[100:103]
    ds_read_b64_tr_b16 v[152:153], v13 offset:8192
    v_mfma_f32_16x16x32_bf16 v[116:119], v[180:183], v[204:207], v[116:119]
    ds_read_b64_tr_b16 v[154:155], v13 offset:10240
    s_add_u32 s32, s30, 20480
    buffer_load_dwordx4 v[204:207], v1, s[4:7], s32 offen offset:1024 sc1
    v_mfma_f32_16x16x32_bf16 v[24:27], v[156:159], v[208:211], v[24:27]
    v_mfma_f32_16x16x32_bf16 v[40:43], v[160:163], v[208:211], v[40:43]
    v_mfma_f32_16x16x32_bf16 v[56:59], v[164:167], v[208:211], v[56:59]
    v_mfma_f32_16x16x32_bf16 v[72:75], v[168:171], v[208:211], v[72:75]
    v_mfma_f32_16x16x32_bf16 v[88:91], v[172:175], v[208:211], v[88:91]
    v_mfma_f32_16x16x32_bf16 v[104:107], v[176:179], v[208:211], v[104:107]
    v_mfma_f32_16x16x32_bf16 v[120:123], v[180:183], v[208:211], v[120:123]
    s_add_u32 s32, s30, 36864
    buffer_load_dwordx4 v[208:211], v1, s[4:7], s32 offen offset:1024 sc1
    v_mfma_f32_16x16x32_bf16 v[28:31], v[156:159], v[212:215], v[28:31]
    v_mfma_f32_16x16x32_bf16 v[44:47], v[160:163], v[212:215], v[44:47]
    v_mfma_f32_16x16x32_bf16 v[60:63], v[164:167], v[212:215], v[60:63]
    v_mfma_f32_16x16x32_bf16 v[76:79], v[168:171], v[212:215], v[76:79]
    v_mfma_f32_16x16x32_bf16 v[92:95], v[172:175], v[212:215], v[92:95]
    v_mfma_f32_16x16x32_bf16 v[108:111], v[176:179], v[212:215], v[108:111]
    v_mfma_f32_16x16x32_bf16 v[124:127], v[180:183], v[212:215], v[124:127]
    s_add_u32 s32, s30, 53248
    buffer_load_dwordx4 v[212:215], v1, s[4:7], s32 offen offset:1024 sc1
    s_waitcnt lgkmcnt(0)
    s_waitcnt vmcnt(12)
    v_mfma_f32_16x16x32_bf16 v[16:19], v[128:131], v[216:219], v[16:19]
    ds_read_b64_tr_b16 v[156:157], v7 offset:12288
    v_mfma_f32_16x16x32_bf16 v[32:35], v[132:135], v[216:219], v[32:35]
    ds_read_b64_tr_b16 v[158:159], v7 offset:14336
    v_mfma_f32_16x16x32_bf16 v[48:51], v[136:139], v[216:219], v[48:51]
    ds_read_b64_tr_b16 v[160:161], v8 offset:12288
    v_mfma_f32_16x16x32_bf16 v[64:67], v[140:143], v[216:219], v[64:67]
    ds_read_b64_tr_b16 v[162:163], v8 offset:14336
    v_mfma_f32_16x16x32_bf16 v[80:83], v[144:147], v[216:219], v[80:83]
    ds_read_b64_tr_b16 v[164:165], v9 offset:12288
    v_mfma_f32_16x16x32_bf16 v[96:99], v[148:151], v[216:219], v[96:99]
    ds_read_b64_tr_b16 v[166:167], v9 offset:14336
    v_mfma_f32_16x16x32_bf16 v[112:115], v[152:155], v[216:219], v[112:115]
    ds_read_b64_tr_b16 v[168:169], v10 offset:12288
    s_add_u32 s32, s30, 4096
    buffer_load_dwordx4 v[216:219], v1, s[4:7], s32 offen offset:2048 sc1
    v_mfma_f32_16x16x32_bf16 v[20:23], v[128:131], v[220:223], v[20:23]
    ds_read_b64_tr_b16 v[170:171], v10 offset:14336
    v_mfma_f32_16x16x32_bf16 v[36:39], v[132:135], v[220:223], v[36:39]
    ds_read_b64_tr_b16 v[172:173], v11 offset:12288
    v_mfma_f32_16x16x32_bf16 v[52:55], v[136:139], v[220:223], v[52:55]
    ds_read_b64_tr_b16 v[174:175], v11 offset:14336
    v_mfma_f32_16x16x32_bf16 v[68:71], v[140:143], v[220:223], v[68:71]
    ds_read_b64_tr_b16 v[176:177], v12 offset:12288
    v_mfma_f32_16x16x32_bf16 v[84:87], v[144:147], v[220:223], v[84:87]
    ds_read_b64_tr_b16 v[178:179], v12 offset:14336
    v_mfma_f32_16x16x32_bf16 v[100:103], v[148:151], v[220:223], v[100:103]
    ds_read_b64_tr_b16 v[180:181], v13 offset:12288
    v_mfma_f32_16x16x32_bf16 v[116:119], v[152:155], v[220:223], v[116:119]
    ds_read_b64_tr_b16 v[182:183], v13 offset:14336
    s_add_u32 s32, s30, 20480
    buffer_load_dwordx4 v[220:223], v1, s[4:7], s32 offen offset:2048 sc1
    v_mfma_f32_16x16x32_bf16 v[24:27], v[128:131], v[224:227], v[24:27]
    v_mfma_f32_16x16x32_bf16 v[40:43], v[132:135], v[224:227], v[40:43]
    v_mfma_f32_16x16x32_bf16 v[56:59], v[136:139], v[224:227], v[56:59]
    v_mfma_f32_16x16x32_bf16 v[72:75], v[140:143], v[224:227], v[72:75]
    v_mfma_f32_16x16x32_bf16 v[88:91], v[144:147], v[224:227], v[88:91]
    v_mfma_f32_16x16x32_bf16 v[104:107], v[148:151], v[224:227], v[104:107]
    v_mfma_f32_16x16x32_bf16 v[120:123], v[152:155], v[224:227], v[120:123]
    s_add_u32 s32, s30, 36864
    buffer_load_dwordx4 v[224:227], v1, s[4:7], s32 offen offset:2048 sc1
    v_mfma_f32_16x16x32_bf16 v[28:31], v[128:131], v[228:231], v[28:31]
    v_mfma_f32_16x16x32_bf16 v[44:47], v[132:135], v[228:231], v[44:47]
    v_mfma_f32_16x16x32_bf16 v[60:63], v[136:139], v[228:231], v[60:63]
    v_mfma_f32_16x16x32_bf16 v[76:79], v[140:143], v[228:231], v[76:79]
    v_mfma_f32_16x16x32_bf16 v[92:95], v[144:147], v[228:231], v[92:95]
    v_mfma_f32_16x16x32_bf16 v[108:111], v[148:151], v[228:231], v[108:111]
    v_mfma_f32_16x16x32_bf16 v[124:127], v[152:155], v[228:231], v[124:127]
    s_add_u32 s32, s30, 53248
    buffer_load_dwordx4 v[228:231], v1, s[4:7], s32 offen offset:2048 sc1
    s_waitcnt lgkmcnt(0)
    s_waitcnt vmcnt(12)
    v_mfma_f32_16x16x32_bf16 v[16:19], v[156:159], v[232:235], v[16:19]
    ds_read_b64_tr_b16 v[128:129], v7 offset:16384
    v_mfma_f32_16x16x32_bf16 v[32:35], v[160:163], v[232:235], v[32:35]
    ds_read_b64_tr_b16 v[130:131], v7 offset:18432
    v_mfma_f32_16x16x32_bf16 v[48:51], v[164:167], v[232:235], v[48:51]
    ds_read_b64_tr_b16 v[132:133], v8 offset:16384
    v_mfma_f32_16x16x32_bf16 v[64:67], v[168:171], v[232:235], v[64:67]
    ds_read_b64_tr_b16 v[134:135], v8 offset:18432
    v_mfma_f32_16x16x32_bf16 v[80:83], v[172:175], v[232:235], v[80:83]
    ds_read_b64_tr_b16 v[136:137], v9 offset:16384
    v_mfma_f32_16x16x32_bf16 v[96:99], v[176:179], v[232:235], v[96:99]
    ds_read_b64_tr_b16 v[138:139], v9 offset:18432
    v_mfma_f32_16x16x32_bf16 v[112:115], v[180:183], v[232:235], v[112:115]
    ds_read_b64_tr_b16 v[140:141], v10 offset:16384
    s_add_u32 s32, s30, 4096
    buffer_load_dwordx4 v[232:235], v1, s[4:7], s32 offen offset:3072 sc1
    v_mfma_f32_16x16x32_bf16 v[20:23], v[156:159], v[236:239], v[20:23]
    ds_read_b64_tr_b16 v[142:143], v10 offset:18432
    v_mfma_f32_16x16x32_bf16 v[36:39], v[160:163], v[236:239], v[36:39]
    ds_read_b64_tr_b16 v[144:145], v11 offset:16384
    v_mfma_f32_16x16x32_bf16 v[52:55], v[164:167], v[236:239], v[52:55]
    ds_read_b64_tr_b16 v[146:147], v11 offset:18432
    v_mfma_f32_16x16x32_bf16 v[68:71], v[168:171], v[236:239], v[68:71]
    ds_read_b64_tr_b16 v[148:149], v12 offset:16384
    v_mfma_f32_16x16x32_bf16 v[84:87], v[172:175], v[236:239], v[84:87]
    ds_read_b64_tr_b16 v[150:151], v12 offset:18432
    v_mfma_f32_16x16x32_bf16 v[100:103], v[176:179], v[236:239], v[100:103]
    ds_read_b64_tr_b16 v[152:153], v13 offset:16384
    v_mfma_f32_16x16x32_bf16 v[116:119], v[180:183], v[236:239], v[116:119]
    ds_read_b64_tr_b16 v[154:155], v13 offset:18432
    s_add_u32 s32, s30, 20480
    buffer_load_dwordx4 v[236:239], v1, s[4:7], s32 offen offset:3072 sc1
    v_mfma_f32_16x16x32_bf16 v[24:27], v[156:159], v[240:243], v[24:27]
    v_mfma_f32_16x16x32_bf16 v[40:43], v[160:163], v[240:243], v[40:43]
    v_mfma_f32_16x16x32_bf16 v[56:59], v[164:167], v[240:243], v[56:59]
    v_mfma_f32_16x16x32_bf16 v[72:75], v[168:171], v[240:243], v[72:75]
    v_mfma_f32_16x16x32_bf16 v[88:91], v[172:175], v[240:243], v[88:91]
    v_mfma_f32_16x16x32_bf16 v[104:107], v[176:179], v[240:243], v[104:107]
    v_mfma_f32_16x16x32_bf16 v[120:123], v[180:183], v[240:243], v[120:123]
    s_add_u32 s32, s30, 36864
    buffer_load_dwordx4 v[240:243], v1, s[4:7], s32 offen offset:3072 sc1
    v_mfma_f32_16x16x32_bf16 v[28:31], v[156:159], v[244:247], v[28:31]
    v_mfma_f32_16x16x32_bf16 v[44:47], v[160:163], v[244:247], v[44:47]
    v_mfma_f32_16x16x32_bf16 v[60:63], v[164:167], v[244:247], v[60:63]
    v_mfma_f32_16x16x32_bf16 v[76:79], v[168:171], v[244:247], v[76:79]
    v_mfma_f32_16x16x32_bf16 v[92:95], v[172:175], v[244:247], v[92:95]
    v_mfma_f32_16x16x32_bf16 v[108:111], v[176:179], v[244:247], v[108:111]
    v_mfma_f32_16x16x32_bf16 v[124:127], v[180:183], v[244:247], v[124:127]
    s_add_u32 s32, s30, 53248
    buffer_load_dwordx4 v[244:247], v1, s[4:7], s32 offen offset:3072 sc1
    s_waitcnt lgkmcnt(0)
    s_waitcnt vmcnt(12)
    v_mfma_f32_16x16x32_bf16 v[16:19], v[128:131], v[184:187], v[16:19]
    ds_read_b64_tr_b16 v[156:157], v7 offset:20480
    v_mfma_f32_16x16x32_bf16 v[32:35], v[132:135], v[184:187], v[32:35]
    ds_read_b64_tr_b16 v[158:159], v7 offset:22528
    v_mfma_f32_16x16x32_bf16 v[48:51], v[136:139], v[184:187], v[48:51]
    ds_read_b64_tr_b16 v[160:161], v8 offset:20480
    v_mfma_f32_16x16x32_bf16 v[64:67], v[140:143], v[184:187], v[64:67]
    ds_read_b64_tr_b16 v[162:163], v8 offset:22528
    v_mfma_f32_16x16x32_bf16 v[80:83], v[144:147], v[184:187], v[80:83]
    ds_read_b64_tr_b16 v[164:165], v9 offset:20480
    v_mfma_f32_16x16x32_bf16 v[96:99], v[148:151], v[184:187], v[96:99]
    ds_read_b64_tr_b16 v[166:167], v9 offset:22528
    v_mfma_f32_16x16x32_bf16 v[112:115], v[152:155], v[184:187], v[112:115]
    ds_read_b64_tr_b16 v[168:169], v10 offset:20480
    s_add_u32 s32, s30, 8192
    buffer_load_dwordx4 v[184:187], v1, s[4:7], s32 offen offset:0 sc1
    v_mfma_f32_16x16x32_bf16 v[20:23], v[128:131], v[188:191], v[20:23]
    ds_read_b64_tr_b16 v[170:171], v10 offset:22528
    v_mfma_f32_16x16x32_bf16 v[36:39], v[132:135], v[188:191], v[36:39]
    ds_read_b64_tr_b16 v[172:173], v11 offset:20480
    v_mfma_f32_16x16x32_bf16 v[52:55], v[136:139], v[188:191], v[52:55]
    ds_read_b64_tr_b16 v[174:175], v11 offset:22528
    v_mfma_f32_16x16x32_bf16 v[68:71], v[140:143], v[188:191], v[68:71]
    ds_read_b64_tr_b16 v[176:177], v12 offset:20480
    v_mfma_f32_16x16x32_bf16 v[84:87], v[144:147], v[188:191], v[84:87]
    ds_read_b64_tr_b16 v[178:179], v12 offset:22528
    v_mfma_f32_16x16x32_bf16 v[100:103], v[148:151], v[188:191], v[100:103]
    ds_read_b64_tr_b16 v[180:181], v13 offset:20480
    v_mfma_f32_16x16x32_bf16 v[116:119], v[152:155], v[188:191], v[116:119]
    ds_read_b64_tr_b16 v[182:183], v13 offset:22528
    s_add_u32 s32, s30, 24576
    buffer_load_dwordx4 v[188:191], v1, s[4:7], s32 offen offset:0 sc1
    v_mfma_f32_16x16x32_bf16 v[24:27], v[128:131], v[192:195], v[24:27]
    v_mfma_f32_16x16x32_bf16 v[40:43], v[132:135], v[192:195], v[40:43]
    v_mfma_f32_16x16x32_bf16 v[56:59], v[136:139], v[192:195], v[56:59]
    v_mfma_f32_16x16x32_bf16 v[72:75], v[140:143], v[192:195], v[72:75]
    v_mfma_f32_16x16x32_bf16 v[88:91], v[144:147], v[192:195], v[88:91]
    v_mfma_f32_16x16x32_bf16 v[104:107], v[148:151], v[192:195], v[104:107]
    v_mfma_f32_16x16x32_bf16 v[120:123], v[152:155], v[192:195], v[120:123]
    s_add_u32 s32, s30, 40960
    buffer_load_dwordx4 v[192:195], v1, s[4:7], s32 offen offset:0 sc1
    v_mfma_f32_16x16x32_bf16 v[28:31], v[128:131], v[196:199], v[28:31]
    v_mfma_f32_16x16x32_bf16 v[44:47], v[132:135], v[196:199], v[44:47]
    v_mfma_f32_16x16x32_bf16 v[60:63], v[136:139], v[196:199], v[60:63]
    v_mfma_f32_16x16x32_bf16 v[76:79], v[140:143], v[196:199], v[76:79]
    v_mfma_f32_16x16x32_bf16 v[92:95], v[144:147], v[196:199], v[92:95]
    v_mfma_f32_16x16x32_bf16 v[108:111], v[148:151], v[196:199], v[108:111]
    v_mfma_f32_16x16x32_bf16 v[124:127], v[152:155], v[196:199], v[124:127]
    s_add_u32 s32, s30, 57344
    buffer_load_dwordx4 v[196:199], v1, s[4:7], s32 offen offset:0 sc1
    s_waitcnt lgkmcnt(0)
    s_waitcnt vmcnt(12)
    v_mfma_f32_16x16x32_bf16 v[16:19], v[156:159], v[200:203], v[16:19]
    ds_read_b64_tr_b16 v[128:129], v7 offset:24576
    v_mfma_f32_16x16x32_bf16 v[32:35], v[160:163], v[200:203], v[32:35]
    ds_read_b64_tr_b16 v[130:131], v7 offset:26624
    v_mfma_f32_16x16x32_bf16 v[48:51], v[164:167], v[200:203], v[48:51]
    ds_read_b64_tr_b16 v[132:133], v8 offset:24576
    v_mfma_f32_16x16x32_bf16 v[64:67], v[168:171], v[200:203], v[64:67]
    ds_read_b64_tr_b16 v[134:135], v8 offset:26624
    v_mfma_f32_16x16x32_bf16 v[80:83], v[172:175], v[200:203], v[80:83]
    ds_read_b64_tr_b16 v[136:137], v9 offset:24576
    v_mfma_f32_16x16x32_bf16 v[96:99], v[176:179], v[200:203], v[96:99]
    ds_read_b64_tr_b16 v[138:139], v9 offset:26624
    v_mfma_f32_16x16x32_bf16 v[112:115], v[180:183], v[200:203], v[112:115]
    ds_read_b64_tr_b16 v[140:141], v10 offset:24576
    s_add_u32 s32, s30, 8192
    buffer_load_dwordx4 v[200:203], v1, s[4:7], s32 offen offset:1024 sc1
    v_mfma_f32_16x16x32_bf16 v[20:23], v[156:159], v[204:207], v[20:23]
    ds_read_b64_tr_b16 v[142:143], v10 offset:26624
    v_mfma_f32_16x16x32_bf16 v[36:39], v[160:163], v[204:207], v[36:39]
    ds_read_b64_tr_b16 v[144:145], v11 offset:24576
    v_mfma_f32_16x16x32_bf16 v[52:55], v[164:167], v[204:207], v[52:55]
    ds_read_b64_tr_b16 v[146:147], v11 offset:26624
    v_mfma_f32_16x16x32_bf16 v[68:71], v[168:171], v[204:207], v[68:71]
    ds_read_b64_tr_b16 v[148:149], v12 offset:24576
    v_mfma_f32_16x16x32_bf16 v[84:87], v[172:175], v[204:207], v[84:87]
    ds_read_b64_tr_b16 v[150:151], v12 offset:26624
    v_mfma_f32_16x16x32_bf16 v[100:103], v[176:179], v[204:207], v[100:103]
    ds_read_b64_tr_b16 v[152:153], v13 offset:24576
    v_mfma_f32_16x16x32_bf16 v[116:119], v[180:183], v[204:207], v[116:119]
    ds_read_b64_tr_b16 v[154:155], v13 offset:26624
    s_add_u32 s32, s30, 24576
    buffer_load_dwordx4 v[204:207], v1, s[4:7], s32 offen offset:1024 sc1
    v_mfma_f32_16x16x32_bf16 v[24:27], v[156:159], v[208:211], v[24:27]
    v_mfma_f32_16x16x32_bf16 v[40:43], v[160:163], v[208:211], v[40:43]
    v_mfma_f32_16x16x32_bf16 v[56:59], v[164:167], v[208:211], v[56:59]
    v_mfma_f32_16x16x32_bf16 v[72:75], v[168:171], v[208:211], v[72:75]
    v_mfma_f32_16x16x32_bf16 v[88:91], v[172:175], v[208:211], v[88:91]
    v_mfma_f32_16x16x32_bf16 v[104:107], v[176:179], v[208:211], v[104:107]
    v_mfma_f32_16x16x32_bf16 v[120:123], v[180:183], v[208:211], v[120:123]
    s_add_u32 s32, s30, 40960
    buffer_load_dwordx4 v[208:211], v1, s[4:7], s32 offen offset:1024 sc1
    v_mfma_f32_16x16x32_bf16 v[28:31], v[156:159], v[212:215], v[28:31]
    v_mfma_f32_16x16x32_bf16 v[44:47], v[160:163], v[212:215], v[44:47]
    v_mfma_f32_16x16x32_bf16 v[60:63], v[164:167], v[212:215], v[60:63]
    v_mfma_f32_16x16x32_bf16 v[76:79], v[168:171], v[212:215], v[76:79]
    v_mfma_f32_16x16x32_bf16 v[92:95], v[172:175], v[212:215], v[92:95]
    v_mfma_f32_16x16x32_bf16 v[108:111], v[176:179], v[212:215], v[108:111]
    v_mfma_f32_16x16x32_bf16 v[124:127], v[180:183], v[212:215], v[124:127]
    s_add_u32 s32, s30, 57344
    buffer_load_dwordx4 v[212:215], v1, s[4:7], s32 offen offset:1024 sc1
    s_waitcnt lgkmcnt(0)
    s_waitcnt vmcnt(12)
    v_mfma_f32_16x16x32_bf16 v[16:19], v[128:131], v[216:219], v[16:19]
    ds_read_b64_tr_b16 v[156:157], v7 offset:28672
    v_mfma_f32_16x16x32_bf16 v[32:35], v[132:135], v[216:219], v[32:35]
    ds_read_b64_tr_b16 v[158:159], v7 offset:30720
    v_mfma_f32_16x16x32_bf16 v[48:51], v[136:139], v[216:219], v[48:51]
    ds_read_b64_tr_b16 v[160:161], v8 offset:28672
    v_mfma_f32_16x16x32_bf16 v[64:67], v[140:143], v[216:219], v[64:67]
    ds_read_b64_tr_b16 v[162:163], v8 offset:30720
    v_mfma_f32_16x16x32_bf16 v[80:83], v[144:147], v[216:219], v[80:83]
    ds_read_b64_tr_b16 v[164:165], v9 offset:28672
    v_mfma_f32_16x16x32_bf16 v[96:99], v[148:151], v[216:219], v[96:99]
    ds_read_b64_tr_b16 v[166:167], v9 offset:30720
    v_mfma_f32_16x16x32_bf16 v[112:115], v[152:155], v[216:219], v[112:115]
    ds_read_b64_tr_b16 v[168:169], v10 offset:28672
    s_add_u32 s32, s30, 8192
    buffer_load_dwordx4 v[216:219], v1, s[4:7], s32 offen offset:2048 sc1
    v_mfma_f32_16x16x32_bf16 v[20:23], v[128:131], v[220:223], v[20:23]
    ds_read_b64_tr_b16 v[170:171], v10 offset:30720
    v_mfma_f32_16x16x32_bf16 v[36:39], v[132:135], v[220:223], v[36:39]
    ds_read_b64_tr_b16 v[172:173], v11 offset:28672
    v_mfma_f32_16x16x32_bf16 v[52:55], v[136:139], v[220:223], v[52:55]
    ds_read_b64_tr_b16 v[174:175], v11 offset:30720
    v_mfma_f32_16x16x32_bf16 v[68:71], v[140:143], v[220:223], v[68:71]
    ds_read_b64_tr_b16 v[176:177], v12 offset:28672
    v_mfma_f32_16x16x32_bf16 v[84:87], v[144:147], v[220:223], v[84:87]
    ds_read_b64_tr_b16 v[178:179], v12 offset:30720
    v_mfma_f32_16x16x32_bf16 v[100:103], v[148:151], v[220:223], v[100:103]
    ds_read_b64_tr_b16 v[180:181], v13 offset:28672
    v_mfma_f32_16x16x32_bf16 v[116:119], v[152:155], v[220:223], v[116:119]
    ds_read_b64_tr_b16 v[182:183], v13 offset:30720
    s_add_u32 s32, s30, 24576
    buffer_load_dwordx4 v[220:223], v1, s[4:7], s32 offen offset:2048 sc1
    v_mfma_f32_16x16x32_bf16 v[24:27], v[128:131], v[224:227], v[24:27]
    v_mfma_f32_16x16x32_bf16 v[40:43], v[132:135], v[224:227], v[40:43]
    v_mfma_f32_16x16x32_bf16 v[56:59], v[136:139], v[224:227], v[56:59]
    v_mfma_f32_16x16x32_bf16 v[72:75], v[140:143], v[224:227], v[72:75]
    v_mfma_f32_16x16x32_bf16 v[88:91], v[144:147], v[224:227], v[88:91]
    v_mfma_f32_16x16x32_bf16 v[104:107], v[148:151], v[224:227], v[104:107]
    v_mfma_f32_16x16x32_bf16 v[120:123], v[152:155], v[224:227], v[120:123]
    s_add_u32 s32, s30, 40960
    buffer_load_dwordx4 v[224:227], v1, s[4:7], s32 offen offset:2048 sc1
    v_mfma_f32_16x16x32_bf16 v[28:31], v[128:131], v[228:231], v[28:31]
    v_mfma_f32_16x16x32_bf16 v[44:47], v[132:135], v[228:231], v[44:47]
    v_mfma_f32_16x16x32_bf16 v[60:63], v[136:139], v[228:231], v[60:63]
    v_mfma_f32_16x16x32_bf16 v[76:79], v[140:143], v[228:231], v[76:79]
    v_mfma_f32_16x16x32_bf16 v[92:95], v[144:147], v[228:231], v[92:95]
    v_mfma_f32_16x16x32_bf16 v[108:111], v[148:151], v[228:231], v[108:111]
    v_mfma_f32_16x16x32_bf16 v[124:127], v[152:155], v[228:231], v[124:127]
    s_add_u32 s32, s30, 57344
    buffer_load_dwordx4 v[228:231], v1, s[4:7], s32 offen offset:2048 sc1
    s_waitcnt lgkmcnt(0)
    s_waitcnt vmcnt(12)
    v_mfma_f32_16x16x32_bf16 v[16:19], v[156:159], v[232:235], v[16:19]
    ds_read_b64_tr_b16 v[128:129], v7 offset:32768
    v_mfma_f32_16x16x32_bf16 v[32:35], v[160:163], v[232:235], v[32:35]
    ds_read_b64_tr_b16 v[130:131], v7 offset:34816
    v_mfma_f32_16x16x32_bf16 v[48:51], v[164:167], v[232:235], v[48:51]
    ds_read_b64_tr_b16 v[132:133], v8 offset:32768
    v_mfma_f32_16x16x32_bf16 v[64:67], v[168:171], v[232:235], v[64:67]
    ds_read_b64_tr_b16 v[134:135], v8 offset:34816
    v_mfma_f32_16x16x32_bf16 v[80:83], v[172:175], v[232:235], v[80:83]
    ds_read_b64_tr_b16 v[136:137], v9 offset:32768
    v_mfma_f32_16x16x32_bf16 v[96:99], v[176:179], v[232:235], v[96:99]
    ds_read_b64_tr_b16 v[138:139], v9 offset:34816
    v_mfma_f32_16x16x32_bf16 v[112:115], v[180:183], v[232:235], v[112:115]
    ds_read_b64_tr_b16 v[140:141], v10 offset:32768
    s_add_u32 s32, s30, 8192
    buffer_load_dwordx4 v[232:235], v1, s[4:7], s32 offen offset:3072 sc1
    v_mfma_f32_16x16x32_bf16 v[20:23], v[156:159], v[236:239], v[20:23]
    ds_read_b64_tr_b16 v[142:143], v10 offset:34816
    v_mfma_f32_16x16x32_bf16 v[36:39], v[160:163], v[236:239], v[36:39]
    ds_read_b64_tr_b16 v[144:145], v11 offset:32768
    v_mfma_f32_16x16x32_bf16 v[52:55], v[164:167], v[236:239], v[52:55]
    ds_read_b64_tr_b16 v[146:147], v11 offset:34816
    v_mfma_f32_16x16x32_bf16 v[68:71], v[168:171], v[236:239], v[68:71]
    ds_read_b64_tr_b16 v[148:149], v12 offset:32768
    v_mfma_f32_16x16x32_bf16 v[84:87], v[172:175], v[236:239], v[84:87]
    ds_read_b64_tr_b16 v[150:151], v12 offset:34816
    v_mfma_f32_16x16x32_bf16 v[100:103], v[176:179], v[236:239], v[100:103]
    ds_read_b64_tr_b16 v[152:153], v13 offset:32768
    v_mfma_f32_16x16x32_bf16 v[116:119], v[180:183], v[236:239], v[116:119]
    ds_read_b64_tr_b16 v[154:155], v13 offset:34816
    s_add_u32 s32, s30, 24576
    buffer_load_dwordx4 v[236:239], v1, s[4:7], s32 offen offset:3072 sc1
    v_mfma_f32_16x16x32_bf16 v[24:27], v[156:159], v[240:243], v[24:27]
    v_mfma_f32_16x16x32_bf16 v[40:43], v[160:163], v[240:243], v[40:43]
    v_mfma_f32_16x16x32_bf16 v[56:59], v[164:167], v[240:243], v[56:59]
    v_mfma_f32_16x16x32_bf16 v[72:75], v[168:171], v[240:243], v[72:75]
    v_mfma_f32_16x16x32_bf16 v[88:91], v[172:175], v[240:243], v[88:91]
    v_mfma_f32_16x16x32_bf16 v[104:107], v[176:179], v[240:243], v[104:107]
    v_mfma_f32_16x16x32_bf16 v[120:123], v[180:183], v[240:243], v[120:123]
    s_add_u32 s32, s30, 40960
    buffer_load_dwordx4 v[240:243], v1, s[4:7], s32 offen offset:3072 sc1
    v_mfma_f32_16x16x32_bf16 v[28:31], v[156:159], v[244:247], v[28:31]
    v_mfma_f32_16x16x32_bf16 v[44:47], v[160:163], v[244:247], v[44:47]
    v_mfma_f32_16x16x32_bf16 v[60:63], v[164:167], v[244:247], v[60:63]
    v_mfma_f32_16x16x32_bf16 v[76:79], v[168:171], v[244:247], v[76:79]
    v_mfma_f32_16x16x32_bf16 v[92:95], v[172:175], v[244:247], v[92:95]
    v_mfma_f32_16x16x32_bf16 v[108:111], v[176:179], v[244:247], v[108:111]
    v_mfma_f32_16x16x32_bf16 v[124:127], v[180:183], v[244:247], v[124:127]
    s_add_u32 s32, s30, 57344
    buffer_load_dwordx4 v[244:247], v1, s[4:7], s32 offen offset:3072 sc1
    s_waitcnt lgkmcnt(0)
    s_waitcnt vmcnt(12)
    v_mfma_f32_16x16x32_bf16 v[16:19], v[128:131], v[184:187], v[16:19]
    ds_read_b64_tr_b16 v[156:157], v7 offset:36864
    v_mfma_f32_16x16x32_bf16 v[32:35], v[132:135], v[184:187], v[32:35]
    ds_read_b64_tr_b16 v[158:159], v7 offset:38912
    v_mfma_f32_16x16x32_bf16 v[48:51], v[136:139], v[184:187], v[48:51]
    ds_read_b64_tr_b16 v[160:161], v8 offset:36864
    v_mfma_f32_16x16x32_bf16 v[64:67], v[140:143], v[184:187], v[64:67]
    ds_read_b64_tr_b16 v[162:163], v8 offset:38912
    v_mfma_f32_16x16x32_bf16 v[80:83], v[144:147], v[184:187], v[80:83]
    ds_read_b64_tr_b16 v[164:165], v9 offset:36864
    v_mfma_f32_16x16x32_bf16 v[96:99], v[148:151], v[184:187], v[96:99]
    ds_read_b64_tr_b16 v[166:167], v9 offset:38912
    v_mfma_f32_16x16x32_bf16 v[112:115], v[152:155], v[184:187], v[112:115]
    ds_read_b64_tr_b16 v[168:169], v10 offset:36864
    s_add_u32 s32, s30, 12288
    buffer_load_dwordx4 v[184:187], v1, s[4:7], s32 offen offset:0 sc1
    v_mfma_f32_16x16x32_bf16 v[20:23], v[128:131], v[188:191], v[20:23]
    ds_read_b64_tr_b16 v[170:171], v10 offset:38912
    v_mfma_f32_16x16x32_bf16 v[36:39], v[132:135], v[188:191], v[36:39]
    ds_read_b64_tr_b16 v[172:173], v11 offset:36864
    v_mfma_f32_16x16x32_bf16 v[52:55], v[136:139], v[188:191], v[52:55]
    ds_read_b64_tr_b16 v[174:175], v11 offset:38912
    v_mfma_f32_16x16x32_bf16 v[68:71], v[140:143], v[188:191], v[68:71]
    ds_read_b64_tr_b16 v[176:177], v12 offset:36864
    v_mfma_f32_16x16x32_bf16 v[84:87], v[144:147], v[188:191], v[84:87]
    ds_read_b64_tr_b16 v[178:179], v12 offset:38912
    v_mfma_f32_16x16x32_bf16 v[100:103], v[148:151], v[188:191], v[100:103]
    ds_read_b64_tr_b16 v[180:181], v13 offset:36864
    v_mfma_f32_16x16x32_bf16 v[116:119], v[152:155], v[188:191], v[116:119]
    ds_read_b64_tr_b16 v[182:183], v13 offset:38912
    s_add_u32 s32, s30, 28672
    buffer_load_dwordx4 v[188:191], v1, s[4:7], s32 offen offset:0 sc1
    v_mfma_f32_16x16x32_bf16 v[24:27], v[128:131], v[192:195], v[24:27]
    v_mfma_f32_16x16x32_bf16 v[40:43], v[132:135], v[192:195], v[40:43]
    v_mfma_f32_16x16x32_bf16 v[56:59], v[136:139], v[192:195], v[56:59]
    v_mfma_f32_16x16x32_bf16 v[72:75], v[140:143], v[192:195], v[72:75]
    v_mfma_f32_16x16x32_bf16 v[88:91], v[144:147], v[192:195], v[88:91]
    v_mfma_f32_16x16x32_bf16 v[104:107], v[148:151], v[192:195], v[104:107]
    v_mfma_f32_16x16x32_bf16 v[120:123], v[152:155], v[192:195], v[120:123]
    s_add_u32 s32, s30, 45056
    buffer_load_dwordx4 v[192:195], v1, s[4:7], s32 offen offset:0 sc1
    v_mfma_f32_16x16x32_bf16 v[28:31], v[128:131], v[196:199], v[28:31]
    v_mfma_f32_16x16x32_bf16 v[44:47], v[132:135], v[196:199], v[44:47]
    v_mfma_f32_16x16x32_bf16 v[60:63], v[136:139], v[196:199], v[60:63]
    v_mfma_f32_16x16x32_bf16 v[76:79], v[140:143], v[196:199], v[76:79]
    v_mfma_f32_16x16x32_bf16 v[92:95], v[144:147], v[196:199], v[92:95]
    v_mfma_f32_16x16x32_bf16 v[108:111], v[148:151], v[196:199], v[108:111]
    v_mfma_f32_16x16x32_bf16 v[124:127], v[152:155], v[196:199], v[124:127]
    s_add_u32 s32, s30, 61440
    buffer_load_dwordx4 v[196:199], v1, s[4:7], s32 offen offset:0 sc1
    s_waitcnt lgkmcnt(0)
    s_waitcnt vmcnt(12)
    v_mfma_f32_16x16x32_bf16 v[16:19], v[156:159], v[200:203], v[16:19]
    ds_read_b64_tr_b16 v[128:129], v7 offset:40960
    v_mfma_f32_16x16x32_bf16 v[32:35], v[160:163], v[200:203], v[32:35]
    ds_read_b64_tr_b16 v[130:131], v7 offset:43008
    v_mfma_f32_16x16x32_bf16 v[48:51], v[164:167], v[200:203], v[48:51]
    ds_read_b64_tr_b16 v[132:133], v8 offset:40960
    v_mfma_f32_16x16x32_bf16 v[64:67], v[168:171], v[200:203], v[64:67]
    ds_read_b64_tr_b16 v[134:135], v8 offset:43008
    v_mfma_f32_16x16x32_bf16 v[80:83], v[172:175], v[200:203], v[80:83]
    ds_read_b64_tr_b16 v[136:137], v9 offset:40960
    v_mfma_f32_16x16x32_bf16 v[96:99], v[176:179], v[200:203], v[96:99]
    ds_read_b64_tr_b16 v[138:139], v9 offset:43008
    v_mfma_f32_16x16x32_bf16 v[112:115], v[180:183], v[200:203], v[112:115]
    ds_read_b64_tr_b16 v[140:141], v10 offset:40960
    s_add_u32 s32, s30, 12288
    buffer_load_dwordx4 v[200:203], v1, s[4:7], s32 offen offset:1024 sc1
    v_mfma_f32_16x16x32_bf16 v[20:23], v[156:159], v[204:207], v[20:23]
    ds_read_b64_tr_b16 v[142:143], v10 offset:43008
    v_mfma_f32_16x16x32_bf16 v[36:39], v[160:163], v[204:207], v[36:39]
    ds_read_b64_tr_b16 v[144:145], v11 offset:40960
    v_mfma_f32_16x16x32_bf16 v[52:55], v[164:167], v[204:207], v[52:55]
    ds_read_b64_tr_b16 v[146:147], v11 offset:43008
    v_mfma_f32_16x16x32_bf16 v[68:71], v[168:171], v[204:207], v[68:71]
    ds_read_b64_tr_b16 v[148:149], v12 offset:40960
    v_mfma_f32_16x16x32_bf16 v[84:87], v[172:175], v[204:207], v[84:87]
    ds_read_b64_tr_b16 v[150:151], v12 offset:43008
    v_mfma_f32_16x16x32_bf16 v[100:103], v[176:179], v[204:207], v[100:103]
    ds_read_b64_tr_b16 v[152:153], v13 offset:40960
    v_mfma_f32_16x16x32_bf16 v[116:119], v[180:183], v[204:207], v[116:119]
    ds_read_b64_tr_b16 v[154:155], v13 offset:43008
    s_add_u32 s32, s30, 28672
    buffer_load_dwordx4 v[204:207], v1, s[4:7], s32 offen offset:1024 sc1
    v_mfma_f32_16x16x32_bf16 v[24:27], v[156:159], v[208:211], v[24:27]
    v_mfma_f32_16x16x32_bf16 v[40:43], v[160:163], v[208:211], v[40:43]
    v_mfma_f32_16x16x32_bf16 v[56:59], v[164:167], v[208:211], v[56:59]
    v_mfma_f32_16x16x32_bf16 v[72:75], v[168:171], v[208:211], v[72:75]
    v_mfma_f32_16x16x32_bf16 v[88:91], v[172:175], v[208:211], v[88:91]
    v_mfma_f32_16x16x32_bf16 v[104:107], v[176:179], v[208:211], v[104:107]
    v_mfma_f32_16x16x32_bf16 v[120:123], v[180:183], v[208:211], v[120:123]
    s_add_u32 s32, s30, 45056
    buffer_load_dwordx4 v[208:211], v1, s[4:7], s32 offen offset:1024 sc1
    v_mfma_f32_16x16x32_bf16 v[28:31], v[156:159], v[212:215], v[28:31]
    v_mfma_f32_16x16x32_bf16 v[44:47], v[160:163], v[212:215], v[44:47]
    v_mfma_f32_16x16x32_bf16 v[60:63], v[164:167], v[212:215], v[60:63]
    v_mfma_f32_16x16x32_bf16 v[76:79], v[168:171], v[212:215], v[76:79]
    v_mfma_f32_16x16x32_bf16 v[92:95], v[172:175], v[212:215], v[92:95]
    v_mfma_f32_16x16x32_bf16 v[108:111], v[176:179], v[212:215], v[108:111]
    v_mfma_f32_16x16x32_bf16 v[124:127], v[180:183], v[212:215], v[124:127]
    s_add_u32 s32, s30, 61440
    buffer_load_dwordx4 v[212:215], v1, s[4:7], s32 offen offset:1024 sc1
    s_waitcnt lgkmcnt(0)
    s_waitcnt vmcnt(12)
    v_mfma_f32_16x16x32_bf16 v[16:19], v[128:131], v[216:219], v[16:19]
    ds_read_b64_tr_b16 v[156:157], v7 offset:45056
    v_mfma_f32_16x16x32_bf16 v[32:35], v[132:135], v[216:219], v[32:35]
    ds_read_b64_tr_b16 v[158:159], v7 offset:47104
    v_mfma_f32_16x16x32_bf16 v[48:51], v[136:139], v[216:219], v[48:51]
    ds_read_b64_tr_b16 v[160:161], v8 offset:45056
    v_mfma_f32_16x16x32_bf16 v[64:67], v[140:143], v[216:219], v[64:67]
    ds_read_b64_tr_b16 v[162:163], v8 offset:47104
    v_mfma_f32_16x16x32_bf16 v[80:83], v[144:147], v[216:219], v[80:83]
    ds_read_b64_tr_b16 v[164:165], v9 offset:45056
    v_mfma_f32_16x16x32_bf16 v[96:99], v[148:151], v[216:219], v[96:99]
    ds_read_b64_tr_b16 v[166:167], v9 offset:47104
    v_mfma_f32_16x16x32_bf16 v[112:115], v[152:155], v[216:219], v[112:115]
    ds_read_b64_tr_b16 v[168:169], v10 offset:45056
    s_add_u32 s32, s30, 12288
    buffer_load_dwordx4 v[216:219], v1, s[4:7], s32 offen offset:2048 sc1
    v_mfma_f32_16x16x32_bf16 v[20:23], v[128:131], v[220:223], v[20:23]
    ds_read_b64_tr_b16 v[170:171], v10 offset:47104
    v_mfma_f32_16x16x32_bf16 v[36:39], v[132:135], v[220:223], v[36:39]
    ds_read_b64_tr_b16 v[172:173], v11 offset:45056
    v_mfma_f32_16x16x32_bf16 v[52:55], v[136:139], v[220:223], v[52:55]
    ds_read_b64_tr_b16 v[174:175], v11 offset:47104
    v_mfma_f32_16x16x32_bf16 v[68:71], v[140:143], v[220:223], v[68:71]
    ds_read_b64_tr_b16 v[176:177], v12 offset:45056
    v_mfma_f32_16x16x32_bf16 v[84:87], v[144:147], v[220:223], v[84:87]
    ds_read_b64_tr_b16 v[178:179], v12 offset:47104
    v_mfma_f32_16x16x32_bf16 v[100:103], v[148:151], v[220:223], v[100:103]
    ds_read_b64_tr_b16 v[180:181], v13 offset:45056
    v_mfma_f32_16x16x32_bf16 v[116:119], v[152:155], v[220:223], v[116:119]
    ds_read_b64_tr_b16 v[182:183], v13 offset:47104
    s_add_u32 s32, s30, 28672
    buffer_load_dwordx4 v[220:223], v1, s[4:7], s32 offen offset:2048 sc1
    v_mfma_f32_16x16x32_bf16 v[24:27], v[128:131], v[224:227], v[24:27]
    v_mfma_f32_16x16x32_bf16 v[40:43], v[132:135], v[224:227], v[40:43]
    v_mfma_f32_16x16x32_bf16 v[56:59], v[136:139], v[224:227], v[56:59]
    v_mfma_f32_16x16x32_bf16 v[72:75], v[140:143], v[224:227], v[72:75]
    v_mfma_f32_16x16x32_bf16 v[88:91], v[144:147], v[224:227], v[88:91]
    v_mfma_f32_16x16x32_bf16 v[104:107], v[148:151], v[224:227], v[104:107]
    v_mfma_f32_16x16x32_bf16 v[120:123], v[152:155], v[224:227], v[120:123]
    s_add_u32 s32, s30, 45056
    buffer_load_dwordx4 v[224:227], v1, s[4:7], s32 offen offset:2048 sc1
    v_mfma_f32_16x16x32_bf16 v[28:31], v[128:131], v[228:231], v[28:31]
    v_mfma_f32_16x16x32_bf16 v[44:47], v[132:135], v[228:231], v[44:47]
    v_mfma_f32_16x16x32_bf16 v[60:63], v[136:139], v[228:231], v[60:63]
    v_mfma_f32_16x16x32_bf16 v[76:79], v[140:143], v[228:231], v[76:79]
    v_mfma_f32_16x16x32_bf16 v[92:95], v[144:147], v[228:231], v[92:95]
    v_mfma_f32_16x16x32_bf16 v[108:111], v[148:151], v[228:231], v[108:111]
    v_mfma_f32_16x16x32_bf16 v[124:127], v[152:155], v[228:231], v[124:127]
    s_add_u32 s32, s30, 61440
    buffer_load_dwordx4 v[228:231], v1, s[4:7], s32 offen offset:2048 sc1
    s_waitcnt lgkmcnt(0)
    s_waitcnt vmcnt(12)
    v_mfma_f32_16x16x32_bf16 v[16:19], v[156:159], v[232:235], v[16:19]
    ds_read_b64_tr_b16 v[128:129], v7 offset:49152
    v_mfma_f32_16x16x32_bf16 v[32:35], v[160:163], v[232:235], v[32:35]
    ds_read_b64_tr_b16 v[130:131], v7 offset:51200
    v_mfma_f32_16x16x32_bf16 v[48:51], v[164:167], v[232:235], v[48:51]
    ds_read_b64_tr_b16 v[132:133], v8 offset:49152
    v_mfma_f32_16x16x32_bf16 v[64:67], v[168:171], v[232:235], v[64:67]
    ds_read_b64_tr_b16 v[134:135], v8 offset:51200
    v_mfma_f32_16x16x32_bf16 v[80:83], v[172:175], v[232:235], v[80:83]
    ds_read_b64_tr_b16 v[136:137], v9 offset:49152
    v_mfma_f32_16x16x32_bf16 v[96:99], v[176:179], v[232:235], v[96:99]
    ds_read_b64_tr_b16 v[138:139], v9 offset:51200
    v_mfma_f32_16x16x32_bf16 v[112:115], v[180:183], v[232:235], v[112:115]
    ds_read_b64_tr_b16 v[140:141], v10 offset:49152
    s_add_u32 s32, s30, 12288
    buffer_load_dwordx4 v[232:235], v1, s[4:7], s32 offen offset:3072 sc1
    v_mfma_f32_16x16x32_bf16 v[20:23], v[156:159], v[236:239], v[20:23]
    ds_read_b64_tr_b16 v[142:143], v10 offset:51200
    v_mfma_f32_16x16x32_bf16 v[36:39], v[160:163], v[236:239], v[36:39]
    ds_read_b64_tr_b16 v[144:145], v11 offset:49152
    v_mfma_f32_16x16x32_bf16 v[52:55], v[164:167], v[236:239], v[52:55]
    ds_read_b64_tr_b16 v[146:147], v11 offset:51200
    v_mfma_f32_16x16x32_bf16 v[68:71], v[168:171], v[236:239], v[68:71]
    ds_read_b64_tr_b16 v[148:149], v12 offset:49152
    v_mfma_f32_16x16x32_bf16 v[84:87], v[172:175], v[236:239], v[84:87]
    ds_read_b64_tr_b16 v[150:151], v12 offset:51200
    v_mfma_f32_16x16x32_bf16 v[100:103], v[176:179], v[236:239], v[100:103]
    ds_read_b64_tr_b16 v[152:153], v13 offset:49152
    v_mfma_f32_16x16x32_bf16 v[116:119], v[180:183], v[236:239], v[116:119]
    ds_read_b64_tr_b16 v[154:155], v13 offset:51200
    s_add_u32 s32, s30, 28672
    buffer_load_dwordx4 v[236:239], v1, s[4:7], s32 offen offset:3072 sc1
    v_mfma_f32_16x16x32_bf16 v[24:27], v[156:159], v[240:243], v[24:27]
    v_mfma_f32_16x16x32_bf16 v[40:43], v[160:163], v[240:243], v[40:43]
    v_mfma_f32_16x16x32_bf16 v[56:59], v[164:167], v[240:243], v[56:59]
    v_mfma_f32_16x16x32_bf16 v[72:75], v[168:171], v[240:243], v[72:75]
    v_mfma_f32_16x16x32_bf16 v[88:91], v[172:175], v[240:243], v[88:91]
    v_mfma_f32_16x16x32_bf16 v[104:107], v[176:179], v[240:243], v[104:107]
    v_mfma_f32_16x16x32_bf16 v[120:123], v[180:183], v[240:243], v[120:123]
    s_add_u32 s32, s30, 45056
    buffer_load_dwordx4 v[240:243], v1, s[4:7], s32 offen offset:3072 sc1
    v_mfma_f32_16x16x32_bf16 v[28:31], v[156:159], v[244:247], v[28:31]
    v_mfma_f32_16x16x32_bf16 v[44:47], v[160:163], v[244:247], v[44:47]
    v_mfma_f32_16x16x32_bf16 v[60:63], v[164:167], v[244:247], v[60:63]
    v_mfma_f32_16x16x32_bf16 v[76:79], v[168:171], v[244:247], v[76:79]
    v_mfma_f32_16x16x32_bf16 v[92:95], v[172:175], v[244:247], v[92:95]
    v_mfma_f32_16x16x32_bf16 v[108:111], v[176:179], v[244:247], v[108:111]
    v_mfma_f32_16x16x32_bf16 v[124:127], v[180:183], v[244:247], v[124:127]
    s_add_u32 s32, s30, 61440
    buffer_load_dwordx4 v[244:247], v1, s[4:7], s32 offen offset:3072 sc1
    s_waitcnt lgkmcnt(0)
    s_waitcnt vmcnt(12)
    v_mfma_f32_16x16x32_bf16 v[16:19], v[128:131], v[184:187], v[16:19]
    ds_read_b64_tr_b16 v[156:157], v7 offset:53248
    v_mfma_f32_16x16x32_bf16 v[32:35], v[132:135], v[184:187], v[32:35]
    ds_read_b64_tr_b16 v[158:159], v7 offset:55296
    v_mfma_f32_16x16x32_bf16 v[48:51], v[136:139], v[184:187], v[48:51]
    ds_read_b64_tr_b16 v[160:161], v8 offset:53248
    v_mfma_f32_16x16x32_bf16 v[64:67], v[140:143], v[184:187], v[64:67]
    ds_read_b64_tr_b16 v[162:163], v8 offset:55296
    v_mfma_f32_16x16x32_bf16 v[80:83], v[144:147], v[184:187], v[80:83]
    ds_read_b64_tr_b16 v[164:165], v9 offset:53248
    v_mfma_f32_16x16x32_bf16 v[96:99], v[148:151], v[184:187], v[96:99]
    ds_read_b64_tr_b16 v[166:167], v9 offset:55296
    v_mfma_f32_16x16x32_bf16 v[112:115], v[152:155], v[184:187], v[112:115]
    ds_read_b64_tr_b16 v[168:169], v10 offset:53248
    buffer_load_dwordx2 v[184:185], v15, s[4:7], s33 offen offset:0 sc1
    buffer_load_dwordx2 v[186:187], v15, s[4:7], s33 offen offset:512 sc1
    v_mfma_f32_16x16x32_bf16 v[20:23], v[128:131], v[188:191], v[20:23]
    ds_read_b64_tr_b16 v[170:171], v10 offset:55296
    v_mfma_f32_16x16x32_bf16 v[36:39], v[132:135], v[188:191], v[36:39]
    ds_read_b64_tr_b16 v[172:173], v11 offset:53248
    v_mfma_f32_16x16x32_bf16 v[52:55], v[136:139], v[188:191], v[52:55]
    ds_read_b64_tr_b16 v[174:175], v11 offset:55296
    v_mfma_f32_16x16x32_bf16 v[68:71], v[140:143], v[188:191], v[68:71]
    ds_read_b64_tr_b16 v[176:177], v12 offset:53248
    v_mfma_f32_16x16x32_bf16 v[84:87], v[144:147], v[188:191], v[84:87]
    ds_read_b64_tr_b16 v[178:179], v12 offset:55296
    v_mfma_f32_16x16x32_bf16 v[100:103], v[148:151], v[188:191], v[100:103]
    ds_read_b64_tr_b16 v[180:181], v13 offset:53248
    v_mfma_f32_16x16x32_bf16 v[116:119], v[152:155], v[188:191], v[116:119]
    ds_read_b64_tr_b16 v[182:183], v13 offset:55296
    buffer_load_dwordx2 v[188:189], v15, s[4:7], s33 offen offset:1024 sc1
    buffer_load_dwordx2 v[190:191], v15, s[4:7], s33 offen offset:1536 sc1
    v_mfma_f32_16x16x32_bf16 v[24:27], v[128:131], v[192:195], v[24:27]
    v_mfma_f32_16x16x32_bf16 v[40:43], v[132:135], v[192:195], v[40:43]
    v_mfma_f32_16x16x32_bf16 v[56:59], v[136:139], v[192:195], v[56:59]
    v_mfma_f32_16x16x32_bf16 v[72:75], v[140:143], v[192:195], v[72:75]
    v_mfma_f32_16x16x32_bf16 v[88:91], v[144:147], v[192:195], v[88:91]
    v_mfma_f32_16x16x32_bf16 v[104:107], v[148:151], v[192:195], v[104:107]
    v_mfma_f32_16x16x32_bf16 v[120:123], v[152:155], v[192:195], v[120:123]
    buffer_load_dwordx2 v[192:193], v15, s[4:7], s33 offen offset:2048 sc1
    buffer_load_dwordx2 v[194:195], v15, s[4:7], s33 offen offset:2560 sc1
    v_mfma_f32_16x16x32_bf16 v[28:31], v[128:131], v[196:199], v[28:31]
    v_mfma_f32_16x16x32_bf16 v[44:47], v[132:135], v[196:199], v[44:47]
    v_mfma_f32_16x16x32_bf16 v[60:63], v[136:139], v[196:199], v[60:63]
    v_mfma_f32_16x16x32_bf16 v[76:79], v[140:143], v[196:199], v[76:79]
    v_mfma_f32_16x16x32_bf16 v[92:95], v[144:147], v[196:199], v[92:95]
    v_mfma_f32_16x16x32_bf16 v[108:111], v[148:151], v[196:199], v[108:111]
    v_mfma_f32_16x16x32_bf16 v[124:127], v[152:155], v[196:199], v[124:127]
    buffer_load_dwordx2 v[196:197], v15, s[4:7], s33 offen offset:3072 sc1
    buffer_load_dwordx2 v[198:199], v15, s[4:7], s33 offen offset:3584 sc1
    s_waitcnt lgkmcnt(0)
    s_waitcnt vmcnt(16)
    v_mfma_f32_16x16x32_bf16 v[16:19], v[156:159], v[200:203], v[16:19]
    ds_read_b64_tr_b16 v[128:129], v7 offset:57344
    v_mfma_f32_16x16x32_bf16 v[32:35], v[160:163], v[200:203], v[32:35]
    ds_read_b64_tr_b16 v[130:131], v7 offset:59392
    v_mfma_f32_16x16x32_bf16 v[48:51], v[164:167], v[200:203], v[48:51]
    ds_read_b64_tr_b16 v[132:133], v8 offset:57344
    v_mfma_f32_16x16x32_bf16 v[64:67], v[168:171], v[200:203], v[64:67]
    ds_read_b64_tr_b16 v[134:135], v8 offset:59392
    v_mfma_f32_16x16x32_bf16 v[80:83], v[172:175], v[200:203], v[80:83]
    ds_read_b64_tr_b16 v[136:137], v9 offset:57344
    v_mfma_f32_16x16x32_bf16 v[96:99], v[176:179], v[200:203], v[96:99]
    ds_read_b64_tr_b16 v[138:139], v9 offset:59392
    v_mfma_f32_16x16x32_bf16 v[112:115], v[180:183], v[200:203], v[112:115]
    ds_read_b64_tr_b16 v[140:141], v10 offset:57344
    v_mfma_f32_16x16x32_bf16 v[20:23], v[156:159], v[204:207], v[20:23]
    ds_read_b64_tr_b16 v[142:143], v10 offset:59392
    v_mfma_f32_16x16x32_bf16 v[36:39], v[160:163], v[204:207], v[36:39]
    ds_read_b64_tr_b16 v[144:145], v11 offset:57344
    v_mfma_f32_16x16x32_bf16 v[52:55], v[164:167], v[204:207], v[52:55]
    ds_read_b64_tr_b16 v[146:147], v11 offset:59392
    v_mfma_f32_16x16x32_bf16 v[68:71], v[168:171], v[204:207], v[68:71]
    ds_read_b64_tr_b16 v[148:149], v12 offset:57344
    v_mfma_f32_16x16x32_bf16 v[84:87], v[172:175], v[204:207], v[84:87]
    ds_read_b64_tr_b16 v[150:151], v12 offset:59392
    v_mfma_f32_16x16x32_bf16 v[100:103], v[176:179], v[204:207], v[100:103]
    ds_read_b64_tr_b16 v[152:153], v13 offset:57344
    v_mfma_f32_16x16x32_bf16 v[116:119], v[180:183], v[204:207], v[116:119]
    ds_read_b64_tr_b16 v[154:155], v13 offset:59392
    v_mfma_f32_16x16x32_bf16 v[24:27], v[156:159], v[208:211], v[24:27]
    v_mfma_f32_16x16x32_bf16 v[40:43], v[160:163], v[208:211], v[40:43]
    v_mfma_f32_16x16x32_bf16 v[56:59], v[164:167], v[208:211], v[56:59]
    v_mfma_f32_16x16x32_bf16 v[72:75], v[168:171], v[208:211], v[72:75]
    v_mfma_f32_16x16x32_bf16 v[88:91], v[172:175], v[208:211], v[88:91]
    v_mfma_f32_16x16x32_bf16 v[104:107], v[176:179], v[208:211], v[104:107]
    v_mfma_f32_16x16x32_bf16 v[120:123], v[180:183], v[208:211], v[120:123]
    v_mfma_f32_16x16x32_bf16 v[28:31], v[156:159], v[212:215], v[28:31]
    v_mfma_f32_16x16x32_bf16 v[44:47], v[160:163], v[212:215], v[44:47]
    v_mfma_f32_16x16x32_bf16 v[60:63], v[164:167], v[212:215], v[60:63]
    v_mfma_f32_16x16x32_bf16 v[76:79], v[168:171], v[212:215], v[76:79]
    v_mfma_f32_16x16x32_bf16 v[92:95], v[172:175], v[212:215], v[92:95]
    v_mfma_f32_16x16x32_bf16 v[108:111], v[176:179], v[212:215], v[108:111]
    v_mfma_f32_16x16x32_bf16 v[124:127], v[180:183], v[212:215], v[124:127]
    s_waitcnt lgkmcnt(0)
    s_waitcnt vmcnt(12)
    v_mfma_f32_16x16x32_bf16 v[16:19], v[128:131], v[216:219], v[16:19]
    ds_read_b64_tr_b16 v[156:157], v7 offset:61440
    v_mfma_f32_16x16x32_bf16 v[32:35], v[132:135], v[216:219], v[32:35]
    ds_read_b64_tr_b16 v[158:159], v7 offset:63488
    v_mfma_f32_16x16x32_bf16 v[48:51], v[136:139], v[216:219], v[48:51]
    ds_read_b64_tr_b16 v[160:161], v8 offset:61440
    v_mfma_f32_16x16x32_bf16 v[64:67], v[140:143], v[216:219], v[64:67]
    ds_read_b64_tr_b16 v[162:163], v8 offset:63488
    v_mfma_f32_16x16x32_bf16 v[80:83], v[144:147], v[216:219], v[80:83]
    ds_read_b64_tr_b16 v[164:165], v9 offset:61440
    v_mfma_f32_16x16x32_bf16 v[96:99], v[148:151], v[216:219], v[96:99]
    ds_read_b64_tr_b16 v[166:167], v9 offset:63488
    v_mfma_f32_16x16x32_bf16 v[112:115], v[152:155], v[216:219], v[112:115]
    ds_read_b64_tr_b16 v[168:169], v10 offset:61440
    v_mfma_f32_16x16x32_bf16 v[20:23], v[128:131], v[220:223], v[20:23]
    ds_read_b64_tr_b16 v[170:171], v10 offset:63488
    v_mfma_f32_16x16x32_bf16 v[36:39], v[132:135], v[220:223], v[36:39]
    ds_read_b64_tr_b16 v[172:173], v11 offset:61440
    v_mfma_f32_16x16x32_bf16 v[52:55], v[136:139], v[220:223], v[52:55]
    ds_read_b64_tr_b16 v[174:175], v11 offset:63488
    v_mfma_f32_16x16x32_bf16 v[68:71], v[140:143], v[220:223], v[68:71]
    ds_read_b64_tr_b16 v[176:177], v12 offset:61440
    v_mfma_f32_16x16x32_bf16 v[84:87], v[144:147], v[220:223], v[84:87]
    ds_read_b64_tr_b16 v[178:179], v12 offset:63488
    v_mfma_f32_16x16x32_bf16 v[100:103], v[148:151], v[220:223], v[100:103]
    ds_read_b64_tr_b16 v[180:181], v13 offset:61440
    v_mfma_f32_16x16x32_bf16 v[116:119], v[152:155], v[220:223], v[116:119]
    ds_read_b64_tr_b16 v[182:183], v13 offset:63488
    v_mfma_f32_16x16x32_bf16 v[24:27], v[128:131], v[224:227], v[24:27]
    v_mfma_f32_16x16x32_bf16 v[40:43], v[132:135], v[224:227], v[40:43]
    v_mfma_f32_16x16x32_bf16 v[56:59], v[136:139], v[224:227], v[56:59]
    v_mfma_f32_16x16x32_bf16 v[72:75], v[140:143], v[224:227], v[72:75]
    v_mfma_f32_16x16x32_bf16 v[88:91], v[144:147], v[224:227], v[88:91]
    v_mfma_f32_16x16x32_bf16 v[104:107], v[148:151], v[224:227], v[104:107]
    v_mfma_f32_16x16x32_bf16 v[120:123], v[152:155], v[224:227], v[120:123]
    v_mfma_f32_16x16x32_bf16 v[28:31], v[128:131], v[228:231], v[28:31]
    v_mfma_f32_16x16x32_bf16 v[44:47], v[132:135], v[228:231], v[44:47]
    v_mfma_f32_16x16x32_bf16 v[60:63], v[136:139], v[228:231], v[60:63]
    v_mfma_f32_16x16x32_bf16 v[76:79], v[140:143], v[228:231], v[76:79]
    v_mfma_f32_16x16x32_bf16 v[92:95], v[144:147], v[228:231], v[92:95]
    v_mfma_f32_16x16x32_bf16 v[108:111], v[148:151], v[228:231], v[108:111]
    v_mfma_f32_16x16x32_bf16 v[124:127], v[152:155], v[228:231], v[124:127]
    s_waitcnt lgkmcnt(0)
    s_waitcnt vmcnt(8)
    s_nop 5
L_sequential_preLN__sliding_local_dilated__geglu_ffn__prompt_kernel_ccs:
    ds_read_b32 v249, v248 offset:96
    s_waitcnt lgkmcnt(0)
    v_readfirstlane_b32 s40, v249
    s_nop 1
    s_cmp_lt_u32 s40, 4
    s_nop 1
    s_cbranch_scc1 L_sequential_preLN__sliding_local_dilated__geglu_ffn__prompt_kernel_ccs
    v_mfma_f32_16x16x32_bf16 v[16:19], v[156:159], v[232:235], v[16:19]
    ds_read_b128 v[128:131], v14 offset:0
    s_waitcnt vmcnt(0)
    v_add_f32 v184, v184, v186
    v_add_f32 v185, v185, v187
    v_add_f32 v188, v188, v190
    v_mfma_f32_16x16x32_bf16 v[32:35], v[160:163], v[232:235], v[32:35]
    ds_read_b128 v[132:135], v14 offset:64
    v_add_f32 v189, v189, v191
    v_add_f32 v192, v192, v194
    v_add_f32 v193, v193, v195
    v_add_f32 v196, v196, v198
    v_mfma_f32_16x16x32_bf16 v[48:51], v[164:167], v[232:235], v[48:51]
    ds_read_b128 v[136:139], v14 offset:128
    v_add_f32 v197, v197, v199
    v_mov_b32 v186, v184
    v_mov_b32 v187, v185
    v_mfma_f32_16x16x32_bf16 v[64:67], v[168:171], v[232:235], v[64:67]
    ds_read_b128 v[140:143], v14 offset:192
    v_mov_b32 v190, v188
    v_mov_b32 v191, v189
    v_mov_b32 v194, v192
    v_mov_b32 v195, v193
    v_mfma_f32_16x16x32_bf16 v[80:83], v[172:175], v[232:235], v[80:83]
    ds_read_b128 v[144:147], v14 offset:256
    v_mov_b32 v198, v196
    v_mov_b32 v199, v197
    v_permlane32_swap_b32 v184, v186
    v_permlane32_swap_b32 v185, v187
    v_mfma_f32_16x16x32_bf16 v[96:99], v[176:179], v[232:235], v[96:99]
    ds_read_b128 v[148:151], v14 offset:320
    v_permlane32_swap_b32 v188, v190
    v_permlane32_swap_b32 v189, v191
    v_permlane32_swap_b32 v192, v194
    v_mfma_f32_16x16x32_bf16 v[112:115], v[180:183], v[232:235], v[112:115]
    ds_read_b128 v[152:155], v14 offset:384
    v_permlane32_swap_b32 v193, v195
    v_permlane32_swap_b32 v196, v198
    v_permlane32_swap_b32 v197, v199
    v_add_f32 v184, v184, v186
    v_mfma_f32_16x16x32_bf16 v[20:23], v[156:159], v[236:239], v[20:23]
    v_add_f32 v185, v185, v187
    v_add_f32 v188, v188, v190
    v_add_f32 v189, v189, v191
    v_mfma_f32_16x16x32_bf16 v[36:39], v[160:163], v[236:239], v[36:39]
    v_add_f32 v192, v192, v194
    v_add_f32 v193, v193, v195
    v_add_f32 v196, v196, v198
    v_add_f32 v197, v197, v199
    v_mfma_f32_16x16x32_bf16 v[52:55], v[164:167], v[236:239], v[52:55]
    v_mov_b32 v186, v184
    v_mov_b32 v187, v185
    v_mov_b32 v190, v188
    v_mov_b32 v191, v189
    v_mfma_f32_16x16x32_bf16 v[68:71], v[168:171], v[236:239], v[68:71]
    v_mov_b32 v194, v192
    v_mov_b32 v195, v193
    v_mov_b32 v198, v196
    v_mfma_f32_16x16x32_bf16 v[84:87], v[172:175], v[236:239], v[84:87]
    v_mov_b32 v199, v197
    v_permlane16_swap_b32 v184, v186
    v_permlane16_swap_b32 v185, v187
    v_permlane16_swap_b32 v188, v190
    v_mfma_f32_16x16x32_bf16 v[100:103], v[176:179], v[236:239], v[100:103]
    v_permlane16_swap_b32 v189, v191
    v_permlane16_swap_b32 v192, v194
    v_permlane16_swap_b32 v193, v195
    v_mfma_f32_16x16x32_bf16 v[116:119], v[180:183], v[236:239], v[116:119]
    v_permlane16_swap_b32 v196, v198
    v_permlane16_swap_b32 v197, v199
    v_add_f32 v184, v184, v186
    v_add_f32 v185, v185, v187
    v_mfma_f32_16x16x32_bf16 v[24:27], v[156:159], v[240:243], v[24:27]
    v_add_f32 v188, v188, v190
    v_add_f32 v189, v189, v191
    v_add_f32 v192, v192, v194
    v_add_f32 v193, v193, v195
    v_mfma_f32_16x16x32_bf16 v[40:43], v[160:163], v[240:243], v[40:43]
    v_add_f32 v196, v196, v198
    v_add_f32 v197, v197, v199
    v_mul_f32 v184, -0.001953125, v184
    v_mfma_f32_16x16x32_bf16 v[56:59], v[164:167], v[240:243], v[56:59]
    v_mul_f32 v185, 0.001953125, v185
    v_fma_f32 v185, -v184, v184, v185
    v_max_f32 v185, 0, v185
    v_add_f32 v186, 0x3727c5ac, v185
    v_mfma_f32_16x16x32_bf16 v[72:75], v[168:171], v[240:243], v[72:75]
    v_rsq_f32 v185, v186
    v_mov_b32 v187, v184
    v_mul_f32 v184, 0xc0135761, v185
    v_mfma_f32_16x16x32_bf16 v[88:91], v[172:175], v[240:243], v[88:91]
    v_mul_f32 v248, v185, v185
    v_mul_f32 v185, v248, v184
    v_mul_f32 v185, 0x3d372713, v185
    v_mul_f32 v188, -0.001953125, v188
    v_mfma_f32_16x16x32_bf16 v[104:107], v[176:179], v[240:243], v[104:107]
    v_mul_f32 v189, 0.001953125, v189
    v_fma_f32 v189, -v188, v188, v189
    v_max_f32 v189, 0, v189
    v_add_f32 v190, 0x3727c5ac, v189
    v_mfma_f32_16x16x32_bf16 v[120:123], v[180:183], v[240:243], v[120:123]
    v_rsq_f32 v189, v190
    v_mov_b32 v191, v188
    v_mul_f32 v188, 0xc0135761, v189
    v_mfma_f32_16x16x32_bf16 v[28:31], v[156:159], v[244:247], v[28:31]
    v_mul_f32 v248, v189, v189
    v_mul_f32 v189, v248, v188
    v_mul_f32 v189, 0x3d372713, v189
    v_mul_f32 v192, -0.001953125, v192
    v_mfma_f32_16x16x32_bf16 v[44:47], v[160:163], v[244:247], v[44:47]
    v_mul_f32 v193, 0.001953125, v193
    v_fma_f32 v193, -v192, v192, v193
    v_max_f32 v193, 0, v193
    v_mfma_f32_16x16x32_bf16 v[60:63], v[164:167], v[244:247], v[60:63]
    v_add_f32 v194, 0x3727c5ac, v193
    v_rsq_f32 v193, v194
    v_mov_b32 v195, v192
    v_mul_f32 v192, 0xc0135761, v193
    v_mfma_f32_16x16x32_bf16 v[76:79], v[168:171], v[244:247], v[76:79]
    v_mul_f32 v248, v193, v193
    v_mul_f32 v193, v248, v192
    v_mul_f32 v193, 0x3d372713, v193
    v_mul_f32 v196, -0.001953125, v196
    v_mfma_f32_16x16x32_bf16 v[92:95], v[172:175], v[244:247], v[92:95]
    v_mul_f32 v197, 0.001953125, v197
    v_fma_f32 v197, -v196, v196, v197
    v_max_f32 v197, 0, v197
    v_mfma_f32_16x16x32_bf16 v[108:111], v[176:179], v[244:247], v[108:111]
    v_add_f32 v198, 0x3727c5ac, v197
    v_rsq_f32 v197, v198
    v_mov_b32 v199, v196
    v_mul_f32 v196, 0xc0135761, v197
    v_mfma_f32_16x16x32_bf16 v[124:127], v[180:183], v[244:247], v[124:127]
    v_mul_f32 v248, v197, v197
    v_mul_f32 v197, v248, v196
    v_mul_f32 v197, 0x3d372713, v197
    s_waitcnt lgkmcnt(0)
    s_barrier
    s_mov_b32 s56, 0
    s_mov_b32 s57, -1
    v_and_b32 v8, 1, v5
    v_lshlrev_b32 v8, 8, v8
    v_lshl_add_u32 v8, v6, 4, v8
    v_lshrrev_b32 v9, 1, v5
    v_mul_u32_u24 v10, 57344, v9
    v_add_u32 v8, v10, v8
    v_and_b32 v11, 1, v5
    v_lshl_add_u32 v9, v11, 1, v9
    v_mul_u32_u24 v9, 57344, v9
    v_lshl_add_u32 v9, v6, 4, v9
    s_mul_i32 s36, s94, 917504
    s_mul_i32 s37, s26, 229376
    s_add_u32 s36, s36, s37
    s_mul_i32 s37, s95, 1792
    s_add_u32 s36, s36, s37
    s_add_u32 s36, s36, 4194304
    v_pk_fma_f32 v[16:17], v[128:129], v[186:187], v[16:17] op_sel:[0,1,0] op_sel_hi:[1,1,1]
    v_pk_fma_f32 v[18:19], v[130:131], v[186:187], v[18:19] op_sel:[0,1,0] op_sel_hi:[1,1,1]
    v_pk_fma_f32 v[64:65], v[140:141], v[186:187], v[64:65] op_sel:[0,1,0] op_sel_hi:[1,1,1]
    v_pk_fma_f32 v[66:67], v[142:143], v[186:187], v[66:67] op_sel:[0,1,0] op_sel_hi:[1,1,1]
    v_pk_mul_f32 v[156:157], v[16:17], v[16:17]
    v_pk_fma_f32 v[156:157], v[156:157], v[184:185], v[184:185] op_sel:[0,1,0] op_sel_hi:[1,1,0]
    v_pk_mul_f32 v[156:157], v[156:157], v[16:17]
    v_pk_mul_f32 v[160:161], v[18:19], v[18:19]
    v_pk_fma_f32 v[160:161], v[160:161], v[184:185], v[184:185] op_sel:[0,1,0] op_sel_hi:[1,1,0]
    v_pk_mul_f32 v[160:161], v[160:161], v[18:19]
    v_exp_f32 v156, v156
    v_exp_f32 v157, v157
    v_exp_f32 v160, v160
    v_exp_f32 v161, v161
    v_pk_mul_f32 v[158:159], v[16:17], v[64:65]
    v_pk_fma_f32 v[156:157], v[156:157], v[186:187], v[186:187] op_sel_hi:[1,0,0]
    v_pk_mul_f32 v[162:163], v[18:19], v[66:67]
    v_pk_fma_f32 v[160:161], v[160:161], v[186:187], v[186:187] op_sel_hi:[1,0,0]
    v_rcp_f32 v156, v156
    v_rcp_f32 v157, v157
    v_rcp_f32 v160, v160
    v_rcp_f32 v161, v161
    v_pk_mul_f32 v[156:157], v[156:157], v[158:159]
    v_pk_mul_f32 v[160:161], v[160:161], v[162:163]
    v_cvt_pk_bf16_f32 v208, v156, v157
    v_cvt_pk_bf16_f32 v209, v160, v161
    v_pk_fma_f32 v[32:33], v[132:133], v[186:187], v[32:33] op_sel:[0,1,0] op_sel_hi:[1,1,1]
    v_pk_fma_f32 v[34:35], v[134:135], v[186:187], v[34:35] op_sel:[0,1,0] op_sel_hi:[1,1,1]
    v_pk_fma_f32 v[80:81], v[144:145], v[186:187], v[80:81] op_sel:[0,1,0] op_sel_hi:[1,1,1]
    v_pk_fma_f32 v[82:83], v[146:147], v[186:187], v[82:83] op_sel:[0,1,0] op_sel_hi:[1,1,1]
    v_pk_mul_f32 v[164:165], v[32:33], v[32:33]
    v_pk_fma_f32 v[164:165], v[164:165], v[184:185], v[184:185] op_sel:[0,1,0] op_sel_hi:[1,1,0]
    v_pk_mul_f32 v[164:165], v[164:165], v[32:33]
    v_pk_mul_f32 v[168:169], v[34:35], v[34:35]
    v_pk_fma_f32 v[168:169], v[168:169], v[184:185], v[184:185] op_sel:[0,1,0] op_sel_hi:[1,1,0]
    v_pk_mul_f32 v[168:169], v[168:169], v[34:35]
    v_exp_f32 v164, v164
    v_exp_f32 v165, v165
    v_exp_f32 v168, v168
    v_exp_f32 v169, v169
    v_pk_mul_f32 v[166:167], v[32:33], v[80:81]
    v_pk_fma_f32 v[164:165], v[164:165], v[186:187], v[186:187] op_sel_hi:[1,0,0]
    v_pk_mul_f32 v[170:171], v[34:35], v[82:83]
    v_pk_fma_f32 v[168:169], v[168:169], v[186:187], v[186:187] op_sel_hi:[1,0,0]
    v_rcp_f32 v164, v164
    v_rcp_f32 v165, v165
    v_rcp_f32 v168, v168
    v_rcp_f32 v169, v169
    v_pk_mul_f32 v[164:165], v[164:165], v[166:167]
    v_pk_mul_f32 v[168:169], v[168:169], v[170:171]
    v_cvt_pk_bf16_f32 v210, v164, v165
    v_cvt_pk_bf16_f32 v211, v168, v169
    s_add_u32 s37, s36, 0
    buffer_store_dwordx4 v[208:211], v1, s[4:7], s37 offen sc1
    v_pk_fma_f32 v[20:21], v[128:129], v[190:191], v[20:21] op_sel:[0,1,0] op_sel_hi:[1,1,1]
    v_pk_fma_f32 v[22:23], v[130:131], v[190:191], v[22:23] op_sel:[0,1,0] op_sel_hi:[1,1,1]
    v_pk_fma_f32 v[68:69], v[140:141], v[190:191], v[68:69] op_sel:[0,1,0] op_sel_hi:[1,1,1]
    v_pk_fma_f32 v[70:71], v[142:143], v[190:191], v[70:71] op_sel:[0,1,0] op_sel_hi:[1,1,1]
    v_pk_mul_f32 v[172:173], v[20:21], v[20:21]
    v_pk_fma_f32 v[172:173], v[172:173], v[188:189], v[188:189] op_sel:[0,1,0] op_sel_hi:[1,1,0]
    v_pk_mul_f32 v[172:173], v[172:173], v[20:21]
    v_pk_mul_f32 v[176:177], v[22:23], v[22:23]
    v_pk_fma_f32 v[176:177], v[176:177], v[188:189], v[188:189] op_sel:[0,1,0] op_sel_hi:[1,1,0]
    v_pk_mul_f32 v[176:177], v[176:177], v[22:23]
    v_exp_f32 v172, v172
    v_exp_f32 v173, v173
    v_exp_f32 v176, v176
    v_exp_f32 v177, v177
    v_pk_mul_f32 v[174:175], v[20:21], v[68:69]
    v_pk_fma_f32 v[172:173], v[172:173], v[190:191], v[190:191] op_sel_hi:[1,0,0]
    v_pk_mul_f32 v[178:179], v[22:23], v[70:71]
    v_pk_fma_f32 v[176:177], v[176:177], v[190:191], v[190:191] op_sel_hi:[1,0,0]
    v_rcp_f32 v172, v172
    v_rcp_f32 v173, v173
    v_rcp_f32 v176, v176
    v_rcp_f32 v177, v177
    v_pk_mul_f32 v[172:173], v[172:173], v[174:175]
    v_pk_mul_f32 v[176:177], v[176:177], v[178:179]
    v_cvt_pk_bf16_f32 v212, v172, v173
    v_cvt_pk_bf16_f32 v213, v176, v177
    v_pk_fma_f32 v[36:37], v[132:133], v[190:191], v[36:37] op_sel:[0,1,0] op_sel_hi:[1,1,1]
    v_pk_fma_f32 v[38:39], v[134:135], v[190:191], v[38:39] op_sel:[0,1,0] op_sel_hi:[1,1,1]
    v_pk_fma_f32 v[84:85], v[144:145], v[190:191], v[84:85] op_sel:[0,1,0] op_sel_hi:[1,1,1]
    v_pk_fma_f32 v[86:87], v[146:147], v[190:191], v[86:87] op_sel:[0,1,0] op_sel_hi:[1,1,1]
    v_pk_mul_f32 v[156:157], v[36:37], v[36:37]
    v_pk_fma_f32 v[156:157], v[156:157], v[188:189], v[188:189] op_sel:[0,1,0] op_sel_hi:[1,1,0]
    v_pk_mul_f32 v[156:157], v[156:157], v[36:37]
    v_pk_mul_f32 v[160:161], v[38:39], v[38:39]
    v_pk_fma_f32 v[160:161], v[160:161], v[188:189], v[188:189] op_sel:[0,1,0] op_sel_hi:[1,1,0]
    v_pk_mul_f32 v[160:161], v[160:161], v[38:39]
    v_exp_f32 v156, v156
    v_exp_f32 v157, v157
    v_exp_f32 v160, v160
    v_exp_f32 v161, v161
    v_pk_mul_f32 v[158:159], v[36:37], v[84:85]
    v_pk_fma_f32 v[156:157], v[156:157], v[190:191], v[190:191] op_sel_hi:[1,0,0]
    v_pk_mul_f32 v[162:163], v[38:39], v[86:87]
    v_pk_fma_f32 v[160:161], v[160:161], v[190:191], v[190:191] op_sel_hi:[1,0,0]
    v_rcp_f32 v156, v156
    v_rcp_f32 v157, v157
    v_rcp_f32 v160, v160
    v_rcp_f32 v161, v161
    v_pk_mul_f32 v[156:157], v[156:157], v[158:159]
    v_pk_mul_f32 v[160:161], v[160:161], v[162:163]
    v_cvt_pk_bf16_f32 v214, v156, v157
    v_cvt_pk_bf16_f32 v215, v160, v161
    s_add_u32 s37, s36, 57344
    buffer_store_dwordx4 v[212:215], v1, s[4:7], s37 offen sc1
    v_pk_fma_f32 v[24:25], v[128:129], v[194:195], v[24:25] op_sel:[0,1,0] op_sel_hi:[1,1,1]
    v_pk_fma_f32 v[26:27], v[130:131], v[194:195], v[26:27] op_sel:[0,1,0] op_sel_hi:[1,1,1]
    v_pk_fma_f32 v[72:73], v[140:141], v[194:195], v[72:73] op_sel:[0,1,0] op_sel_hi:[1,1,1]
    v_pk_fma_f32 v[74:75], v[142:143], v[194:195], v[74:75] op_sel:[0,1,0] op_sel_hi:[1,1,1]
    v_pk_mul_f32 v[164:165], v[24:25], v[24:25]
    v_pk_fma_f32 v[164:165], v[164:165], v[192:193], v[192:193] op_sel:[0,1,0] op_sel_hi:[1,1,0]
    v_pk_mul_f32 v[164:165], v[164:165], v[24:25]
    v_pk_mul_f32 v[168:169], v[26:27], v[26:27]
    v_pk_fma_f32 v[168:169], v[168:169], v[192:193], v[192:193] op_sel:[0,1,0] op_sel_hi:[1,1,0]
    v_pk_mul_f32 v[168:169], v[168:169], v[26:27]
    v_exp_f32 v164, v164
    v_exp_f32 v165, v165
    v_exp_f32 v168, v168
    v_exp_f32 v169, v169
    v_pk_mul_f32 v[166:167], v[24:25], v[72:73]
    v_pk_fma_f32 v[164:165], v[164:165], v[194:195], v[194:195] op_sel_hi:[1,0,0]
    v_pk_mul_f32 v[170:171], v[26:27], v[74:75]
    v_pk_fma_f32 v[168:169], v[168:169], v[194:195], v[194:195] op_sel_hi:[1,0,0]
    v_rcp_f32 v164, v164
    v_rcp_f32 v165, v165
    v_rcp_f32 v168, v168
    v_rcp_f32 v169, v169
    v_pk_mul_f32 v[164:165], v[164:165], v[166:167]
    v_pk_mul_f32 v[168:169], v[168:169], v[170:171]
    v_cvt_pk_bf16_f32 v216, v164, v165
    v_cvt_pk_bf16_f32 v217, v168, v169
    v_pk_fma_f32 v[40:41], v[132:133], v[194:195], v[40:41] op_sel:[0,1,0] op_sel_hi:[1,1,1]
    v_pk_fma_f32 v[42:43], v[134:135], v[194:195], v[42:43] op_sel:[0,1,0] op_sel_hi:[1,1,1]
    v_pk_fma_f32 v[88:89], v[144:145], v[194:195], v[88:89] op_sel:[0,1,0] op_sel_hi:[1,1,1]
    v_pk_fma_f32 v[90:91], v[146:147], v[194:195], v[90:91] op_sel:[0,1,0] op_sel_hi:[1,1,1]
    v_pk_mul_f32 v[172:173], v[40:41], v[40:41]
    v_pk_fma_f32 v[172:173], v[172:173], v[192:193], v[192:193] op_sel:[0,1,0] op_sel_hi:[1,1,0]
    v_pk_mul_f32 v[172:173], v[172:173], v[40:41]
    v_pk_mul_f32 v[176:177], v[42:43], v[42:43]
    v_pk_fma_f32 v[176:177], v[176:177], v[192:193], v[192:193] op_sel:[0,1,0] op_sel_hi:[1,1,0]
    v_pk_mul_f32 v[176:177], v[176:177], v[42:43]
    v_exp_f32 v172, v172
    v_exp_f32 v173, v173
    v_exp_f32 v176, v176
    v_exp_f32 v177, v177
    v_pk_mul_f32 v[174:175], v[40:41], v[88:89]
    v_pk_fma_f32 v[172:173], v[172:173], v[194:195], v[194:195] op_sel_hi:[1,0,0]
    v_pk_mul_f32 v[178:179], v[42:43], v[90:91]
    v_pk_fma_f32 v[176:177], v[176:177], v[194:195], v[194:195] op_sel_hi:[1,0,0]
    v_rcp_f32 v172, v172
    v_rcp_f32 v173, v173
    v_rcp_f32 v176, v176
    v_rcp_f32 v177, v177
    v_pk_mul_f32 v[172:173], v[172:173], v[174:175]
    v_pk_mul_f32 v[176:177], v[176:177], v[178:179]
    v_cvt_pk_bf16_f32 v218, v172, v173
    v_cvt_pk_bf16_f32 v219, v176, v177
    s_add_u32 s37, s36, 114688
    buffer_store_dwordx4 v[216:219], v1, s[4:7], s37 offen sc1
    v_pk_fma_f32 v[28:29], v[128:129], v[198:199], v[28:29] op_sel:[0,1,0] op_sel_hi:[1,1,1]
    v_pk_fma_f32 v[30:31], v[130:131], v[198:199], v[30:31] op_sel:[0,1,0] op_sel_hi:[1,1,1]
    v_pk_fma_f32 v[76:77], v[140:141], v[198:199], v[76:77] op_sel:[0,1,0] op_sel_hi:[1,1,1]
    v_pk_fma_f32 v[78:79], v[142:143], v[198:199], v[78:79] op_sel:[0,1,0] op_sel_hi:[1,1,1]
    v_pk_mul_f32 v[156:157], v[28:29], v[28:29]
    v_pk_fma_f32 v[156:157], v[156:157], v[196:197], v[196:197] op_sel:[0,1,0] op_sel_hi:[1,1,0]
    v_pk_mul_f32 v[156:157], v[156:157], v[28:29]
    v_pk_mul_f32 v[160:161], v[30:31], v[30:31]
    v_pk_fma_f32 v[160:161], v[160:161], v[196:197], v[196:197] op_sel:[0,1,0] op_sel_hi:[1,1,0]
    v_pk_mul_f32 v[160:161], v[160:161], v[30:31]
    v_exp_f32 v156, v156
    v_exp_f32 v157, v157
    v_exp_f32 v160, v160
    v_exp_f32 v161, v161
    v_pk_mul_f32 v[158:159], v[28:29], v[76:77]
    v_pk_fma_f32 v[156:157], v[156:157], v[198:199], v[198:199] op_sel_hi:[1,0,0]
    v_pk_mul_f32 v[162:163], v[30:31], v[78:79]
    v_pk_fma_f32 v[160:161], v[160:161], v[198:199], v[198:199] op_sel_hi:[1,0,0]
    v_rcp_f32 v156, v156
    v_rcp_f32 v157, v157
    v_rcp_f32 v160, v160
    v_rcp_f32 v161, v161
    v_pk_mul_f32 v[156:157], v[156:157], v[158:159]
    v_pk_mul_f32 v[160:161], v[160:161], v[162:163]
    v_cvt_pk_bf16_f32 v220, v156, v157
    v_cvt_pk_bf16_f32 v221, v160, v161
    v_pk_fma_f32 v[44:45], v[132:133], v[198:199], v[44:45] op_sel:[0,1,0] op_sel_hi:[1,1,1]
    v_pk_fma_f32 v[46:47], v[134:135], v[198:199], v[46:47] op_sel:[0,1,0] op_sel_hi:[1,1,1]
    v_pk_fma_f32 v[92:93], v[144:145], v[198:199], v[92:93] op_sel:[0,1,0] op_sel_hi:[1,1,1]
    v_pk_fma_f32 v[94:95], v[146:147], v[198:199], v[94:95] op_sel:[0,1,0] op_sel_hi:[1,1,1]
    v_pk_mul_f32 v[164:165], v[44:45], v[44:45]
    v_pk_fma_f32 v[164:165], v[164:165], v[196:197], v[196:197] op_sel:[0,1,0] op_sel_hi:[1,1,0]
    v_pk_mul_f32 v[164:165], v[164:165], v[44:45]
    v_pk_mul_f32 v[168:169], v[46:47], v[46:47]
    v_pk_fma_f32 v[168:169], v[168:169], v[196:197], v[196:197] op_sel:[0,1,0] op_sel_hi:[1,1,0]
    v_pk_mul_f32 v[168:169], v[168:169], v[46:47]
    v_exp_f32 v164, v164
    v_exp_f32 v165, v165
    v_exp_f32 v168, v168
    v_exp_f32 v169, v169
    v_pk_mul_f32 v[166:167], v[44:45], v[92:93]
    v_pk_fma_f32 v[164:165], v[164:165], v[198:199], v[198:199] op_sel_hi:[1,0,0]
    v_pk_mul_f32 v[170:171], v[46:47], v[94:95]
    v_pk_fma_f32 v[168:169], v[168:169], v[198:199], v[198:199] op_sel_hi:[1,0,0]
    v_rcp_f32 v164, v164
    v_rcp_f32 v165, v165
    v_rcp_f32 v168, v168
    v_rcp_f32 v169, v169
    v_pk_mul_f32 v[164:165], v[164:165], v[166:167]
    v_pk_mul_f32 v[168:169], v[168:169], v[170:171]
    v_cvt_pk_bf16_f32 v222, v164, v165
    v_cvt_pk_bf16_f32 v223, v168, v169
    s_add_u32 s37, s36, 172032
    buffer_store_dwordx4 v[220:223], v1, s[4:7], s37 offen sc1
    v_pk_fma_f32 v[48:49], v[136:137], v[186:187], v[48:49] op_sel:[0,1,0] op_sel_hi:[1,1,1]
    v_pk_fma_f32 v[50:51], v[138:139], v[186:187], v[50:51] op_sel:[0,1,0] op_sel_hi:[1,1,1]
    v_pk_fma_f32 v[96:97], v[148:149], v[186:187], v[96:97] op_sel:[0,1,0] op_sel_hi:[1,1,1]
    v_pk_fma_f32 v[98:99], v[150:151], v[186:187], v[98:99] op_sel:[0,1,0] op_sel_hi:[1,1,1]
    v_pk_mul_f32 v[172:173], v[48:49], v[48:49]
    v_pk_fma_f32 v[172:173], v[172:173], v[184:185], v[184:185] op_sel:[0,1,0] op_sel_hi:[1,1,0]
    v_pk_mul_f32 v[172:173], v[172:173], v[48:49]
    v_pk_mul_f32 v[176:177], v[50:51], v[50:51]
    v_pk_fma_f32 v[176:177], v[176:177], v[184:185], v[184:185] op_sel:[0,1,0] op_sel_hi:[1,1,0]
    v_pk_mul_f32 v[176:177], v[176:177], v[50:51]
    v_exp_f32 v172, v172
    v_exp_f32 v173, v173
    v_exp_f32 v176, v176
    v_exp_f32 v177, v177
    v_pk_mul_f32 v[174:175], v[48:49], v[96:97]
    v_pk_fma_f32 v[172:173], v[172:173], v[186:187], v[186:187] op_sel_hi:[1,0,0]
    v_pk_mul_f32 v[178:179], v[50:51], v[98:99]
    v_pk_fma_f32 v[176:177], v[176:177], v[186:187], v[186:187] op_sel_hi:[1,0,0]
    v_rcp_f32 v172, v172
    v_rcp_f32 v173, v173
    v_rcp_f32 v176, v176
    v_rcp_f32 v177, v177
    v_pk_mul_f32 v[172:173], v[172:173], v[174:175]
    v_pk_mul_f32 v[176:177], v[176:177], v[178:179]
    v_cvt_pk_bf16_f32 v224, v172, v173
    v_cvt_pk_bf16_f32 v225, v176, v177
    v_pk_fma_f32 v[52:53], v[136:137], v[190:191], v[52:53] op_sel:[0,1,0] op_sel_hi:[1,1,1]
    v_pk_fma_f32 v[54:55], v[138:139], v[190:191], v[54:55] op_sel:[0,1,0] op_sel_hi:[1,1,1]
    v_pk_fma_f32 v[100:101], v[148:149], v[190:191], v[100:101] op_sel:[0,1,0] op_sel_hi:[1,1,1]
    v_pk_fma_f32 v[102:103], v[150:151], v[190:191], v[102:103] op_sel:[0,1,0] op_sel_hi:[1,1,1]
    v_pk_mul_f32 v[156:157], v[52:53], v[52:53]
    v_pk_fma_f32 v[156:157], v[156:157], v[188:189], v[188:189] op_sel:[0,1,0] op_sel_hi:[1,1,0]
    v_pk_mul_f32 v[156:157], v[156:157], v[52:53]
    v_pk_mul_f32 v[160:161], v[54:55], v[54:55]
    v_pk_fma_f32 v[160:161], v[160:161], v[188:189], v[188:189] op_sel:[0,1,0] op_sel_hi:[1,1,0]
    v_pk_mul_f32 v[160:161], v[160:161], v[54:55]
    v_exp_f32 v156, v156
    v_exp_f32 v157, v157
    v_exp_f32 v160, v160
    v_exp_f32 v161, v161
    v_pk_mul_f32 v[158:159], v[52:53], v[100:101]
    v_pk_fma_f32 v[156:157], v[156:157], v[190:191], v[190:191] op_sel_hi:[1,0,0]
    v_pk_mul_f32 v[162:163], v[54:55], v[102:103]
    v_pk_fma_f32 v[160:161], v[160:161], v[190:191], v[190:191] op_sel_hi:[1,0,0]
    v_rcp_f32 v156, v156
    v_rcp_f32 v157, v157
    v_rcp_f32 v160, v160
    v_rcp_f32 v161, v161
    v_pk_mul_f32 v[156:157], v[156:157], v[158:159]
    v_pk_mul_f32 v[160:161], v[160:161], v[162:163]
    v_cvt_pk_bf16_f32 v226, v156, v157
    v_cvt_pk_bf16_f32 v227, v160, v161
    s_nop 0
    v_permlane32_swap_b32 v224, v226
    v_permlane32_swap_b32 v225, v227
    s_add_u32 s37, s36, 0
    buffer_store_dwordx4 v[224:227], v8, s[4:7], s37 offen offset:1024 sc1
    v_pk_fma_f32 v[56:57], v[136:137], v[194:195], v[56:57] op_sel:[0,1,0] op_sel_hi:[1,1,1]
    v_pk_fma_f32 v[58:59], v[138:139], v[194:195], v[58:59] op_sel:[0,1,0] op_sel_hi:[1,1,1]
    v_pk_fma_f32 v[104:105], v[148:149], v[194:195], v[104:105] op_sel:[0,1,0] op_sel_hi:[1,1,1]
    v_pk_fma_f32 v[106:107], v[150:151], v[194:195], v[106:107] op_sel:[0,1,0] op_sel_hi:[1,1,1]
    v_pk_mul_f32 v[164:165], v[56:57], v[56:57]
    v_pk_fma_f32 v[164:165], v[164:165], v[192:193], v[192:193] op_sel:[0,1,0] op_sel_hi:[1,1,0]
    v_pk_mul_f32 v[164:165], v[164:165], v[56:57]
    v_pk_mul_f32 v[168:169], v[58:59], v[58:59]
    v_pk_fma_f32 v[168:169], v[168:169], v[192:193], v[192:193] op_sel:[0,1,0] op_sel_hi:[1,1,0]
    v_pk_mul_f32 v[168:169], v[168:169], v[58:59]
    v_exp_f32 v164, v164
    v_exp_f32 v165, v165
    v_exp_f32 v168, v168
    v_exp_f32 v169, v169
    v_pk_mul_f32 v[166:167], v[56:57], v[104:105]
    v_pk_fma_f32 v[164:165], v[164:165], v[194:195], v[194:195] op_sel_hi:[1,0,0]
    v_pk_mul_f32 v[170:171], v[58:59], v[106:107]
    v_pk_fma_f32 v[168:169], v[168:169], v[194:195], v[194:195] op_sel_hi:[1,0,0]
    v_rcp_f32 v164, v164
    v_rcp_f32 v165, v165
    v_rcp_f32 v168, v168
    v_rcp_f32 v169, v169
    v_pk_mul_f32 v[164:165], v[164:165], v[166:167]
    v_pk_mul_f32 v[168:169], v[168:169], v[170:171]
    v_cvt_pk_bf16_f32 v228, v164, v165
    v_cvt_pk_bf16_f32 v229, v168, v169
    v_pk_fma_f32 v[60:61], v[136:137], v[198:199], v[60:61] op_sel:[0,1,0] op_sel_hi:[1,1,1]
    v_pk_fma_f32 v[62:63], v[138:139], v[198:199], v[62:63] op_sel:[0,1,0] op_sel_hi:[1,1,1]
    v_pk_fma_f32 v[108:109], v[148:149], v[198:199], v[108:109] op_sel:[0,1,0] op_sel_hi:[1,1,1]
    v_pk_fma_f32 v[110:111], v[150:151], v[198:199], v[110:111] op_sel:[0,1,0] op_sel_hi:[1,1,1]
    v_pk_mul_f32 v[172:173], v[60:61], v[60:61]
    v_pk_fma_f32 v[172:173], v[172:173], v[196:197], v[196:197] op_sel:[0,1,0] op_sel_hi:[1,1,0]
    v_pk_mul_f32 v[172:173], v[172:173], v[60:61]
    v_pk_mul_f32 v[176:177], v[62:63], v[62:63]
    v_pk_fma_f32 v[176:177], v[176:177], v[196:197], v[196:197] op_sel:[0,1,0] op_sel_hi:[1,1,0]
    v_pk_mul_f32 v[176:177], v[176:177], v[62:63]
    v_exp_f32 v172, v172
    v_exp_f32 v173, v173
    v_exp_f32 v176, v176
    v_exp_f32 v177, v177
    v_pk_mul_f32 v[174:175], v[60:61], v[108:109]
    v_pk_fma_f32 v[172:173], v[172:173], v[198:199], v[198:199] op_sel_hi:[1,0,0]
    v_pk_mul_f32 v[178:179], v[62:63], v[110:111]
    v_pk_fma_f32 v[176:177], v[176:177], v[198:199], v[198:199] op_sel_hi:[1,0,0]
    v_rcp_f32 v172, v172
    v_rcp_f32 v173, v173
    v_rcp_f32 v176, v176
    v_rcp_f32 v177, v177
    v_pk_mul_f32 v[172:173], v[172:173], v[174:175]
    v_pk_mul_f32 v[176:177], v[176:177], v[178:179]
    v_cvt_pk_bf16_f32 v230, v172, v173
    v_cvt_pk_bf16_f32 v231, v176, v177
    s_nop 0
    v_permlane32_swap_b32 v228, v230
    v_permlane32_swap_b32 v229, v231
    s_add_u32 s37, s36, 114688
    buffer_store_dwordx4 v[228:231], v8, s[4:7], s37 offen offset:1024 sc1
    v_pk_fma_f32 v[112:113], v[152:153], v[186:187], v[112:113] op_sel:[0,1,0] op_sel_hi:[1,1,1]
    v_pk_fma_f32 v[114:115], v[154:155], v[186:187], v[114:115] op_sel:[0,1,0] op_sel_hi:[1,1,1]
    v_pk_fma_f32 v[116:117], v[152:153], v[190:191], v[116:117] op_sel:[0,1,0] op_sel_hi:[1,1,1]
    v_pk_fma_f32 v[118:119], v[154:155], v[190:191], v[118:119] op_sel:[0,1,0] op_sel_hi:[1,1,1]
    v_pk_fma_f32 v[120:121], v[152:153], v[194:195], v[120:121] op_sel:[0,1,0] op_sel_hi:[1,1,1]
    v_pk_fma_f32 v[122:123], v[154:155], v[194:195], v[122:123] op_sel:[0,1,0] op_sel_hi:[1,1,1]
    v_pk_fma_f32 v[124:125], v[152:153], v[198:199], v[124:125] op_sel:[0,1,0] op_sel_hi:[1,1,1]
    v_pk_fma_f32 v[126:127], v[154:155], v[198:199], v[126:127] op_sel:[0,1,0] op_sel_hi:[1,1,1]
    v_permlane32_swap_b32 v112, v116
    v_permlane32_swap_b32 v113, v117
    v_permlane32_swap_b32 v114, v118
    v_permlane32_swap_b32 v115, v119
    v_cndmask_b32 v184, v184, v188, s[56:57]
    v_cndmask_b32 v185, v185, v189, s[56:57]
    v_cndmask_b32 v186, v186, v190, s[56:57]
    v_pk_mul_f32 v[156:157], v[112:113], v[112:113]
    v_pk_fma_f32 v[156:157], v[156:157], v[184:185], v[184:185] op_sel:[0,1,0] op_sel_hi:[1,1,0]
    v_pk_mul_f32 v[156:157], v[156:157], v[112:113]
    v_pk_mul_f32 v[160:161], v[114:115], v[114:115]
    v_pk_fma_f32 v[160:161], v[160:161], v[184:185], v[184:185] op_sel:[0,1,0] op_sel_hi:[1,1,0]
    v_pk_mul_f32 v[160:161], v[160:161], v[114:115]
    v_exp_f32 v156, v156
    v_exp_f32 v157, v157
    v_exp_f32 v160, v160
    v_exp_f32 v161, v161
    v_pk_mul_f32 v[158:159], v[112:113], v[116:117]
    v_pk_fma_f32 v[156:157], v[156:157], v[186:187], v[186:187] op_sel_hi:[1,0,0]
    v_pk_mul_f32 v[162:163], v[114:115], v[118:119]
    v_pk_fma_f32 v[160:161], v[160:161], v[186:187], v[186:187] op_sel_hi:[1,0,0]
    v_rcp_f32 v156, v156
    v_rcp_f32 v157, v157
    v_rcp_f32 v160, v160
    v_rcp_f32 v161, v161
    v_pk_mul_f32 v[156:157], v[156:157], v[158:159]
    v_pk_mul_f32 v[160:161], v[160:161], v[162:163]
    v_cvt_pk_bf16_f32 v232, v156, v157
    v_cvt_pk_bf16_f32 v233, v160, v161
    v_permlane32_swap_b32 v120, v124
    v_permlane32_swap_b32 v121, v125
    v_permlane32_swap_b32 v122, v126
    v_permlane32_swap_b32 v123, v127
    v_cndmask_b32 v192, v192, v196, s[56:57]
    v_cndmask_b32 v193, v193, v197, s[56:57]
    v_cndmask_b32 v194, v194, v198, s[56:57]
    v_pk_mul_f32 v[164:165], v[120:121], v[120:121]
    v_pk_fma_f32 v[164:165], v[164:165], v[192:193], v[192:193] op_sel:[0,1,0] op_sel_hi:[1,1,0]
    v_pk_mul_f32 v[164:165], v[164:165], v[120:121]
    v_pk_mul_f32 v[168:169], v[122:123], v[122:123]
    v_pk_fma_f32 v[168:169], v[168:169], v[192:193], v[192:193] op_sel:[0,1,0] op_sel_hi:[1,1,0]
    v_pk_mul_f32 v[168:169], v[168:169], v[122:123]
    v_exp_f32 v164, v164
    v_exp_f32 v165, v165
    v_exp_f32 v168, v168
    v_exp_f32 v169, v169
    v_pk_mul_f32 v[166:167], v[120:121], v[124:125]
    v_pk_fma_f32 v[164:165], v[164:165], v[194:195], v[194:195] op_sel_hi:[1,0,0]
    v_pk_mul_f32 v[170:171], v[122:123], v[126:127]
    v_pk_fma_f32 v[168:169], v[168:169], v[194:195], v[194:195] op_sel_hi:[1,0,0]
    v_rcp_f32 v164, v164
    v_rcp_f32 v165, v165
    v_rcp_f32 v168, v168
    v_rcp_f32 v169, v169
    v_pk_mul_f32 v[164:165], v[164:165], v[166:167]
    v_pk_mul_f32 v[168:169], v[168:169], v[170:171]
    v_cvt_pk_bf16_f32 v234, v164, v165
    v_cvt_pk_bf16_f32 v235, v168, v169
    s_nop 0
    v_permlane16_swap_b32 v232, v234
    v_permlane16_swap_b32 v233, v235
    buffer_store_dwordx4 v[232:235], v9, s[4:7], s36 offen offset:1536 sc1
    s_and_b32 s30, s26, 1
    s_lshr_b32 s31, s26, 1
    s_lshl_b32 s29, s92, 2
    s_lshl_b32 s32, s30, 1
    s_add_u32 s29, s29, s32
    s_add_u32 s33, s29, s31
    s_xor_b32 s32, s31, 1
    s_add_u32 s34, s29, s32
    s_mov_b32 s29, s33
    v_bfe_u32 v12, v4, 2, 2
    v_lshl_add_u32 v13, v5, 3, v12
    v_lshlrev_b32 v13, 7, v13
    v_and_b32 v14, 3, v4
    v_lshl_add_u32 v13, v14, 3, v13
    s_lshl_b32 s36, s31, 12
    v_add_u32 v13, s36, v13
    v_lshrrev_b32 v12, 1, v12
    v_and_b32 v14, 1, v5
    v_lshl_add_u32 v12, v14, 1, v12
    v_xor_b32 v14, 0, v12
    v_lshl_add_u32 v236, v14, 5, v13
    v_add_u32 v240, 65536, v236
    v_add_u32 v244, 131072, v236
    v_xor_b32 v14, 1, v12
    v_lshl_add_u32 v237, v14, 5, v13
    v_add_u32 v241, 65536, v237
    v_add_u32 v245, 131072, v237
    v_xor_b32 v14, 2, v12
    v_lshl_add_u32 v238, v14, 5, v13
    v_add_u32 v242, 65536, v238
    v_add_u32 v246, 131072, v238
    v_xor_b32 v14, 3, v12
    v_lshl_add_u32 v239, v14, 5, v13
    v_add_u32 v243, 65536, v239
    v_add_u32 v247, 131072, v239
    s_waitcnt vmcnt(0)
    s_barrier
    ds_read_b64_tr_b16 v[48:49], v236 offset:0
    ds_read_b64_tr_b16 v[50:51], v236 offset:512
    ds_read_b64_tr_b16 v[52:53], v237 offset:0
    ds_read_b64_tr_b16 v[54:55], v237 offset:512
    ds_read_b64_tr_b16 v[56:57], v238 offset:0
    ds_read_b64_tr_b16 v[58:59], v238 offset:512
    ds_read_b64_tr_b16 v[60:61], v239 offset:0
    ds_read_b64_tr_b16 v[62:63], v239 offset:512
    ds_read_b64_tr_b16 v[64:65], v236 offset:8192
    ds_read_b64_tr_b16 v[66:67], v236 offset:8704
    ds_read_b64_tr_b16 v[68:69], v237 offset:8192
    ds_read_b64_tr_b16 v[70:71], v237 offset:8704
    ds_read_b64_tr_b16 v[72:73], v238 offset:8192
    ds_read_b64_tr_b16 v[74:75], v238 offset:8704
    ds_read_b64_tr_b16 v[76:77], v239 offset:8192
    ds_read_b64_tr_b16 v[78:79], v239 offset:8704
    ds_read_b64_tr_b16 v[80:81], v236 offset:16384
    ds_read_b64_tr_b16 v[82:83], v236 offset:16896
    ds_read_b64_tr_b16 v[84:85], v237 offset:16384
    ds_read_b64_tr_b16 v[86:87], v237 offset:16896
    ds_read_b64_tr_b16 v[88:89], v238 offset:16384
    ds_read_b64_tr_b16 v[90:91], v238 offset:16896
    ds_read_b64_tr_b16 v[92:93], v239 offset:16384
    ds_read_b64_tr_b16 v[94:95], v239 offset:16896
    ds_read_b64_tr_b16 v[96:97], v236 offset:24576
    ds_read_b64_tr_b16 v[98:99], v236 offset:25088
    ds_read_b64_tr_b16 v[100:101], v237 offset:24576
    ds_read_b64_tr_b16 v[102:103], v237 offset:25088
    ds_read_b64_tr_b16 v[104:105], v238 offset:24576
    ds_read_b64_tr_b16 v[106:107], v238 offset:25088
    ds_read_b64_tr_b16 v[108:109], v239 offset:24576
    ds_read_b64_tr_b16 v[110:111], v239 offset:25088
    ds_read_b64_tr_b16 v[112:113], v236 offset:32768
    ds_read_b64_tr_b16 v[114:115], v236 offset:33280
    ds_read_b64_tr_b16 v[116:117], v237 offset:32768
    ds_read_b64_tr_b16 v[118:119], v237 offset:33280
    ds_read_b64_tr_b16 v[120:121], v238 offset:32768
    ds_read_b64_tr_b16 v[122:123], v238 offset:33280
    ds_read_b64_tr_b16 v[124:125], v239 offset:32768
    ds_read_b64_tr_b16 v[126:127], v239 offset:33280
    ds_read_b64_tr_b16 v[128:129], v236 offset:40960
    ds_read_b64_tr_b16 v[130:131], v236 offset:41472
    ds_read_b64_tr_b16 v[132:133], v237 offset:40960
    ds_read_b64_tr_b16 v[134:135], v237 offset:41472
    ds_read_b64_tr_b16 v[136:137], v238 offset:40960
    ds_read_b64_tr_b16 v[138:139], v238 offset:41472
    ds_read_b64_tr_b16 v[140:141], v239 offset:40960
    ds_read_b64_tr_b16 v[142:143], v239 offset:41472
    ds_read_b64_tr_b16 v[144:145], v236 offset:49152
    ds_read_b64_tr_b16 v[146:147], v236 offset:49664
    ds_read_b64_tr_b16 v[148:149], v237 offset:49152
    ds_read_b64_tr_b16 v[150:151], v237 offset:49664
    ds_read_b64_tr_b16 v[152:153], v238 offset:49152
    ds_read_b64_tr_b16 v[154:155], v238 offset:49664
    ds_read_b64_tr_b16 v[156:157], v239 offset:49152
    ds_read_b64_tr_b16 v[158:159], v239 offset:49664
    ds_read_b64_tr_b16 v[160:161], v236 offset:57344
    ds_read_b64_tr_b16 v[162:163], v236 offset:57856
    ds_read_b64_tr_b16 v[164:165], v237 offset:57344
    ds_read_b64_tr_b16 v[166:167], v237 offset:57856
    ds_read_b64_tr_b16 v[168:169], v238 offset:57344
    ds_read_b64_tr_b16 v[170:171], v238 offset:57856
    ds_read_b64_tr_b16 v[172:173], v239 offset:57344
    ds_read_b64_tr_b16 v[174:175], v239 offset:57856
    v_mov_b32 v16, 0
    v_mov_b32 v17, 0
    v_mov_b32 v18, 0
    v_mov_b32 v19, 0
    v_mov_b32 v20, 0
    v_mov_b32 v21, 0
    v_mov_b32 v22, 0
    v_mov_b32 v23, 0
    v_mov_b32 v24, 0
    v_mov_b32 v25, 0
    v_mov_b32 v26, 0
    v_mov_b32 v27, 0
    v_mov_b32 v28, 0
    v_mov_b32 v29, 0
    v_mov_b32 v30, 0
    v_mov_b32 v31, 0
    v_mov_b32 v32, 0
    v_mov_b32 v33, 0
    v_mov_b32 v34, 0
    v_mov_b32 v35, 0
    v_mov_b32 v36, 0
    v_mov_b32 v37, 0
    v_mov_b32 v38, 0
    v_mov_b32 v39, 0
    v_mov_b32 v40, 0
    v_mov_b32 v41, 0
    v_mov_b32 v42, 0
    v_mov_b32 v43, 0
    v_mov_b32 v44, 0
    v_mov_b32 v45, 0
    v_mov_b32 v46, 0
    v_mov_b32 v47, 0
    s_mov_b32 s20, s78
    s_and_b32 s21, s79, 0xffff
    s_mov_b32 s22, 2097152
    s_mov_b32 s23, 0x00020000
    v_lshlrev_b32 v7, 10, v6
    v_lshl_add_u32 v7, v5, 3, v7
    s_lshl_b32 s32, s29, 14
    s_lshl_b32 s35, s93, 7
    s_add_u32 s32, s32, s35
    s_lshl_b32 s35, s29, 14
    s_lshl_b32 s36, s93, 11
    s_add_u32 s35, s35, s36
    s_add_u32 s35, s35, 2097152
    s_lshl_b32 s37, s31, 10
    s_add_u32 s37, s37, 4194304
    s_mul_i32 s33, s33, 57344
    s_mul_i32 s34, s34, 57344
    s_add_u32 s33, s33, s37
    s_add_u32 s34, s34, s37
    s_waitcnt lgkmcnt(0)
    s_barrier
    buffer_load_dwordx4 v[248:251], v1, s[4:7], s35 offen offset:0 sc1
    buffer_load_dwordx4 v[252:255], v1, s[4:7], s35 offen offset:1024 sc1
    s_barrier
    buffer_load_dwordx4 v[176:179], v1, s[4:7], s33 offen offset:0 sc1
    buffer_load_dwordx4 v[180:183], v1, s[4:7], s34 offen offset:0 sc1
    buffer_load_dwordx4 v[184:187], v1, s[4:7], s33 offen offset:2048 sc1
    buffer_load_dwordx4 v[188:191], v1, s[4:7], s34 offen offset:2048 sc1
    s_add_u32 s33, s33, 4096
    buffer_load_dwordx4 v[192:195], v1, s[4:7], s33 offen offset:0 sc1
    s_add_u32 s34, s34, 4096
    buffer_load_dwordx4 v[196:199], v1, s[4:7], s34 offen offset:0 sc1
    buffer_load_dwordx4 v[200:203], v1, s[4:7], s33 offen offset:2048 sc1
    buffer_load_dwordx4 v[204:207], v1, s[4:7], s34 offen offset:2048 sc1
    s_add_u32 s33, s33, 4096
    buffer_load_dwordx4 v[208:211], v1, s[4:7], s33 offen offset:0 sc1
    s_add_u32 s34, s34, 4096
    buffer_load_dwordx4 v[212:215], v1, s[4:7], s34 offen offset:0 sc1
    buffer_load_dwordx4 v[216:219], v1, s[4:7], s33 offen offset:2048 sc1
    buffer_load_dwordx4 v[220:223], v1, s[4:7], s34 offen offset:2048 sc1
    s_add_u32 s33, s33, 4096
    buffer_load_dwordx4 v[224:227], v1, s[4:7], s33 offen offset:0 sc1
    s_add_u32 s34, s34, 4096
    buffer_load_dwordx4 v[228:231], v1, s[4:7], s34 offen offset:0 sc1
    s_waitcnt vmcnt(12)
    v_mfma_f32_16x16x32_bf16 v[16:19], v[48:51], v[176:179], v[16:19]
    v_mfma_f32_16x16x32_bf16 v[32:35], v[48:51], v[180:183], v[32:35]
    ds_read_b64_tr_b16 v[48:49], v240 offset:0
    ds_read_b64_tr_b16 v[50:51], v240 offset:512
    v_mfma_f32_16x16x32_bf16 v[20:23], v[52:55], v[176:179], v[20:23]
    v_mfma_f32_16x16x32_bf16 v[36:39], v[52:55], v[180:183], v[36:39]
    ds_read_b64_tr_b16 v[52:53], v241 offset:0
    ds_read_b64_tr_b16 v[54:55], v241 offset:512
    v_mfma_f32_16x16x32_bf16 v[24:27], v[56:59], v[176:179], v[24:27]
    v_mfma_f32_16x16x32_bf16 v[40:43], v[56:59], v[180:183], v[40:43]
    ds_read_b64_tr_b16 v[56:57], v242 offset:0
    ds_read_b64_tr_b16 v[58:59], v242 offset:512
    v_mfma_f32_16x16x32_bf16 v[28:31], v[60:63], v[176:179], v[28:31]
    v_mfma_f32_16x16x32_bf16 v[44:47], v[60:63], v[180:183], v[44:47]
    ds_read_b64_tr_b16 v[60:61], v243 offset:0
    ds_read_b64_tr_b16 v[62:63], v243 offset:512
    buffer_load_dwordx4 v[176:179], v1, s[4:7], s33 offen offset:2048 sc1
    buffer_load_dwordx4 v[180:183], v1, s[4:7], s34 offen offset:2048 sc1
    s_waitcnt vmcnt(12)
    v_mfma_f32_16x16x32_bf16 v[16:19], v[64:67], v[184:187], v[16:19]
    v_mfma_f32_16x16x32_bf16 v[32:35], v[64:67], v[188:191], v[32:35]
    ds_read_b64_tr_b16 v[64:65], v240 offset:8192
    ds_read_b64_tr_b16 v[66:67], v240 offset:8704
    v_mfma_f32_16x16x32_bf16 v[20:23], v[68:71], v[184:187], v[20:23]
    v_mfma_f32_16x16x32_bf16 v[36:39], v[68:71], v[188:191], v[36:39]
    ds_read_b64_tr_b16 v[68:69], v241 offset:8192
    ds_read_b64_tr_b16 v[70:71], v241 offset:8704
    v_mfma_f32_16x16x32_bf16 v[24:27], v[72:75], v[184:187], v[24:27]
    v_mfma_f32_16x16x32_bf16 v[40:43], v[72:75], v[188:191], v[40:43]
    ds_read_b64_tr_b16 v[72:73], v242 offset:8192
    ds_read_b64_tr_b16 v[74:75], v242 offset:8704
    v_mfma_f32_16x16x32_bf16 v[28:31], v[76:79], v[184:187], v[28:31]
    v_mfma_f32_16x16x32_bf16 v[44:47], v[76:79], v[188:191], v[44:47]
    ds_read_b64_tr_b16 v[76:77], v243 offset:8192
    ds_read_b64_tr_b16 v[78:79], v243 offset:8704
    s_add_u32 s33, s33, 4096
    buffer_load_dwordx4 v[184:187], v1, s[4:7], s33 offen offset:0 sc1
    s_add_u32 s34, s34, 4096
    buffer_load_dwordx4 v[188:191], v1, s[4:7], s34 offen offset:0 sc1
    s_waitcnt vmcnt(12)
    v_mfma_f32_16x16x32_bf16 v[16:19], v[80:83], v[192:195], v[16:19]
    v_mfma_f32_16x16x32_bf16 v[32:35], v[80:83], v[196:199], v[32:35]
    ds_read_b64_tr_b16 v[80:81], v240 offset:16384
    ds_read_b64_tr_b16 v[82:83], v240 offset:16896
    v_mfma_f32_16x16x32_bf16 v[20:23], v[84:87], v[192:195], v[20:23]
    v_mfma_f32_16x16x32_bf16 v[36:39], v[84:87], v[196:199], v[36:39]
    ds_read_b64_tr_b16 v[84:85], v241 offset:16384
    ds_read_b64_tr_b16 v[86:87], v241 offset:16896
    v_mfma_f32_16x16x32_bf16 v[24:27], v[88:91], v[192:195], v[24:27]
    v_mfma_f32_16x16x32_bf16 v[40:43], v[88:91], v[196:199], v[40:43]
    ds_read_b64_tr_b16 v[88:89], v242 offset:16384
    ds_read_b64_tr_b16 v[90:91], v242 offset:16896
    v_mfma_f32_16x16x32_bf16 v[28:31], v[92:95], v[192:195], v[28:31]
    v_mfma_f32_16x16x32_bf16 v[44:47], v[92:95], v[196:199], v[44:47]
    ds_read_b64_tr_b16 v[92:93], v243 offset:16384
    ds_read_b64_tr_b16 v[94:95], v243 offset:16896
    buffer_load_dwordx4 v[192:195], v1, s[4:7], s33 offen offset:2048 sc1
    buffer_load_dwordx4 v[196:199], v1, s[4:7], s34 offen offset:2048 sc1
    s_waitcnt vmcnt(12)
    v_mfma_f32_16x16x32_bf16 v[16:19], v[96:99], v[200:203], v[16:19]
    v_mfma_f32_16x16x32_bf16 v[32:35], v[96:99], v[204:207], v[32:35]
    ds_read_b64_tr_b16 v[96:97], v240 offset:24576
    ds_read_b64_tr_b16 v[98:99], v240 offset:25088
    v_mfma_f32_16x16x32_bf16 v[20:23], v[100:103], v[200:203], v[20:23]
    v_mfma_f32_16x16x32_bf16 v[36:39], v[100:103], v[204:207], v[36:39]
    ds_read_b64_tr_b16 v[100:101], v241 offset:24576
    ds_read_b64_tr_b16 v[102:103], v241 offset:25088
    v_mfma_f32_16x16x32_bf16 v[24:27], v[104:107], v[200:203], v[24:27]
    v_mfma_f32_16x16x32_bf16 v[40:43], v[104:107], v[204:207], v[40:43]
    ds_read_b64_tr_b16 v[104:105], v242 offset:24576
    ds_read_b64_tr_b16 v[106:107], v242 offset:25088
    v_mfma_f32_16x16x32_bf16 v[28:31], v[108:111], v[200:203], v[28:31]
    v_mfma_f32_16x16x32_bf16 v[44:47], v[108:111], v[204:207], v[44:47]
    ds_read_b64_tr_b16 v[108:109], v243 offset:24576
    ds_read_b64_tr_b16 v[110:111], v243 offset:25088
    s_add_u32 s33, s33, 4096
    buffer_load_dwordx4 v[200:203], v1, s[4:7], s33 offen offset:0 sc1
    s_add_u32 s34, s34, 4096
    buffer_load_dwordx4 v[204:207], v1, s[4:7], s34 offen offset:0 sc1
    s_waitcnt vmcnt(12)
    v_mfma_f32_16x16x32_bf16 v[16:19], v[112:115], v[208:211], v[16:19]
    v_mfma_f32_16x16x32_bf16 v[32:35], v[112:115], v[212:215], v[32:35]
    ds_read_b64_tr_b16 v[112:113], v240 offset:32768
    ds_read_b64_tr_b16 v[114:115], v240 offset:33280
    v_mfma_f32_16x16x32_bf16 v[20:23], v[116:119], v[208:211], v[20:23]
    v_mfma_f32_16x16x32_bf16 v[36:39], v[116:119], v[212:215], v[36:39]
    ds_read_b64_tr_b16 v[116:117], v241 offset:32768
    ds_read_b64_tr_b16 v[118:119], v241 offset:33280
    v_mfma_f32_16x16x32_bf16 v[24:27], v[120:123], v[208:211], v[24:27]
    v_mfma_f32_16x16x32_bf16 v[40:43], v[120:123], v[212:215], v[40:43]
    ds_read_b64_tr_b16 v[120:121], v242 offset:32768
    ds_read_b64_tr_b16 v[122:123], v242 offset:33280
    v_mfma_f32_16x16x32_bf16 v[28:31], v[124:127], v[208:211], v[28:31]
    v_mfma_f32_16x16x32_bf16 v[44:47], v[124:127], v[212:215], v[44:47]
    ds_read_b64_tr_b16 v[124:125], v243 offset:32768
    ds_read_b64_tr_b16 v[126:127], v243 offset:33280
    buffer_load_dwordx4 v[208:211], v1, s[4:7], s33 offen offset:2048 sc1
    buffer_load_dwordx4 v[212:215], v1, s[4:7], s34 offen offset:2048 sc1
    s_waitcnt vmcnt(12)
    v_mfma_f32_16x16x32_bf16 v[16:19], v[128:131], v[216:219], v[16:19]
    v_mfma_f32_16x16x32_bf16 v[32:35], v[128:131], v[220:223], v[32:35]
    ds_read_b64_tr_b16 v[128:129], v240 offset:40960
    ds_read_b64_tr_b16 v[130:131], v240 offset:41472
    v_mfma_f32_16x16x32_bf16 v[20:23], v[132:135], v[216:219], v[20:23]
    v_mfma_f32_16x16x32_bf16 v[36:39], v[132:135], v[220:223], v[36:39]
    ds_read_b64_tr_b16 v[132:133], v241 offset:40960
    ds_read_b64_tr_b16 v[134:135], v241 offset:41472
    v_mfma_f32_16x16x32_bf16 v[24:27], v[136:139], v[216:219], v[24:27]
    v_mfma_f32_16x16x32_bf16 v[40:43], v[136:139], v[220:223], v[40:43]
    ds_read_b64_tr_b16 v[136:137], v242 offset:40960
    ds_read_b64_tr_b16 v[138:139], v242 offset:41472
    v_mfma_f32_16x16x32_bf16 v[28:31], v[140:143], v[216:219], v[28:31]
    v_mfma_f32_16x16x32_bf16 v[44:47], v[140:143], v[220:223], v[44:47]
    ds_read_b64_tr_b16 v[140:141], v243 offset:40960
    ds_read_b64_tr_b16 v[142:143], v243 offset:41472
    s_add_u32 s33, s33, 4096
    buffer_load_dwordx4 v[216:219], v1, s[4:7], s33 offen offset:0 sc1
    s_add_u32 s34, s34, 4096
    buffer_load_dwordx4 v[220:223], v1, s[4:7], s34 offen offset:0 sc1
    s_waitcnt vmcnt(12)
    v_mfma_f32_16x16x32_bf16 v[16:19], v[144:147], v[224:227], v[16:19]
    v_mfma_f32_16x16x32_bf16 v[32:35], v[144:147], v[228:231], v[32:35]
    ds_read_b64_tr_b16 v[144:145], v240 offset:49152
    ds_read_b64_tr_b16 v[146:147], v240 offset:49664
    v_mfma_f32_16x16x32_bf16 v[20:23], v[148:151], v[224:227], v[20:23]
    v_mfma_f32_16x16x32_bf16 v[36:39], v[148:151], v[228:231], v[36:39]
    ds_read_b64_tr_b16 v[148:149], v241 offset:49152
    ds_read_b64_tr_b16 v[150:151], v241 offset:49664
    v_mfma_f32_16x16x32_bf16 v[24:27], v[152:155], v[224:227], v[24:27]
    v_mfma_f32_16x16x32_bf16 v[40:43], v[152:155], v[228:231], v[40:43]
    ds_read_b64_tr_b16 v[152:153], v242 offset:49152
    ds_read_b64_tr_b16 v[154:155], v242 offset:49664
    v_mfma_f32_16x16x32_bf16 v[28:31], v[156:159], v[224:227], v[28:31]
    v_mfma_f32_16x16x32_bf16 v[44:47], v[156:159], v[228:231], v[44:47]
    ds_read_b64_tr_b16 v[156:157], v243 offset:49152
    ds_read_b64_tr_b16 v[158:159], v243 offset:49664
    buffer_load_dwordx4 v[224:227], v1, s[4:7], s33 offen offset:2048 sc1
    buffer_load_dwordx4 v[228:231], v1, s[4:7], s34 offen offset:2048 sc1
    s_waitcnt vmcnt(12)
    v_mfma_f32_16x16x32_bf16 v[16:19], v[160:163], v[176:179], v[16:19]
    v_mfma_f32_16x16x32_bf16 v[32:35], v[160:163], v[180:183], v[32:35]
    ds_read_b64_tr_b16 v[160:161], v240 offset:57344
    ds_read_b64_tr_b16 v[162:163], v240 offset:57856
    v_mfma_f32_16x16x32_bf16 v[20:23], v[164:167], v[176:179], v[20:23]
    v_mfma_f32_16x16x32_bf16 v[36:39], v[164:167], v[180:183], v[36:39]
    ds_read_b64_tr_b16 v[164:165], v241 offset:57344
    ds_read_b64_tr_b16 v[166:167], v241 offset:57856
    v_mfma_f32_16x16x32_bf16 v[24:27], v[168:171], v[176:179], v[24:27]
    v_mfma_f32_16x16x32_bf16 v[40:43], v[168:171], v[180:183], v[40:43]
    ds_read_b64_tr_b16 v[168:169], v242 offset:57344
    ds_read_b64_tr_b16 v[170:171], v242 offset:57856
    v_mfma_f32_16x16x32_bf16 v[28:31], v[172:175], v[176:179], v[28:31]
    v_mfma_f32_16x16x32_bf16 v[44:47], v[172:175], v[180:183], v[44:47]
    ds_read_b64_tr_b16 v[172:173], v243 offset:57344
    ds_read_b64_tr_b16 v[174:175], v243 offset:57856
    s_add_u32 s33, s33, 4096
    buffer_load_dwordx4 v[176:179], v1, s[4:7], s33 offen offset:0 sc1
    s_add_u32 s34, s34, 4096
    buffer_load_dwordx4 v[180:183], v1, s[4:7], s34 offen offset:0 sc1
    s_waitcnt lgkmcnt(8)
    s_waitcnt vmcnt(12)
    s_barrier
    v_mfma_f32_16x16x32_bf16 v[16:19], v[48:51], v[184:187], v[16:19]
    v_mfma_f32_16x16x32_bf16 v[32:35], v[48:51], v[188:191], v[32:35]
    ds_read_b64_tr_b16 v[48:49], v244 offset:0
    ds_read_b64_tr_b16 v[50:51], v244 offset:512
    v_mfma_f32_16x16x32_bf16 v[20:23], v[52:55], v[184:187], v[20:23]
    v_mfma_f32_16x16x32_bf16 v[36:39], v[52:55], v[188:191], v[36:39]
    ds_read_b64_tr_b16 v[52:53], v245 offset:0
    ds_read_b64_tr_b16 v[54:55], v245 offset:512
    v_mfma_f32_16x16x32_bf16 v[24:27], v[56:59], v[184:187], v[24:27]
    v_mfma_f32_16x16x32_bf16 v[40:43], v[56:59], v[188:191], v[40:43]
    ds_read_b64_tr_b16 v[56:57], v246 offset:0
    ds_read_b64_tr_b16 v[58:59], v246 offset:512
    v_mfma_f32_16x16x32_bf16 v[28:31], v[60:63], v[184:187], v[28:31]
    v_mfma_f32_16x16x32_bf16 v[44:47], v[60:63], v[188:191], v[44:47]
    ds_read_b64_tr_b16 v[60:61], v247 offset:0
    ds_read_b64_tr_b16 v[62:63], v247 offset:512
    buffer_load_dwordx4 v[184:187], v1, s[4:7], s33 offen offset:2048 sc1
    buffer_load_dwordx4 v[188:191], v1, s[4:7], s34 offen offset:2048 sc1
    s_waitcnt lgkmcnt(8)
    s_waitcnt vmcnt(12)
    v_mfma_f32_16x16x32_bf16 v[16:19], v[64:67], v[192:195], v[16:19]
    v_mfma_f32_16x16x32_bf16 v[32:35], v[64:67], v[196:199], v[32:35]
    ds_read_b64_tr_b16 v[64:65], v244 offset:8192
    ds_read_b64_tr_b16 v[66:67], v244 offset:8704
    v_mfma_f32_16x16x32_bf16 v[20:23], v[68:71], v[192:195], v[20:23]
    v_mfma_f32_16x16x32_bf16 v[36:39], v[68:71], v[196:199], v[36:39]
    ds_read_b64_tr_b16 v[68:69], v245 offset:8192
    ds_read_b64_tr_b16 v[70:71], v245 offset:8704
    v_mfma_f32_16x16x32_bf16 v[24:27], v[72:75], v[192:195], v[24:27]
    v_mfma_f32_16x16x32_bf16 v[40:43], v[72:75], v[196:199], v[40:43]
    ds_read_b64_tr_b16 v[72:73], v246 offset:8192
    ds_read_b64_tr_b16 v[74:75], v246 offset:8704
    v_mfma_f32_16x16x32_bf16 v[28:31], v[76:79], v[192:195], v[28:31]
    v_mfma_f32_16x16x32_bf16 v[44:47], v[76:79], v[196:199], v[44:47]
    ds_read_b64_tr_b16 v[76:77], v247 offset:8192
    ds_read_b64_tr_b16 v[78:79], v247 offset:8704
    s_add_u32 s33, s33, 4096
    buffer_load_dwordx4 v[192:195], v1, s[4:7], s33 offen offset:0 sc1
    s_add_u32 s34, s34, 4096
    buffer_load_dwordx4 v[196:199], v1, s[4:7], s34 offen offset:0 sc1
    s_waitcnt lgkmcnt(8)
    s_waitcnt vmcnt(12)
    v_mfma_f32_16x16x32_bf16 v[16:19], v[80:83], v[200:203], v[16:19]
    v_mfma_f32_16x16x32_bf16 v[32:35], v[80:83], v[204:207], v[32:35]
    ds_read_b64_tr_b16 v[80:81], v244 offset:16384
    ds_read_b64_tr_b16 v[82:83], v244 offset:16896
    v_mfma_f32_16x16x32_bf16 v[20:23], v[84:87], v[200:203], v[20:23]
    v_mfma_f32_16x16x32_bf16 v[36:39], v[84:87], v[204:207], v[36:39]
    ds_read_b64_tr_b16 v[84:85], v245 offset:16384
    ds_read_b64_tr_b16 v[86:87], v245 offset:16896
    v_mfma_f32_16x16x32_bf16 v[24:27], v[88:91], v[200:203], v[24:27]
    v_mfma_f32_16x16x32_bf16 v[40:43], v[88:91], v[204:207], v[40:43]
    ds_read_b64_tr_b16 v[88:89], v246 offset:16384
    ds_read_b64_tr_b16 v[90:91], v246 offset:16896
    v_mfma_f32_16x16x32_bf16 v[28:31], v[92:95], v[200:203], v[28:31]
    v_mfma_f32_16x16x32_bf16 v[44:47], v[92:95], v[204:207], v[44:47]
    ds_read_b64_tr_b16 v[92:93], v247 offset:16384
    ds_read_b64_tr_b16 v[94:95], v247 offset:16896
    buffer_load_dwordx4 v[200:203], v1, s[4:7], s33 offen offset:2048 sc1
    buffer_load_dwordx4 v[204:207], v1, s[4:7], s34 offen offset:2048 sc1
    s_waitcnt lgkmcnt(8)
    s_waitcnt vmcnt(12)
    v_mfma_f32_16x16x32_bf16 v[16:19], v[96:99], v[208:211], v[16:19]
    v_mfma_f32_16x16x32_bf16 v[32:35], v[96:99], v[212:215], v[32:35]
    ds_read_b64_tr_b16 v[96:97], v244 offset:24576
    ds_read_b64_tr_b16 v[98:99], v244 offset:25088
    v_mfma_f32_16x16x32_bf16 v[20:23], v[100:103], v[208:211], v[20:23]
    v_mfma_f32_16x16x32_bf16 v[36:39], v[100:103], v[212:215], v[36:39]
    ds_read_b64_tr_b16 v[100:101], v245 offset:24576
    ds_read_b64_tr_b16 v[102:103], v245 offset:25088
    v_mfma_f32_16x16x32_bf16 v[24:27], v[104:107], v[208:211], v[24:27]
    v_mfma_f32_16x16x32_bf16 v[40:43], v[104:107], v[212:215], v[40:43]
    ds_read_b64_tr_b16 v[104:105], v246 offset:24576
    ds_read_b64_tr_b16 v[106:107], v246 offset:25088
    v_mfma_f32_16x16x32_bf16 v[28:31], v[108:111], v[208:211], v[28:31]
    v_mfma_f32_16x16x32_bf16 v[44:47], v[108:111], v[212:215], v[44:47]
    ds_read_b64_tr_b16 v[108:109], v247 offset:24576
    ds_read_b64_tr_b16 v[110:111], v247 offset:25088
    s_add_u32 s33, s33, 4096
    buffer_load_dwordx4 v[208:211], v1, s[4:7], s33 offen offset:0 sc1
    s_add_u32 s34, s34, 4096
    buffer_load_dwordx4 v[212:215], v1, s[4:7], s34 offen offset:0 sc1
    s_waitcnt lgkmcnt(8)
    s_waitcnt vmcnt(12)
    v_mfma_f32_16x16x32_bf16 v[16:19], v[112:115], v[216:219], v[16:19]
    v_mfma_f32_16x16x32_bf16 v[32:35], v[112:115], v[220:223], v[32:35]
    ds_read_b64_tr_b16 v[112:113], v236 offset:0
    ds_read_b64_tr_b16 v[114:115], v236 offset:512
    v_mfma_f32_16x16x32_bf16 v[20:23], v[116:119], v[216:219], v[20:23]
    v_mfma_f32_16x16x32_bf16 v[36:39], v[116:119], v[220:223], v[36:39]
    ds_read_b64_tr_b16 v[116:117], v237 offset:0
    ds_read_b64_tr_b16 v[118:119], v237 offset:512
    v_mfma_f32_16x16x32_bf16 v[24:27], v[120:123], v[216:219], v[24:27]
    v_mfma_f32_16x16x32_bf16 v[40:43], v[120:123], v[220:223], v[40:43]
    ds_read_b64_tr_b16 v[120:121], v238 offset:0
    ds_read_b64_tr_b16 v[122:123], v238 offset:512
    v_mfma_f32_16x16x32_bf16 v[28:31], v[124:127], v[216:219], v[28:31]
    v_mfma_f32_16x16x32_bf16 v[44:47], v[124:127], v[220:223], v[44:47]
    ds_read_b64_tr_b16 v[124:125], v239 offset:0
    ds_read_b64_tr_b16 v[126:127], v239 offset:512
    buffer_load_dwordx4 v[216:219], v1, s[4:7], s33 offen offset:2048 sc1
    buffer_load_dwordx4 v[220:223], v1, s[4:7], s34 offen offset:2048 sc1
    s_waitcnt lgkmcnt(8)
    s_waitcnt vmcnt(12)
    v_mfma_f32_16x16x32_bf16 v[16:19], v[128:131], v[224:227], v[16:19]
    v_mfma_f32_16x16x32_bf16 v[32:35], v[128:131], v[228:231], v[32:35]
    ds_read_b64_tr_b16 v[128:129], v236 offset:8192
    ds_read_b64_tr_b16 v[130:131], v236 offset:8704
    v_mfma_f32_16x16x32_bf16 v[20:23], v[132:135], v[224:227], v[20:23]
    v_mfma_f32_16x16x32_bf16 v[36:39], v[132:135], v[228:231], v[36:39]
    ds_read_b64_tr_b16 v[132:133], v237 offset:8192
    ds_read_b64_tr_b16 v[134:135], v237 offset:8704
    v_mfma_f32_16x16x32_bf16 v[24:27], v[136:139], v[224:227], v[24:27]
    v_mfma_f32_16x16x32_bf16 v[40:43], v[136:139], v[228:231], v[40:43]
    ds_read_b64_tr_b16 v[136:137], v238 offset:8192
    ds_read_b64_tr_b16 v[138:139], v238 offset:8704
    v_mfma_f32_16x16x32_bf16 v[28:31], v[140:143], v[224:227], v[28:31]
    v_mfma_f32_16x16x32_bf16 v[44:47], v[140:143], v[228:231], v[44:47]
    ds_read_b64_tr_b16 v[140:141], v239 offset:8192
    ds_read_b64_tr_b16 v[142:143], v239 offset:8704
    s_add_u32 s33, s33, 4096
    buffer_load_dwordx4 v[224:227], v1, s[4:7], s33 offen offset:0 sc1
    s_add_u32 s34, s34, 4096
    buffer_load_dwordx4 v[228:231], v1, s[4:7], s34 offen offset:0 sc1
    s_waitcnt lgkmcnt(8)
    s_waitcnt vmcnt(12)
    v_mfma_f32_16x16x32_bf16 v[16:19], v[144:147], v[176:179], v[16:19]
    v_mfma_f32_16x16x32_bf16 v[32:35], v[144:147], v[180:183], v[32:35]
    ds_read_b64_tr_b16 v[144:145], v236 offset:16384
    ds_read_b64_tr_b16 v[146:147], v236 offset:16896
    v_mfma_f32_16x16x32_bf16 v[20:23], v[148:151], v[176:179], v[20:23]
    v_mfma_f32_16x16x32_bf16 v[36:39], v[148:151], v[180:183], v[36:39]
    ds_read_b64_tr_b16 v[148:149], v237 offset:16384
    ds_read_b64_tr_b16 v[150:151], v237 offset:16896
    v_mfma_f32_16x16x32_bf16 v[24:27], v[152:155], v[176:179], v[24:27]
    v_mfma_f32_16x16x32_bf16 v[40:43], v[152:155], v[180:183], v[40:43]
    ds_read_b64_tr_b16 v[152:153], v238 offset:16384
    ds_read_b64_tr_b16 v[154:155], v238 offset:16896
    v_mfma_f32_16x16x32_bf16 v[28:31], v[156:159], v[176:179], v[28:31]
    v_mfma_f32_16x16x32_bf16 v[44:47], v[156:159], v[180:183], v[44:47]
    ds_read_b64_tr_b16 v[156:157], v239 offset:16384
    ds_read_b64_tr_b16 v[158:159], v239 offset:16896
    buffer_load_dwordx4 v[176:179], v1, s[4:7], s33 offen offset:2048 sc1
    buffer_load_dwordx4 v[180:183], v1, s[4:7], s34 offen offset:2048 sc1
    s_waitcnt lgkmcnt(8)
    s_waitcnt vmcnt(12)
    v_mfma_f32_16x16x32_bf16 v[16:19], v[160:163], v[184:187], v[16:19]
    v_mfma_f32_16x16x32_bf16 v[32:35], v[160:163], v[188:191], v[32:35]
    ds_read_b64_tr_b16 v[160:161], v236 offset:24576
    ds_read_b64_tr_b16 v[162:163], v236 offset:25088
    v_mfma_f32_16x16x32_bf16 v[20:23], v[164:167], v[184:187], v[20:23]
    v_mfma_f32_16x16x32_bf16 v[36:39], v[164:167], v[188:191], v[36:39]
    ds_read_b64_tr_b16 v[164:165], v237 offset:24576
    ds_read_b64_tr_b16 v[166:167], v237 offset:25088
    v_mfma_f32_16x16x32_bf16 v[24:27], v[168:171], v[184:187], v[24:27]
    v_mfma_f32_16x16x32_bf16 v[40:43], v[168:171], v[188:191], v[40:43]
    ds_read_b64_tr_b16 v[168:169], v238 offset:24576
    ds_read_b64_tr_b16 v[170:171], v238 offset:25088
    v_mfma_f32_16x16x32_bf16 v[28:31], v[172:175], v[184:187], v[28:31]
    v_mfma_f32_16x16x32_bf16 v[44:47], v[172:175], v[188:191], v[44:47]
    ds_read_b64_tr_b16 v[172:173], v239 offset:24576
    ds_read_b64_tr_b16 v[174:175], v239 offset:25088
    s_add_u32 s33, s33, 4096
    buffer_load_dwordx4 v[184:187], v1, s[4:7], s33 offen offset:0 sc1
    s_add_u32 s34, s34, 4096
    buffer_load_dwordx4 v[188:191], v1, s[4:7], s34 offen offset:0 sc1
    s_waitcnt lgkmcnt(8)
    s_waitcnt vmcnt(12)
    v_mfma_f32_16x16x32_bf16 v[16:19], v[48:51], v[192:195], v[16:19]
    v_mfma_f32_16x16x32_bf16 v[32:35], v[48:51], v[196:199], v[32:35]
    ds_read_b64_tr_b16 v[48:49], v236 offset:32768
    ds_read_b64_tr_b16 v[50:51], v236 offset:33280
    v_mfma_f32_16x16x32_bf16 v[20:23], v[52:55], v[192:195], v[20:23]
    v_mfma_f32_16x16x32_bf16 v[36:39], v[52:55], v[196:199], v[36:39]
    ds_read_b64_tr_b16 v[52:53], v237 offset:32768
    ds_read_b64_tr_b16 v[54:55], v237 offset:33280
    v_mfma_f32_16x16x32_bf16 v[24:27], v[56:59], v[192:195], v[24:27]
    v_mfma_f32_16x16x32_bf16 v[40:43], v[56:59], v[196:199], v[40:43]
    ds_read_b64_tr_b16 v[56:57], v238 offset:32768
    ds_read_b64_tr_b16 v[58:59], v238 offset:33280
    v_mfma_f32_16x16x32_bf16 v[28:31], v[60:63], v[192:195], v[28:31]
    v_mfma_f32_16x16x32_bf16 v[44:47], v[60:63], v[196:199], v[44:47]
    ds_read_b64_tr_b16 v[60:61], v239 offset:32768
    ds_read_b64_tr_b16 v[62:63], v239 offset:33280
    buffer_load_dwordx4 v[192:195], v1, s[4:7], s33 offen offset:2048 sc1
    buffer_load_dwordx4 v[196:199], v1, s[4:7], s34 offen offset:2048 sc1
    s_waitcnt lgkmcnt(8)
    s_waitcnt vmcnt(12)
    v_mfma_f32_16x16x32_bf16 v[16:19], v[64:67], v[200:203], v[16:19]
    v_mfma_f32_16x16x32_bf16 v[32:35], v[64:67], v[204:207], v[32:35]
    ds_read_b64_tr_b16 v[64:65], v236 offset:40960
    ds_read_b64_tr_b16 v[66:67], v236 offset:41472
    v_mfma_f32_16x16x32_bf16 v[20:23], v[68:71], v[200:203], v[20:23]
    v_mfma_f32_16x16x32_bf16 v[36:39], v[68:71], v[204:207], v[36:39]
    ds_read_b64_tr_b16 v[68:69], v237 offset:40960
    ds_read_b64_tr_b16 v[70:71], v237 offset:41472
    v_mfma_f32_16x16x32_bf16 v[24:27], v[72:75], v[200:203], v[24:27]
    v_mfma_f32_16x16x32_bf16 v[40:43], v[72:75], v[204:207], v[40:43]
    ds_read_b64_tr_b16 v[72:73], v238 offset:40960
    ds_read_b64_tr_b16 v[74:75], v238 offset:41472
    v_mfma_f32_16x16x32_bf16 v[28:31], v[76:79], v[200:203], v[28:31]
    v_mfma_f32_16x16x32_bf16 v[44:47], v[76:79], v[204:207], v[44:47]
    ds_read_b64_tr_b16 v[76:77], v239 offset:40960
    ds_read_b64_tr_b16 v[78:79], v239 offset:41472
    s_add_u32 s33, s33, 4096
    buffer_load_dwordx4 v[200:203], v1, s[4:7], s33 offen offset:0 sc1
    s_add_u32 s34, s34, 4096
    buffer_load_dwordx4 v[204:207], v1, s[4:7], s34 offen offset:0 sc1
    s_waitcnt lgkmcnt(8)
    s_waitcnt vmcnt(12)
    v_mfma_f32_16x16x32_bf16 v[16:19], v[80:83], v[208:211], v[16:19]
    v_mfma_f32_16x16x32_bf16 v[32:35], v[80:83], v[212:215], v[32:35]
    ds_read_b64_tr_b16 v[80:81], v236 offset:49152
    ds_read_b64_tr_b16 v[82:83], v236 offset:49664
    v_mfma_f32_16x16x32_bf16 v[20:23], v[84:87], v[208:211], v[20:23]
    v_mfma_f32_16x16x32_bf16 v[36:39], v[84:87], v[212:215], v[36:39]
    ds_read_b64_tr_b16 v[84:85], v237 offset:49152
    ds_read_b64_tr_b16 v[86:87], v237 offset:49664
    v_mfma_f32_16x16x32_bf16 v[24:27], v[88:91], v[208:211], v[24:27]
    v_mfma_f32_16x16x32_bf16 v[40:43], v[88:91], v[212:215], v[40:43]
    ds_read_b64_tr_b16 v[88:89], v238 offset:49152
    ds_read_b64_tr_b16 v[90:91], v238 offset:49664
    v_mfma_f32_16x16x32_bf16 v[28:31], v[92:95], v[208:211], v[28:31]
    v_mfma_f32_16x16x32_bf16 v[44:47], v[92:95], v[212:215], v[44:47]
    ds_read_b64_tr_b16 v[92:93], v239 offset:49152
    ds_read_b64_tr_b16 v[94:95], v239 offset:49664
    buffer_load_dwordx4 v[208:211], v1, s[4:7], s33 offen offset:2048 sc1
    buffer_load_dwordx4 v[212:215], v1, s[4:7], s34 offen offset:2048 sc1
    s_waitcnt lgkmcnt(8)
    s_waitcnt vmcnt(12)
    v_mfma_f32_16x16x32_bf16 v[16:19], v[96:99], v[216:219], v[16:19]
    v_mfma_f32_16x16x32_bf16 v[32:35], v[96:99], v[220:223], v[32:35]
    ds_read_b64_tr_b16 v[96:97], v236 offset:57344
    ds_read_b64_tr_b16 v[98:99], v236 offset:57856
    v_mfma_f32_16x16x32_bf16 v[20:23], v[100:103], v[216:219], v[20:23]
    v_mfma_f32_16x16x32_bf16 v[36:39], v[100:103], v[220:223], v[36:39]
    ds_read_b64_tr_b16 v[100:101], v237 offset:57344
    ds_read_b64_tr_b16 v[102:103], v237 offset:57856
    v_mfma_f32_16x16x32_bf16 v[24:27], v[104:107], v[216:219], v[24:27]
    v_mfma_f32_16x16x32_bf16 v[40:43], v[104:107], v[220:223], v[40:43]
    ds_read_b64_tr_b16 v[104:105], v238 offset:57344
    ds_read_b64_tr_b16 v[106:107], v238 offset:57856
    v_mfma_f32_16x16x32_bf16 v[28:31], v[108:111], v[216:219], v[28:31]
    v_mfma_f32_16x16x32_bf16 v[44:47], v[108:111], v[220:223], v[44:47]
    ds_read_b64_tr_b16 v[108:109], v239 offset:57344
    ds_read_b64_tr_b16 v[110:111], v239 offset:57856
    s_add_u32 s33, s33, 4096
    buffer_load_dwordx4 v[216:219], v1, s[4:7], s33 offen offset:0 sc1
    s_add_u32 s34, s34, 4096
    buffer_load_dwordx4 v[220:223], v1, s[4:7], s34 offen offset:0 sc1
    s_waitcnt lgkmcnt(8)
    s_waitcnt vmcnt(12)
    v_mfma_f32_16x16x32_bf16 v[16:19], v[112:115], v[224:227], v[16:19]
    v_mfma_f32_16x16x32_bf16 v[32:35], v[112:115], v[228:231], v[32:35]
    v_mfma_f32_16x16x32_bf16 v[20:23], v[116:119], v[224:227], v[20:23]
    v_mfma_f32_16x16x32_bf16 v[36:39], v[116:119], v[228:231], v[36:39]
    v_mfma_f32_16x16x32_bf16 v[24:27], v[120:123], v[224:227], v[24:27]
    v_mfma_f32_16x16x32_bf16 v[40:43], v[120:123], v[228:231], v[40:43]
    v_mfma_f32_16x16x32_bf16 v[28:31], v[124:127], v[224:227], v[28:31]
    v_mfma_f32_16x16x32_bf16 v[44:47], v[124:127], v[228:231], v[44:47]
    buffer_load_dwordx4 v[224:227], v1, s[4:7], s33 offen offset:2048 sc1
    buffer_load_dwordx4 v[228:231], v1, s[4:7], s34 offen offset:2048 sc1
    s_waitcnt lgkmcnt(0)
    s_waitcnt vmcnt(12)
    v_mfma_f32_16x16x32_bf16 v[16:19], v[128:131], v[176:179], v[16:19]
    v_mfma_f32_16x16x32_bf16 v[32:35], v[128:131], v[180:183], v[32:35]
    v_mfma_f32_16x16x32_bf16 v[20:23], v[132:135], v[176:179], v[20:23]
    v_mfma_f32_16x16x32_bf16 v[36:39], v[132:135], v[180:183], v[36:39]
    v_mfma_f32_16x16x32_bf16 v[24:27], v[136:139], v[176:179], v[24:27]
    v_mfma_f32_16x16x32_bf16 v[40:43], v[136:139], v[180:183], v[40:43]
    v_mfma_f32_16x16x32_bf16 v[28:31], v[140:143], v[176:179], v[28:31]
    v_mfma_f32_16x16x32_bf16 v[44:47], v[140:143], v[180:183], v[44:47]
    s_waitcnt lgkmcnt(0)
    s_waitcnt vmcnt(10)
    v_mfma_f32_16x16x32_bf16 v[16:19], v[144:147], v[184:187], v[16:19]
    v_mfma_f32_16x16x32_bf16 v[32:35], v[144:147], v[188:191], v[32:35]
    v_mfma_f32_16x16x32_bf16 v[20:23], v[148:151], v[184:187], v[20:23]
    v_mfma_f32_16x16x32_bf16 v[36:39], v[148:151], v[188:191], v[36:39]
    v_mfma_f32_16x16x32_bf16 v[24:27], v[152:155], v[184:187], v[24:27]
    v_mfma_f32_16x16x32_bf16 v[40:43], v[152:155], v[188:191], v[40:43]
    v_mfma_f32_16x16x32_bf16 v[28:31], v[156:159], v[184:187], v[28:31]
    v_mfma_f32_16x16x32_bf16 v[44:47], v[156:159], v[188:191], v[44:47]
    s_waitcnt lgkmcnt(0)
    s_waitcnt vmcnt(8)
    v_mfma_f32_16x16x32_bf16 v[16:19], v[160:163], v[192:195], v[16:19]
    v_mfma_f32_16x16x32_bf16 v[32:35], v[160:163], v[196:199], v[32:35]
    v_mfma_f32_16x16x32_bf16 v[20:23], v[164:167], v[192:195], v[20:23]
    v_mfma_f32_16x16x32_bf16 v[36:39], v[164:167], v[196:199], v[36:39]
    v_mfma_f32_16x16x32_bf16 v[24:27], v[168:171], v[192:195], v[24:27]
    v_mfma_f32_16x16x32_bf16 v[40:43], v[168:171], v[196:199], v[40:43]
    v_mfma_f32_16x16x32_bf16 v[28:31], v[172:175], v[192:195], v[28:31]
    v_mfma_f32_16x16x32_bf16 v[44:47], v[172:175], v[196:199], v[44:47]
    s_waitcnt lgkmcnt(0)
    s_waitcnt vmcnt(6)
    v_mfma_f32_16x16x32_bf16 v[16:19], v[48:51], v[200:203], v[16:19]
    v_mfma_f32_16x16x32_bf16 v[32:35], v[48:51], v[204:207], v[32:35]
    v_mfma_f32_16x16x32_bf16 v[20:23], v[52:55], v[200:203], v[20:23]
    v_mfma_f32_16x16x32_bf16 v[36:39], v[52:55], v[204:207], v[36:39]
    v_mfma_f32_16x16x32_bf16 v[24:27], v[56:59], v[200:203], v[24:27]
    v_mfma_f32_16x16x32_bf16 v[40:43], v[56:59], v[204:207], v[40:43]
    v_mfma_f32_16x16x32_bf16 v[28:31], v[60:63], v[200:203], v[28:31]
    v_mfma_f32_16x16x32_bf16 v[44:47], v[60:63], v[204:207], v[44:47]
    s_waitcnt lgkmcnt(0)
    s_waitcnt vmcnt(4)
    v_mfma_f32_16x16x32_bf16 v[16:19], v[64:67], v[208:211], v[16:19]
    v_mfma_f32_16x16x32_bf16 v[32:35], v[64:67], v[212:215], v[32:35]
    v_mfma_f32_16x16x32_bf16 v[20:23], v[68:71], v[208:211], v[20:23]
    v_mfma_f32_16x16x32_bf16 v[36:39], v[68:71], v[212:215], v[36:39]
    v_mfma_f32_16x16x32_bf16 v[24:27], v[72:75], v[208:211], v[24:27]
    v_mfma_f32_16x16x32_bf16 v[40:43], v[72:75], v[212:215], v[40:43]
    v_mfma_f32_16x16x32_bf16 v[28:31], v[76:79], v[208:211], v[28:31]
    v_mfma_f32_16x16x32_bf16 v[44:47], v[76:79], v[212:215], v[44:47]
    s_waitcnt lgkmcnt(0)
    s_waitcnt vmcnt(2)
    v_mfma_f32_16x16x32_bf16 v[16:19], v[80:83], v[216:219], v[16:19]
    v_mfma_f32_16x16x32_bf16 v[32:35], v[80:83], v[220:223], v[32:35]
    v_mfma_f32_16x16x32_bf16 v[20:23], v[84:87], v[216:219], v[20:23]
    v_mfma_f32_16x16x32_bf16 v[36:39], v[84:87], v[220:223], v[36:39]
    v_mfma_f32_16x16x32_bf16 v[24:27], v[88:91], v[216:219], v[24:27]
    v_mfma_f32_16x16x32_bf16 v[40:43], v[88:91], v[220:223], v[40:43]
    v_mfma_f32_16x16x32_bf16 v[28:31], v[92:95], v[216:219], v[28:31]
    v_mfma_f32_16x16x32_bf16 v[44:47], v[92:95], v[220:223], v[44:47]
    s_waitcnt lgkmcnt(0)
    s_waitcnt vmcnt(0)
    v_mfma_f32_16x16x32_bf16 v[16:19], v[96:99], v[224:227], v[16:19]
    v_mfma_f32_16x16x32_bf16 v[32:35], v[96:99], v[228:231], v[32:35]
    v_mfma_f32_16x16x32_bf16 v[20:23], v[100:103], v[224:227], v[20:23]
    v_mfma_f32_16x16x32_bf16 v[36:39], v[100:103], v[228:231], v[36:39]
    v_mfma_f32_16x16x32_bf16 v[24:27], v[104:107], v[224:227], v[24:27]
    v_mfma_f32_16x16x32_bf16 v[40:43], v[104:107], v[228:231], v[40:43]
    v_mfma_f32_16x16x32_bf16 v[28:31], v[108:111], v[224:227], v[28:31]
    v_mfma_f32_16x16x32_bf16 v[44:47], v[108:111], v[228:231], v[44:47]
    s_barrier
    s_xor_b32 s36, s26, 2
    s_lshl_b32 s36, s36, 12
    s_add_u32 s36, s36, 0
    v_add_u32 v14, s36, v1
    s_lshl_b32 s36, s26, 12
    s_add_u32 s36, s36, 0
    v_add_u32 v15, s36, v1
    ds_write_b128 v14, v[32:35] offset:0
    ds_write_b128 v14, v[36:39] offset:1024
    ds_write_b128 v14, v[40:43] offset:2048
    ds_write_b128 v14, v[44:47] offset:3072
    s_waitcnt lgkmcnt(0)
    s_barrier
    ds_read_b128 v[32:35], v15 offset:0
    ds_read_b128 v[36:39], v15 offset:1024
    ds_read_b128 v[40:43], v15 offset:2048
    ds_read_b128 v[44:47], v15 offset:3072
    v_lshlrev_b32 v48, 16, v248
    v_and_b32 v49, 0xffff0000, v248
    v_lshlrev_b32 v50, 16, v249
    v_and_b32 v51, 0xffff0000, v249
    v_lshlrev_b32 v52, 16, v250
    v_and_b32 v53, 0xffff0000, v250
    v_lshlrev_b32 v54, 16, v251
    v_and_b32 v55, 0xffff0000, v251
    v_lshlrev_b32 v56, 16, v252
    v_and_b32 v57, 0xffff0000, v252
    v_lshlrev_b32 v58, 16, v253
    v_and_b32 v59, 0xffff0000, v253
    v_lshlrev_b32 v60, 16, v254
    v_and_b32 v61, 0xffff0000, v254
    v_lshlrev_b32 v62, 16, v255
    v_and_b32 v63, 0xffff0000, v255
    v_pk_add_f32 v[16:17], v[16:17], v[48:49]
    v_pk_add_f32 v[18:19], v[18:19], v[50:51]
    v_pk_add_f32 v[20:21], v[20:21], v[52:53]
    v_pk_add_f32 v[22:23], v[22:23], v[54:55]
    v_pk_add_f32 v[24:25], v[24:25], v[56:57]
    v_pk_add_f32 v[26:27], v[26:27], v[58:59]
    v_pk_add_f32 v[28:29], v[28:29], v[60:61]
    v_pk_add_f32 v[30:31], v[30:31], v[62:63]
    s_waitcnt lgkmcnt(0)
    v_pk_add_f32 v[16:17], v[16:17], v[32:33]
    v_pk_add_f32 v[18:19], v[18:19], v[34:35]
    v_pk_add_f32 v[20:21], v[20:21], v[36:37]
    v_pk_add_f32 v[22:23], v[22:23], v[38:39]
    v_pk_add_f32 v[24:25], v[24:25], v[40:41]
    v_pk_add_f32 v[26:27], v[26:27], v[42:43]
    v_pk_add_f32 v[28:29], v[28:29], v[44:45]
    v_pk_add_f32 v[30:31], v[30:31], v[46:47]
    v_cvt_pk_bf16_f32 v64, v16, v17
    v_cvt_pk_bf16_f32 v65, v18, v19
    v_cvt_pk_bf16_f32 v66, v20, v21
    v_cvt_pk_bf16_f32 v67, v22, v23
    v_cvt_pk_bf16_f32 v68, v24, v25
    v_cvt_pk_bf16_f32 v69, v26, v27
    v_cvt_pk_bf16_f32 v70, v28, v29
    v_cvt_pk_bf16_f32 v71, v30, v31
    buffer_store_dwordx2 v[64:65], v7, s[20:23], s32 offen offset:0
    buffer_store_dwordx2 v[66:67], v7, s[20:23], s32 offen offset:32
    buffer_store_dwordx2 v[68:69], v7, s[20:23], s32 offen offset:64
    buffer_store_dwordx2 v[70:71], v7, s[20:23], s32 offen offset:96
L_end_sequential_preLN__sliding_local_dilated__geglu_ffn__prompt_kernel:
    s_endpgm
L_sequential_preLN__sliding_local_dilated__geglu_ffn__prompt_kernel_helper:
    v_lshrrev_b32 v8, 3, v4
    v_and_b32 v7, 7, v4
    v_xor_b32 v7, v7, v8
    v_lshlrev_b32 v8, 10, v8
    v_lshl_add_u32 v20, v7, 4, v8
    v_add_u32 v12, 0, v4
    v_mul_u32_u24 v13, 43691, v12
    v_lshrrev_b32 v13, 19, v13
    v_mul_u32_u24 v14, 12, v13
    v_sub_u32 v14, v12, v14
    v_lshrrev_b32 v15, 1, v14
    v_bfe_u32 v16, v13, 3, 1
    v_sub_u32 v15, v15, v16
    v_add_u32 v16, 6, v15
    v_min_u32 v15, v15, v16
    v_lshrrev_b32 v16, 1, v15
    v_lshlrev_b32 v16, 10, v16
    v_and_b32 v15, 1, v15
    v_lshl_add_u32 v16, v15, 5, v16
    v_and_b32 v14, 1, v14
    v_lshl_add_u32 v16, v14, 4, v16
    v_mul_u32_u24 v13, 3072, v13
    v_add_u32 v21, v13, v16
    v_add_u32 v12, 64, v4
    v_mul_u32_u24 v13, 43691, v12
    v_lshrrev_b32 v13, 19, v13
    v_mul_u32_u24 v14, 12, v13
    v_sub_u32 v14, v12, v14
    v_lshrrev_b32 v15, 1, v14
    v_bfe_u32 v16, v13, 3, 1
    v_sub_u32 v15, v15, v16
    v_add_u32 v16, 6, v15
    v_min_u32 v15, v15, v16
    v_lshrrev_b32 v16, 1, v15
    v_lshlrev_b32 v16, 10, v16
    v_and_b32 v15, 1, v15
    v_lshl_add_u32 v16, v15, 5, v16
    v_and_b32 v14, 1, v14
    v_lshl_add_u32 v16, v14, 4, v16
    v_mul_u32_u24 v13, 3072, v13
    v_add_u32 v22, v13, v16
    v_add_u32 v12, 128, v4
    v_mul_u32_u24 v13, 43691, v12
    v_lshrrev_b32 v13, 19, v13
    v_mul_u32_u24 v14, 12, v13
    v_sub_u32 v14, v12, v14
    v_lshrrev_b32 v15, 1, v14
    v_bfe_u32 v16, v13, 3, 1
    v_sub_u32 v15, v15, v16
    v_add_u32 v16, 6, v15
    v_min_u32 v15, v15, v16
    v_lshrrev_b32 v16, 1, v15
    v_lshlrev_b32 v16, 10, v16
    v_and_b32 v15, 1, v15
    v_lshl_add_u32 v16, v15, 5, v16
    v_and_b32 v14, 1, v14
    v_lshl_add_u32 v16, v14, 4, v16
    v_mul_u32_u24 v13, 3072, v13
    v_add_u32 v23, v13, v16
    s_add_u32 s42, s29, s43
    s_and_b32 s42, s42, 7
    s_mov_b32 s41, 1
    s_lshl_b32 s30, s27, 2
    s_add_u32 s32, s30, 0
    v_xor_b32 v12, s32, v4
    v_lshrrev_b32 v13, 3, v12
    v_mul_u32_u24 v13, s41, v13
    v_add_u32 v13, s42, v13
    v_and_b32 v13, 7, v13
    v_and_b32 v12, 7, v12
    v_lshl_add_u32 v12, v13, 3, v12
    v_lshlrev_b32 v24, 4, v12
    s_add_u32 s32, s30, 1
    v_xor_b32 v12, s32, v4
    v_lshrrev_b32 v13, 3, v12
    v_mul_u32_u24 v13, s41, v13
    v_add_u32 v13, s42, v13
    v_and_b32 v13, 7, v13
    v_and_b32 v12, 7, v12
    v_lshl_add_u32 v12, v13, 3, v12
    v_lshlrev_b32 v25, 4, v12
    s_add_u32 s32, s30, 2
    v_xor_b32 v12, s32, v4
    v_lshrrev_b32 v13, 3, v12
    v_mul_u32_u24 v13, s41, v13
    v_add_u32 v13, s42, v13
    v_and_b32 v13, 7, v13
    v_and_b32 v12, 7, v12
    v_lshl_add_u32 v12, v13, 3, v12
    v_lshlrev_b32 v26, 4, v12
    s_add_u32 s32, s30, 3
    v_xor_b32 v12, s32, v4
    v_lshrrev_b32 v13, 3, v12
    v_mul_u32_u24 v13, s41, v13
    v_add_u32 v13, s42, v13
    v_and_b32 v13, 7, v13
    v_and_b32 v12, 7, v12
    v_lshl_add_u32 v12, v13, 3, v12
    v_lshlrev_b32 v27, 4, v12
    s_lshl_b32 s30, s29, 17
    s_lshl_b32 s31, s27, 15
    s_add_u32 s31, s31, s30
    s_lshl_b32 s32, s27, 12
    s_add_u32 s32, s32, s30
    s_sub_u32 s32, s32, 16384
    s_mul_i32 s33, s27, 49152
    s_lshl_b32 s34, s43, 6
    s_add_u32 s33, s33, s34
    s_lshl_b32 s35, s27, 12
    s_add_u32 s35, s35, 16384
    s_mul_i32 s36, s27, 3072
    s_add_u32 s36, s36, 32768
    s_lshl_b32 s37, s27, 12
    s_add_u32 s37, s37, 0
    s_mul_i32 s48, s41, 0
    s_add_u32 s48, s48, s42
    s_and_b32 s48, s48, 7
    s_mul_i32 s49, s41, 1
    s_add_u32 s49, s49, s42
    s_and_b32 s49, s49, 7
    s_mul_i32 s50, s41, 2
    s_add_u32 s50, s50, s42
    s_and_b32 s50, s50, 7
    s_mul_i32 s51, s41, 3
    s_add_u32 s51, s51, s42
    s_and_b32 s51, s51, 7
    s_mul_i32 s52, s41, 4
    s_add_u32 s52, s52, s42
    s_and_b32 s52, s52, 7
    s_mul_i32 s53, s41, 5
    s_add_u32 s53, s53, s42
    s_and_b32 s53, s53, 7
    s_mul_i32 s54, s41, 6
    s_add_u32 s54, s54, s42
    s_and_b32 s54, s54, 7
    s_mul_i32 s55, s41, 7
    s_add_u32 s55, s55, s42
    s_and_b32 s55, s55, 7
    s_waitcnt lgkmcnt(0)
    s_mov_b32 s4, s82
    s_and_b32 s5, s83, 0xffff
    s_mov_b32 s6, 268435456
    s_mov_b32 s7, 0x00020000
    s_mov_b32 s8, s64
    s_and_b32 s9, s65, 0xffff
    s_mov_b32 s10, 2097152
    s_mov_b32 s11, 0x00020000
    s_mov_b32 s16, s66
    s_and_b32 s17, s67, 0xffff
    s_mov_b32 s18, 1572864
    s_mov_b32 s19, 0x00020000
    s_mul_i32 s38, s48, 196608
    s_add_u32 s38, s38, s33
    s_add_u32 m0, s36, 0
    s_nop 0
    buffer_load_dwordx4 v21, s[16:19], s38 offen lds
    s_add_u32 m0, s36, 1024
    s_nop 0
    buffer_load_dwordx4 v22, s[16:19], s38 offen lds
    s_add_u32 m0, s36, 2048
    s_nop 0
    buffer_load_dwordx4 v23, s[16:19], s38 offen lds
    s_lshl_b32 s39, s48, 7
    s_add_u32 s39, s39, s31
    s_add_u32 m0, s35, 0
    s_nop 0
    buffer_load_dwordx4 v20, s[8:11], s39 offen offset:0 lds
    s_add_u32 s39, s39, 7168
    buffer_load_dwordx4 v20, s[8:11], s39 offen offset:1024 lds
    s_add_u32 s39, s39, 7168
    buffer_load_dwordx4 v20, s[8:11], s39 offen offset:2048 lds
    s_add_u32 s39, s39, 7168
    buffer_load_dwordx4 v20, s[8:11], s39 offen offset:3072 lds
    s_mov_b32 m0, s37
    s_nop 0
    buffer_load_dwordx4 v24, s[8:11], s32 offen offset:0 lds
    buffer_load_dwordx4 v25, s[8:11], s32 offen offset:1024 lds
    buffer_load_dwordx4 v26, s[8:11], s32 offen offset:2048 lds
    buffer_load_dwordx4 v27, s[8:11], s32 offen offset:3072 lds
    s_mul_i32 s38, s49, 196608
    s_add_u32 s38, s38, s33
    s_add_u32 m0, s36, 28672
    s_nop 0
    buffer_load_dwordx4 v21, s[16:19], s38 offen lds
    s_add_u32 m0, s36, 29696
    s_nop 0
    buffer_load_dwordx4 v22, s[16:19], s38 offen lds
    s_add_u32 m0, s36, 30720
    s_nop 0
    buffer_load_dwordx4 v23, s[16:19], s38 offen lds
    s_lshl_b32 s39, s49, 7
    s_add_u32 s39, s39, s31
    s_add_u32 m0, s35, 28672
    s_nop 0
    buffer_load_dwordx4 v20, s[8:11], s39 offen offset:0 lds
    s_add_u32 s39, s39, 7168
    buffer_load_dwordx4 v20, s[8:11], s39 offen offset:1024 lds
    s_add_u32 s39, s39, 7168
    buffer_load_dwordx4 v20, s[8:11], s39 offen offset:2048 lds
    s_add_u32 s39, s39, 7168
    buffer_load_dwordx4 v20, s[8:11], s39 offen offset:3072 lds
    s_lshl_b32 s40, s2, 3
    s_add_u32 s40, s40, s26
    s_mov_b32 s20, s80
    s_and_b32 s21, s81, 0xffff
    s_mov_b32 s22, 256
    s_mov_b32 s23, 0x00020000
    s_cmp_lg_u32 s40, 7
    s_cbranch_scc1 L_sequential_preLN__sliding_local_dilated__geglu_ffn__prompt_kernel_noep
    s_max_u32 s90, s90, 1
    v_mov_b32 v17, s90
    v_mov_b32 v18, 0
    s_mov_b64 exec, 1
    buffer_store_dword v17, v18, s[20:23], 0 offen sc1
    s_mov_b64 exec, -1
    s_waitcnt vmcnt(0)
L_sequential_preLN__sliding_local_dilated__geglu_ffn__prompt_kernel_noep:
    v_mov_b32 v31, 163584
    v_mov_b32 v19, 1
    s_waitcnt lgkmcnt(0)
    s_barrier
    v_mov_b32 v18, 0
    s_waitcnt vmcnt(7)
    s_mov_b64 exec, 1
    ds_add_u32 v31, v19 offset:0
    s_mov_b64 exec, -1
    s_mul_i32 s38, s50, 196608
    s_add_u32 s38, s38, s33
    s_add_u32 m0, s36, 57344
    s_nop 0
    buffer_load_dwordx4 v21, s[16:19], s38 offen lds
    s_add_u32 m0, s36, 58368
    s_nop 0
    buffer_load_dwordx4 v22, s[16:19], s38 offen lds
    s_add_u32 m0, s36, 59392
    s_nop 0
    buffer_load_dwordx4 v23, s[16:19], s38 offen lds
    s_lshl_b32 s39, s50, 7
    s_add_u32 s39, s39, s31
    s_add_u32 m0, s35, 57344
    s_nop 0
    buffer_load_dwordx4 v20, s[8:11], s39 offen offset:0 lds
    s_add_u32 s39, s39, 7168
    buffer_load_dwordx4 v20, s[8:11], s39 offen offset:1024 lds
    s_add_u32 s39, s39, 7168
    buffer_load_dwordx4 v20, s[8:11], s39 offen offset:2048 lds
    s_add_u32 s39, s39, 7168
    buffer_load_dwordx4 v20, s[8:11], s39 offen offset:3072 lds
    s_waitcnt vmcnt(7)
    s_mov_b64 exec, 1
    ds_add_u32 v31, v19 offset:4
    s_mov_b64 exec, -1
    s_mul_i32 s38, s51, 196608
    s_add_u32 s38, s38, s33
    s_add_u32 m0, s36, 86016
    s_nop 0
    buffer_load_dwordx4 v21, s[16:19], s38 offen lds
    s_add_u32 m0, s36, 87040
    s_nop 0
    buffer_load_dwordx4 v22, s[16:19], s38 offen lds
    s_add_u32 m0, s36, 88064
    s_nop 0
    buffer_load_dwordx4 v23, s[16:19], s38 offen lds
    s_lshl_b32 s39, s51, 7
    s_add_u32 s39, s39, s31
    s_add_u32 m0, s35, 86016
    s_nop 0
    buffer_load_dwordx4 v20, s[8:11], s39 offen offset:0 lds
    s_add_u32 s39, s39, 7168
    buffer_load_dwordx4 v20, s[8:11], s39 offen offset:1024 lds
    s_add_u32 s39, s39, 7168
    buffer_load_dwordx4 v20, s[8:11], s39 offen offset:2048 lds
    s_add_u32 s39, s39, 7168
    buffer_load_dwordx4 v20, s[8:11], s39 offen offset:3072 lds
    s_mul_i32 s38, s52, 196608
    s_add_u32 s38, s38, s33
    s_add_u32 m0, s36, 114688
    s_nop 0
    buffer_load_dwordx4 v21, s[16:19], s38 offen lds
    s_add_u32 m0, s36, 115712
    s_nop 0
    buffer_load_dwordx4 v22, s[16:19], s38 offen lds
    s_add_u32 m0, s36, 116736
    s_nop 0
    buffer_load_dwordx4 v23, s[16:19], s38 offen lds
    s_lshl_b32 s39, s52, 7
    s_add_u32 s39, s39, s31
    s_add_u32 m0, s35, 114688
    s_nop 0
    buffer_load_dwordx4 v20, s[8:11], s39 offen offset:0 lds
    s_add_u32 s39, s39, 7168
    buffer_load_dwordx4 v20, s[8:11], s39 offen offset:1024 lds
    s_add_u32 s39, s39, 7168
    buffer_load_dwordx4 v20, s[8:11], s39 offen offset:2048 lds
    s_add_u32 s39, s39, 7168
    buffer_load_dwordx4 v20, s[8:11], s39 offen offset:3072 lds
    s_waitcnt vmcnt(14)
    s_mov_b64 exec, 1
    ds_add_u32 v31, v19 offset:8
    s_mov_b64 exec, -1
L_sequential_preLN__sliding_local_dilated__geglu_ffn__prompt_kernel_hc0:
    ds_read_b32 v17, v31 offset:32
    s_waitcnt lgkmcnt(0)
    v_readfirstlane_b32 s40, v17
    s_nop 1
    s_cmp_lt_u32 s40, 4
    s_nop 1
    s_cbranch_scc1 L_sequential_preLN__sliding_local_dilated__geglu_ffn__prompt_kernel_hc0
    s_mul_i32 s38, s53, 196608
    s_add_u32 s38, s38, s33
    s_add_u32 m0, s36, 0
    s_nop 0
    buffer_load_dwordx4 v21, s[16:19], s38 offen lds
    s_add_u32 m0, s36, 1024
    s_nop 0
    buffer_load_dwordx4 v22, s[16:19], s38 offen lds
    s_add_u32 m0, s36, 2048
    s_nop 0
    buffer_load_dwordx4 v23, s[16:19], s38 offen lds
    s_lshl_b32 s39, s53, 7
    s_add_u32 s39, s39, s31
    s_add_u32 m0, s35, 0
    s_nop 0
    buffer_load_dwordx4 v20, s[8:11], s39 offen offset:0 lds
    s_add_u32 s39, s39, 7168
    buffer_load_dwordx4 v20, s[8:11], s39 offen offset:1024 lds
    s_add_u32 s39, s39, 7168
    buffer_load_dwordx4 v20, s[8:11], s39 offen offset:2048 lds
    s_add_u32 s39, s39, 7168
    buffer_load_dwordx4 v20, s[8:11], s39 offen offset:3072 lds
    s_waitcnt vmcnt(14)
    s_mov_b64 exec, 1
    ds_add_u32 v31, v19 offset:12
    s_mov_b64 exec, -1
L_sequential_preLN__sliding_local_dilated__geglu_ffn__prompt_kernel_hc1:
    ds_read_b32 v17, v31 offset:36
    s_waitcnt lgkmcnt(0)
    v_readfirstlane_b32 s40, v17
    s_nop 1
    s_cmp_lt_u32 s40, 4
    s_nop 1
    s_cbranch_scc1 L_sequential_preLN__sliding_local_dilated__geglu_ffn__prompt_kernel_hc1
    s_mul_i32 s38, s54, 196608
    s_add_u32 s38, s38, s33
    s_add_u32 m0, s36, 28672
    s_nop 0
    buffer_load_dwordx4 v21, s[16:19], s38 offen lds
    s_add_u32 m0, s36, 29696
    s_nop 0
    buffer_load_dwordx4 v22, s[16:19], s38 offen lds
    s_add_u32 m0, s36, 30720
    s_nop 0
    buffer_load_dwordx4 v23, s[16:19], s38 offen lds
    s_lshl_b32 s39, s54, 7
    s_add_u32 s39, s39, s31
    s_add_u32 m0, s35, 28672
    s_nop 0
    buffer_load_dwordx4 v20, s[8:11], s39 offen offset:0 lds
    s_add_u32 s39, s39, 7168
    buffer_load_dwordx4 v20, s[8:11], s39 offen offset:1024 lds
    s_add_u32 s39, s39, 7168
    buffer_load_dwordx4 v20, s[8:11], s39 offen offset:2048 lds
    s_add_u32 s39, s39, 7168
    buffer_load_dwordx4 v20, s[8:11], s39 offen offset:3072 lds
    s_waitcnt vmcnt(14)
    s_mov_b64 exec, 1
    ds_add_u32 v31, v19 offset:16
    s_mov_b64 exec, -1
L_sequential_preLN__sliding_local_dilated__geglu_ffn__prompt_kernel_hc2:
    ds_read_b32 v17, v31 offset:40
    s_waitcnt lgkmcnt(0)
    v_readfirstlane_b32 s40, v17
    s_nop 1
    s_cmp_lt_u32 s40, 4
    s_nop 1
    s_cbranch_scc1 L_sequential_preLN__sliding_local_dilated__geglu_ffn__prompt_kernel_hc2
    s_mul_i32 s38, s55, 196608
    s_add_u32 s38, s38, s33
    s_add_u32 m0, s36, 57344
    s_nop 0
    buffer_load_dwordx4 v21, s[16:19], s38 offen lds
    s_add_u32 m0, s36, 58368
    s_nop 0
    buffer_load_dwordx4 v22, s[16:19], s38 offen lds
    s_add_u32 m0, s36, 59392
    s_nop 0
    buffer_load_dwordx4 v23, s[16:19], s38 offen lds
    s_lshl_b32 s39, s55, 7
    s_add_u32 s39, s39, s31
    s_add_u32 m0, s35, 57344
    s_nop 0
    buffer_load_dwordx4 v20, s[8:11], s39 offen offset:0 lds
    s_add_u32 s39, s39, 7168
    buffer_load_dwordx4 v20, s[8:11], s39 offen offset:1024 lds
    s_add_u32 s39, s39, 7168
    buffer_load_dwordx4 v20, s[8:11], s39 offen offset:2048 lds
    s_add_u32 s39, s39, 7168
    buffer_load_dwordx4 v20, s[8:11], s39 offen offset:3072 lds
    s_waitcnt vmcnt(14)
    s_mov_b64 exec, 1
    ds_add_u32 v31, v19 offset:20
    s_mov_b64 exec, -1
    s_waitcnt vmcnt(7)
    s_mov_b64 exec, 1
    ds_add_u32 v31, v19 offset:24
    s_mov_b64 exec, -1
    s_waitcnt vmcnt(0)
    s_mov_b64 exec, 1
    ds_add_u32 v31, v19 offset:28
    s_mov_b64 exec, -1
    s_lshl_b32 s40, s25, 8
    s_or_b32 s40, s40, s24
    s_and_b32 s24, s40, 7
    s_bfe_u32 s25, s40, 0x50008
    s_lshr_b32 s28, s25, 3
    s_and_b32 s93, s25, 7
    s_lshl_b32 s92, s24, 2
    s_add_u32 s92, s92, s28
    s_and_b32 s94, s24, 4
    s_add_u32 s94, s94, s28
    s_and_b32 s95, s24, 3
    s_lshl_b32 s95, s95, 3
    s_add_u32 s95, s95, s93
    v_and_b32 v7, 7, v4
    v_lshlrev_b32 v8, 1, v5
    v_xor_b32 v7, v7, v8
    v_lshrrev_b32 v8, 3, v4
    v_lshlrev_b32 v9, 10, v8
    v_lshl_add_u32 v28, v7, 4, v9
    v_mul_u32_u24 v9, 3584, v8
    v_lshl_add_u32 v29, v7, 4, v9
    s_lshl_b32 s44, s27, 13
    s_lshl_b32 s45, s93, 7
    s_add_u32 s44, s44, s45
    s_mul_i32 s45, s27, 28672
    s_mul_i32 s46, s95, 112
    s_add_u32 s45, s45, s46
    s_lshl_b32 s46, s27, 10
    s_mov_b32 s12, s68
    s_and_b32 s13, s69, 0xffff
    s_mov_b32 s14, 524288
    s_mov_b32 s15, 0x00020000
    s_cmp_lt_u32 s27, 2
    s_cselect_b32 s56, s72, s74
    s_cselect_b32 s57, s73, s75
    s_and_b32 s57, s57, 0xffff
    s_mov_b32 s58, 1835008
    s_mov_b32 s59, 0x00020000
    s_lshl_b32 s60, s25, 4
    s_and_b32 s61, s27, 1
    s_lshl_b32 s61, s61, 3
    s_add_u32 s60, s60, s61
    s_mul_i32 s60, s60, 3584
    s_and_b32 s61, s24, 3
    s_mul_i32 s61, s61, 896
    s_add_u32 s60, s60, s61
    s_lshl_b32 s61, s25, 14
    s_lshl_b32 s47, s27, 12
    s_add_u32 s61, s61, s47
    buffer_load_dwordx4 v[64:67], v1, s[12:15], s61 offen offset:0
    buffer_load_dwordx4 v[68:71], v1, s[12:15], s61 offen offset:1024
    buffer_load_dwordx4 v[72:75], v1, s[12:15], s61 offen offset:2048
    buffer_load_dwordx4 v[76:79], v1, s[12:15], s61 offen offset:3072
    s_add_u32 s47, s60, 0
    buffer_load_dwordx4 v[80:83], v1, s[56:59], s47 offen
    s_add_u32 s47, s60, 3584
    buffer_load_dwordx4 v[84:87], v1, s[56:59], s47 offen
    s_add_u32 s47, s60, 7168
    buffer_load_dwordx4 v[88:91], v1, s[56:59], s47 offen
    s_add_u32 s47, s60, 10752
    buffer_load_dwordx4 v[92:95], v1, s[56:59], s47 offen
    s_add_u32 s47, s60, 14336
    buffer_load_dwordx4 v[96:99], v1, s[56:59], s47 offen
    s_add_u32 s47, s60, 17920
    buffer_load_dwordx4 v[100:103], v1, s[56:59], s47 offen
    s_add_u32 s47, s60, 21504
    buffer_load_dwordx4 v[104:107], v1, s[56:59], s47 offen
    s_add_u32 s47, s60, 25088
    buffer_load_dwordx4 v[108:111], v1, s[56:59], s47 offen
    v_mov_b32 v18, 0
    buffer_load_dword v30, v18, s[20:23], 0 offen sc1
    s_mov_b32 s16, s72
    s_and_b32 s17, s73, 0xffff
    s_mov_b32 s18, 1835008
    s_mov_b32 s19, 0x00020000
    s_barrier
    s_add_u32 m0, s46, 0
    s_add_u32 s47, s44, 0
    buffer_load_dwordx4 v28, s[12:15], s47 offen lds
    s_add_u32 m0, s46, 4096
    s_add_u32 s47, s44, 32768
    buffer_load_dwordx4 v28, s[12:15], s47 offen lds
    s_add_u32 m0, s46, 8192
    s_add_u32 s47, s44, 65536
    buffer_load_dwordx4 v28, s[12:15], s47 offen lds
    s_add_u32 m0, s46, 12288
    s_add_u32 s47, s44, 98304
    buffer_load_dwordx4 v28, s[12:15], s47 offen lds
    s_add_u32 m0, s46, 16384
    s_add_u32 s47, s44, 131072
    buffer_load_dwordx4 v28, s[12:15], s47 offen lds
    s_add_u32 m0, s46, 20480
    s_add_u32 s47, s44, 163840
    buffer_load_dwordx4 v28, s[12:15], s47 offen lds
    s_add_u32 m0, s46, 24576
    s_add_u32 s47, s44, 196608
    buffer_load_dwordx4 v28, s[12:15], s47 offen lds
    s_add_u32 m0, s46, 28672
    s_add_u32 s47, s44, 229376
    buffer_load_dwordx4 v28, s[12:15], s47 offen lds
    s_add_u32 m0, s46, 32768
    s_add_u32 s47, s44, 262144
    buffer_load_dwordx4 v28, s[12:15], s47 offen lds
    s_add_u32 m0, s46, 36864
    s_add_u32 s47, s44, 294912
    buffer_load_dwordx4 v28, s[12:15], s47 offen lds
    s_add_u32 m0, s46, 40960
    s_add_u32 s47, s44, 327680
    buffer_load_dwordx4 v28, s[12:15], s47 offen lds
    s_add_u32 m0, s46, 45056
    s_add_u32 s47, s44, 360448
    buffer_load_dwordx4 v28, s[12:15], s47 offen lds
    s_add_u32 m0, s46, 49152
    s_add_u32 s47, s44, 393216
    buffer_load_dwordx4 v28, s[12:15], s47 offen lds
    s_add_u32 m0, s46, 53248
    s_add_u32 s47, s44, 425984
    buffer_load_dwordx4 v28, s[12:15], s47 offen lds
    s_add_u32 m0, s46, 57344
    s_add_u32 s47, s44, 458752
    buffer_load_dwordx4 v28, s[12:15], s47 offen lds
    s_add_u32 m0, s46, 61440
    s_add_u32 s47, s44, 491520
    buffer_load_dwordx4 v28, s[12:15], s47 offen lds
    s_add_u32 m0, s46, 65552
    s_add_u32 s47, s45, 0
    buffer_load_dwordx4 v29, s[16:19], s47 offen lds
    s_add_u32 m0, s46, 69648
    s_add_u32 s47, s45, 114688
    buffer_load_dwordx4 v29, s[16:19], s47 offen lds
    s_add_u32 m0, s46, 73744
    s_add_u32 s47, s45, 229376
    buffer_load_dwordx4 v29, s[16:19], s47 offen lds
    s_add_u32 m0, s46, 77840
    s_add_u32 s47, s45, 344064
    buffer_load_dwordx4 v29, s[16:19], s47 offen lds
    s_add_u32 m0, s46, 81936
    s_add_u32 s47, s45, 458752
    buffer_load_dwordx4 v29, s[16:19], s47 offen lds
    s_add_u32 m0, s46, 86032
    s_add_u32 s47, s45, 573440
    buffer_load_dwordx4 v29, s[16:19], s47 offen lds
    s_add_u32 m0, s46, 90128
    s_add_u32 s47, s45, 688128
    buffer_load_dwordx4 v29, s[16:19], s47 offen lds
    s_add_u32 m0, s46, 94224
    s_add_u32 s47, s45, 802816
    buffer_load_dwordx4 v29, s[16:19], s47 offen lds
    s_add_u32 m0, s46, 98320
    s_add_u32 s47, s45, 917504
    buffer_load_dwordx4 v29, s[16:19], s47 offen lds
    s_add_u32 m0, s46, 102416
    s_add_u32 s47, s45, 1032192
    buffer_load_dwordx4 v29, s[16:19], s47 offen lds
    s_add_u32 m0, s46, 106512
    s_add_u32 s47, s45, 1146880
    buffer_load_dwordx4 v29, s[16:19], s47 offen lds
    s_add_u32 m0, s46, 110608
    s_add_u32 s47, s45, 1261568
    buffer_load_dwordx4 v29, s[16:19], s47 offen lds
    s_add_u32 m0, s46, 114704
    s_add_u32 s47, s45, 1376256
    buffer_load_dwordx4 v29, s[16:19], s47 offen lds
    s_add_u32 m0, s46, 118800
    s_add_u32 s47, s45, 1490944
    buffer_load_dwordx4 v29, s[16:19], s47 offen lds
    s_add_u32 m0, s46, 122896
    s_add_u32 s47, s45, 1605632
    buffer_load_dwordx4 v29, s[16:19], s47 offen lds
    s_add_u32 m0, s46, 126992
    s_add_u32 s47, s45, 1720320
    buffer_load_dwordx4 v29, s[16:19], s47 offen lds
    s_waitcnt vmcnt(16)
    v_readfirstlane_b32 s88, v30
    s_nop 1
    s_cmp_lg_u32 s88, 0
    s_nop 1
    s_cbranch_scc1 L_sequential_preLN__sliding_local_dilated__geglu_ffn__prompt_kernel_epx
    s_mov_b32 s40, 0
L_sequential_preLN__sliding_local_dilated__geglu_ffn__prompt_kernel_ep:
    buffer_load_dword v30, v18, s[20:23], 0 offen sc1
    s_add_u32 s40, s40, 1
    s_waitcnt vmcnt(0)
    v_readfirstlane_b32 s88, v30
    s_cmp_gt_u32 s40, 0x40000
    s_nop 3
    s_cbranch_scc1 L_sequential_preLN__sliding_local_dilated__geglu_ffn__prompt_kernel_epx
    s_cmp_eq_u32 s88, 0
    s_cbranch_scc1 L_sequential_preLN__sliding_local_dilated__geglu_ffn__prompt_kernel_ep
L_sequential_preLN__sliding_local_dilated__geglu_ffn__prompt_kernel_epx:
    s_lshl_b32 s89, s29, 4
    s_add_u32 s89, s89, s43
    s_mov_b32 s12, s74
    s_and_b32 s13, s75, 0xffff
    s_mov_b32 s14, 1835008
    s_mov_b32 s15, 0x00020000
    s_barrier
    s_cmp_lg_u32 s26, 4
    s_cbranch_scc1 L_sequential_preLN__sliding_local_dilated__geglu_ffn__prompt_kernel_sig1
    s_lshl_b32 s40, s89, 7
    s_add_u32 s40, s40, 13631488
    v_mov_b32 v8, s88
    v_mov_b32 v9, 0
    s_mov_b64 exec, 1
    buffer_store_dword v8, v9, s[4:7], s40 offen sc1
    s_mov_b64 exec, -1
L_sequential_preLN__sliding_local_dilated__geglu_ffn__prompt_kernel_sig1:
    s_barrier
    s_cmp_eq_u32 s26, 4
    s_cbranch_scc1 L_sequential_preLN__sliding_local_dilated__geglu_ffn__prompt_kernel_noups
    s_sub_u32 s37, s45, 28672
    s_sub_u32 s38, s46, 1024
    s_add_u32 m0, s38, 0
    s_add_u32 s47, s37, 0
    buffer_load_dwordx4 v29, s[12:15], s47 offen lds
    s_add_u32 m0, s38, 3072
    s_add_u32 s47, s37, 86016
    buffer_load_dwordx4 v29, s[12:15], s47 offen lds
    s_add_u32 m0, s38, 6144
    s_add_u32 s47, s37, 172032
    buffer_load_dwordx4 v29, s[12:15], s47 offen lds
    s_add_u32 m0, s38, 9216
    s_add_u32 s47, s37, 258048
    buffer_load_dwordx4 v29, s[12:15], s47 offen lds
    s_add_u32 m0, s38, 12288
    s_add_u32 s47, s37, 344064
    buffer_load_dwordx4 v29, s[12:15], s47 offen lds
    s_add_u32 m0, s38, 15360
    s_add_u32 s47, s37, 430080
    buffer_load_dwordx4 v29, s[12:15], s47 offen lds
    s_add_u32 m0, s38, 18432
    s_add_u32 s47, s37, 516096
    buffer_load_dwordx4 v29, s[12:15], s47 offen lds
    s_add_u32 m0, s38, 21504
    s_add_u32 s47, s37, 602112
    buffer_load_dwordx4 v29, s[12:15], s47 offen lds
    s_add_u32 m0, s38, 24576
    s_add_u32 s47, s37, 688128
    buffer_load_dwordx4 v29, s[12:15], s47 offen lds
    s_add_u32 m0, s38, 27648
    s_add_u32 s47, s37, 774144
    buffer_load_dwordx4 v29, s[12:15], s47 offen lds
    s_add_u32 m0, s38, 30720
    s_add_u32 s47, s37, 860160
    buffer_load_dwordx4 v29, s[12:15], s47 offen lds
    s_add_u32 m0, s38, 33792
    s_add_u32 s47, s37, 946176
    buffer_load_dwordx4 v29, s[12:15], s47 offen lds
    s_add_u32 m0, s38, 36864
    s_add_u32 s47, s37, 1032192
    buffer_load_dwordx4 v29, s[12:15], s47 offen lds
    s_add_u32 m0, s38, 39936
    s_add_u32 s47, s37, 1118208
    buffer_load_dwordx4 v29, s[12:15], s47 offen lds
    s_add_u32 m0, s38, 43008
    s_add_u32 s47, s37, 1204224
    buffer_load_dwordx4 v29, s[12:15], s47 offen lds
    s_add_u32 m0, s38, 46080
    s_add_u32 s47, s37, 1290240
    buffer_load_dwordx4 v29, s[12:15], s47 offen lds
    s_add_u32 m0, s38, 49152
    s_add_u32 s47, s37, 1376256
    buffer_load_dwordx4 v29, s[12:15], s47 offen lds
    s_add_u32 m0, s38, 52224
    s_add_u32 s47, s37, 1462272
    buffer_load_dwordx4 v29, s[12:15], s47 offen lds
    s_add_u32 m0, s38, 55296
    s_add_u32 s47, s37, 1548288
    buffer_load_dwordx4 v29, s[12:15], s47 offen lds
    s_add_u32 m0, s38, 58368
    s_add_u32 s47, s37, 1634304
    buffer_load_dwordx4 v29, s[12:15], s47 offen lds
    s_add_u32 m0, s38, 61440
    s_add_u32 s47, s37, 1720320
    buffer_load_dwordx4 v29, s[12:15], s47 offen lds
    s_cmp_lg_u32 s26, 5
    s_cbranch_scc1 L_sequential_preLN__sliding_local_dilated__geglu_ffn__prompt_kernel_noups
    s_add_u32 m0, s38, 64512
    s_add_u32 s47, s37, 1806336
    buffer_load_dwordx4 v29, s[12:15], s47 offen lds
L_sequential_preLN__sliding_local_dilated__geglu_ffn__prompt_kernel_noups:
    s_lshr_b32 s89, s92, 1
    s_lshl_b32 s89, s89, 4
    s_cmp_lg_u32 s26, 4
    s_cbranch_scc1 L_sequential_preLN__sliding_local_dilated__geglu_ffn__prompt_kernel_wt1
    s_mov_b32 s40, 0
    v_lshlrev_b32 v8, 7, v4
    s_lshl_b32 s41, s89, 7
    s_add_u32 s41, s41, 13631488
    s_mov_b64 exec, 0xffff
L_sequential_preLN__sliding_local_dilated__geglu_ffn__prompt_kernel_pl1:
    s_sleep 8
    buffer_load_dword v9, v8, s[4:7], s41 offen sc1
    s_add_u32 s40, s40, 1
    s_waitcnt vmcnt(0)
    v_cmp_ne_u32 vcc, s88, v9
    s_nop 4
    s_cbranch_vccz L_sequential_preLN__sliding_local_dilated__geglu_ffn__prompt_kernel_px1
    s_mov_b64 exec, vcc
    s_cmp_gt_u32 s40, 0x40000
    s_cbranch_scc1 L_sequential_preLN__sliding_local_dilated__geglu_ffn__prompt_kernel_px1
    s_cbranch_vccnz L_sequential_preLN__sliding_local_dilated__geglu_ffn__prompt_kernel_pl1
L_sequential_preLN__sliding_local_dilated__geglu_ffn__prompt_kernel_px1:
    s_mov_b64 exec, 1
    ds_write_b32 v31, v19 offset:68
    s_mov_b64 exec, -1
L_sequential_preLN__sliding_local_dilated__geglu_ffn__prompt_kernel_wt1:
    s_waitcnt vmcnt(0)
    s_barrier
    s_mov_b32 s12, s76
    s_and_b32 s13, s77, 0xffff
    s_mov_b32 s14, 1835008
    s_mov_b32 s15, 0x00020000
    v_lshrrev_b32 v12, 3, v4
    v_and_b32 v13, 7, v4
    v_and_b32 v14, 1, v5
    v_lshlrev_b32 v14, 1, v14
    s_and_b32 s44, s27, 1
    s_lshl_b32 s44, s44, 2
    v_xor_b32 v13, v13, v14
    v_xor_b32 v13, s44, v13
    v_lshlrev_b32 v13, 4, v13
    v_lshrrev_b32 v14, 2, v12
    v_lshl_add_u32 v36, v12, 10, v13
    v_lshl_add_u32 v34, v14, 12, v36
    v_mul_u32_u24 v14, 12288, v14
    v_add_u32 v32, v14, v36
    v_xor_b32 v33, 64, v32
    v_xor_b32 v35, 64, v34
    v_xor_b32 v37, 64, v36
    s_lshl_b32 s45, s93, 7
    s_mul_i32 s46, s27, 57344
    s_add_u32 s45, s45, s46
    s_mul_i32 s46, s27, 7168
    s_lshl_b32 s89, s92, 3
    s_add_u32 s89, s89, s93
    s_barrier
    s_cmp_lg_u32 s26, 4
    s_cbranch_scc1 L_sequential_preLN__sliding_local_dilated__geglu_ffn__prompt_kernel_sig2
    s_lshl_b32 s40, s89, 7
    s_add_u32 s40, s40, 13664256
    v_mov_b32 v8, s88
    v_mov_b32 v9, 0
    s_mov_b64 exec, 1
    buffer_store_dword v8, v9, s[4:7], s40 offen sc1
    s_mov_b64 exec, -1
L_sequential_preLN__sliding_local_dilated__geglu_ffn__prompt_kernel_sig2:
    s_lshl_b32 s89, s94, 5
    s_cmp_lg_u32 s26, 4
    s_cbranch_scc1 L_sequential_preLN__sliding_local_dilated__geglu_ffn__prompt_kernel_wt2
    s_mov_b32 s40, 0
    v_lshlrev_b32 v8, 7, v4
    s_lshl_b32 s41, s89, 7
    s_add_u32 s41, s41, 13664256
    s_mov_b64 exec, 0xffffffff
L_sequential_preLN__sliding_local_dilated__geglu_ffn__prompt_kernel_pl2:
    s_sleep 8
    buffer_load_dword v9, v8, s[4:7], s41 offen sc1
    s_add_u32 s40, s40, 1
    s_waitcnt vmcnt(0)
    v_cmp_ne_u32 vcc, s88, v9
    s_nop 4
    s_cbranch_vccz L_sequential_preLN__sliding_local_dilated__geglu_ffn__prompt_kernel_px2
    s_mov_b64 exec, vcc
    s_cmp_gt_u32 s40, 0x40000
    s_cbranch_scc1 L_sequential_preLN__sliding_local_dilated__geglu_ffn__prompt_kernel_px2
    s_cbranch_vccnz L_sequential_preLN__sliding_local_dilated__geglu_ffn__prompt_kernel_pl2
L_sequential_preLN__sliding_local_dilated__geglu_ffn__prompt_kernel_px2:
    s_mov_b64 exec, 1
    ds_write_b32 v31, v19 offset:72
    s_mov_b64 exec, -1
L_sequential_preLN__sliding_local_dilated__geglu_ffn__prompt_kernel_wt2:
L_sequential_preLN__sliding_local_dilated__geglu_ffn__prompt_kernel_hf2:
    ds_read_b32 v17, v31 offset:72
    s_waitcnt lgkmcnt(0)
    v_readfirstlane_b32 s40, v17
    s_nop 1
    s_cmp_lt_u32 s40, 1
    s_nop 1
    s_cbranch_scc1 L_sequential_preLN__sliding_local_dilated__geglu_ffn__prompt_kernel_hf2
    s_lshl_b32 s40, s94, 18
    s_lshl_b32 s41, s27, 16
    s_add_u32 s40, s40, s41
    s_lshl_b32 s41, s93, 11
    s_add_u32 s40, s40, s41
    s_add_u32 s40, s40, 2097152
    s_add_u32 s41, s40, 0
    buffer_load_dwordx4 v[128:131], v1, s[4:7], s41 offen offset:0 sc1
    s_add_u32 s41, s40, 0
    buffer_load_dwordx4 v[132:135], v1, s[4:7], s41 offen offset:1024 sc1
    s_add_u32 s41, s40, 16384
    buffer_load_dwordx4 v[136:139], v1, s[4:7], s41 offen offset:0 sc1
    s_add_u32 s41, s40, 16384
    buffer_load_dwordx4 v[140:143], v1, s[4:7], s41 offen offset:1024 sc1
    s_add_u32 s41, s40, 32768
    buffer_load_dwordx4 v[144:147], v1, s[4:7], s41 offen offset:0 sc1
    s_add_u32 s41, s40, 32768
    buffer_load_dwordx4 v[148:151], v1, s[4:7], s41 offen offset:1024 sc1
    s_add_u32 s41, s40, 49152
    buffer_load_dwordx4 v[152:155], v1, s[4:7], s41 offen offset:0 sc1
    s_add_u32 s41, s40, 49152
    buffer_load_dwordx4 v[156:159], v1, s[4:7], s41 offen offset:1024 sc1
    s_sleep 32
    s_mul_i32 s40, s25, 57344
    s_mul_i32 s41, s27, 14336
    s_add_u32 s40, s40, s41
    s_add_u32 s41, s40, 0
    buffer_load_dwordx4 v[64:67], v1, s[12:15], s41 offen
    s_sleep 4
    s_add_u32 s41, s40, 1024
    buffer_load_dwordx4 v[68:71], v1, s[12:15], s41 offen
    s_sleep 4
    s_add_u32 s41, s40, 2048
    buffer_load_dwordx4 v[72:75], v1, s[12:15], s41 offen
    s_sleep 4
    s_add_u32 s41, s40, 3072
    buffer_load_dwordx4 v[76:79], v1, s[12:15], s41 offen
    s_sleep 4
    s_add_u32 s41, s40, 4096
    buffer_load_dwordx4 v[80:83], v1, s[12:15], s41 offen
    s_sleep 4
    s_add_u32 s41, s40, 5120
    buffer_load_dwordx4 v[84:87], v1, s[12:15], s41 offen
    s_sleep 4
    s_add_u32 s41, s40, 6144
    buffer_load_dwordx4 v[88:91], v1, s[12:15], s41 offen
    s_sleep 4
    s_add_u32 s41, s40, 7168
    buffer_load_dwordx4 v[92:95], v1, s[12:15], s41 offen
    s_sleep 4
    s_add_u32 s41, s40, 8192
    buffer_load_dwordx4 v[96:99], v1, s[12:15], s41 offen
    s_sleep 4
    s_add_u32 s41, s40, 9216
    buffer_load_dwordx4 v[100:103], v1, s[12:15], s41 offen
    s_sleep 4
    s_add_u32 s41, s40, 10240
    buffer_load_dwordx4 v[104:107], v1, s[12:15], s41 offen
    s_sleep 4
    s_add_u32 s41, s40, 11264
    buffer_load_dwordx4 v[108:111], v1, s[12:15], s41 offen
    s_sleep 4
    s_add_u32 s41, s40, 12288
    buffer_load_dwordx4 v[112:115], v1, s[12:15], s41 offen
    s_sleep 4
    s_add_u32 s41, s40, 13312
    buffer_load_dwordx4 v[116:119], v1, s[12:15], s41 offen
    s_sleep 4
    s_lshl_b32 s89, s94, 5
    s_add_u32 s89, s89, s95
    s_barrier
    s_add_u32 m0, s46, 0
    s_add_u32 s47, s45, 0
    buffer_load_dwordx4 v32, s[12:15], s47 offen lds
    s_add_u32 m0, s46, 1024
    s_add_u32 s47, s45, 4096
    buffer_load_dwordx4 v33, s[12:15], s47 offen lds
    s_add_u32 m0, s46, 2048
    s_add_u32 s47, s45, 8192
    buffer_load_dwordx4 v32, s[12:15], s47 offen lds
    s_add_u32 m0, s46, 3072
    s_add_u32 s47, s45, 12288
    buffer_load_dwordx4 v33, s[12:15], s47 offen lds
    s_add_u32 m0, s46, 4096
    s_add_u32 s47, s45, 32768
    buffer_load_dwordx4 v34, s[12:15], s47 offen lds
    s_add_u32 m0, s46, 5120
    s_add_u32 s47, s45, 36864
    buffer_load_dwordx4 v35, s[12:15], s47 offen lds
    s_add_u32 m0, s46, 6144
    s_add_u32 s47, s45, 49152
    buffer_load_dwordx4 v36, s[12:15], s47 offen lds
    s_add_u32 m0, s46, 28672
    s_add_u32 s47, s45, 229376
    buffer_load_dwordx4 v32, s[12:15], s47 offen lds
    s_add_u32 m0, s46, 29696
    s_add_u32 s47, s45, 233472
    buffer_load_dwordx4 v33, s[12:15], s47 offen lds
    s_add_u32 m0, s46, 30720
    s_add_u32 s47, s45, 237568
    buffer_load_dwordx4 v32, s[12:15], s47 offen lds
    s_add_u32 m0, s46, 31744
    s_add_u32 s47, s45, 241664
    buffer_load_dwordx4 v33, s[12:15], s47 offen lds
    s_add_u32 m0, s46, 32768
    s_add_u32 s47, s45, 262144
    buffer_load_dwordx4 v34, s[12:15], s47 offen lds
    s_add_u32 m0, s46, 33792
    s_add_u32 s47, s45, 266240
    buffer_load_dwordx4 v35, s[12:15], s47 offen lds
    s_add_u32 m0, s46, 34816
    s_add_u32 s47, s45, 278528
    buffer_load_dwordx4 v36, s[12:15], s47 offen lds
    s_add_u32 m0, s46, 57344
    s_add_u32 s47, s45, 458752
    buffer_load_dwordx4 v32, s[12:15], s47 offen lds
    s_add_u32 m0, s46, 58368
    s_add_u32 s47, s45, 462848
    buffer_load_dwordx4 v33, s[12:15], s47 offen lds
    s_add_u32 m0, s46, 59392
    s_add_u32 s47, s45, 466944
    buffer_load_dwordx4 v32, s[12:15], s47 offen lds
    s_add_u32 m0, s46, 60416
    s_add_u32 s47, s45, 471040
    buffer_load_dwordx4 v33, s[12:15], s47 offen lds
    s_add_u32 m0, s46, 61440
    s_add_u32 s47, s45, 491520
    buffer_load_dwordx4 v34, s[12:15], s47 offen lds
    s_add_u32 m0, s46, 62464
    s_add_u32 s47, s45, 495616
    buffer_load_dwordx4 v35, s[12:15], s47 offen lds
    s_add_u32 m0, s46, 63488
    s_add_u32 s47, s45, 507904
    buffer_load_dwordx4 v36, s[12:15], s47 offen lds
    s_add_u32 m0, s46, 86016
    s_add_u32 s47, s45, 688128
    buffer_load_dwordx4 v32, s[12:15], s47 offen lds
    s_add_u32 m0, s46, 87040
    s_add_u32 s47, s45, 692224
    buffer_load_dwordx4 v33, s[12:15], s47 offen lds
    s_add_u32 m0, s46, 88064
    s_add_u32 s47, s45, 696320
    buffer_load_dwordx4 v32, s[12:15], s47 offen lds
    s_add_u32 m0, s46, 89088
    s_add_u32 s47, s45, 700416
    buffer_load_dwordx4 v33, s[12:15], s47 offen lds
    s_add_u32 m0, s46, 90112
    s_add_u32 s47, s45, 720896
    buffer_load_dwordx4 v34, s[12:15], s47 offen lds
    s_add_u32 m0, s46, 91136
    s_add_u32 s47, s45, 724992
    buffer_load_dwordx4 v35, s[12:15], s47 offen lds
    s_add_u32 m0, s46, 92160
    s_add_u32 s47, s45, 737280
    buffer_load_dwordx4 v36, s[12:15], s47 offen lds
    s_add_u32 m0, s46, 114688
    s_add_u32 s47, s45, 917504
    buffer_load_dwordx4 v32, s[12:15], s47 offen lds
    s_add_u32 m0, s46, 115712
    s_add_u32 s47, s45, 921600
    buffer_load_dwordx4 v33, s[12:15], s47 offen lds
    s_add_u32 m0, s46, 116736
    s_add_u32 s47, s45, 925696
    buffer_load_dwordx4 v32, s[12:15], s47 offen lds
    s_add_u32 m0, s46, 117760
    s_add_u32 s47, s45, 929792
    buffer_load_dwordx4 v33, s[12:15], s47 offen lds
    s_add_u32 m0, s46, 118784
    s_add_u32 s47, s45, 950272
    buffer_load_dwordx4 v34, s[12:15], s47 offen lds
    s_add_u32 m0, s46, 119808
    s_add_u32 s47, s45, 954368
    buffer_load_dwordx4 v35, s[12:15], s47 offen lds
    s_add_u32 m0, s46, 120832
    s_add_u32 s47, s45, 966656
    buffer_load_dwordx4 v36, s[12:15], s47 offen lds
    s_waitcnt vmcnt(14)
    s_barrier
    s_cmp_lg_u32 s26, 4
    s_cbranch_scc1 L_sequential_preLN__sliding_local_dilated__geglu_ffn__prompt_kernel_sig3
    s_lshl_b32 s40, s89, 7
    s_add_u32 s40, s40, 13697024
    v_mov_b32 v8, s88
    v_mov_b32 v9, 0
    s_mov_b64 exec, 1
    buffer_store_dword v8, v9, s[4:7], s40 offen sc1
    s_mov_b64 exec, -1
L_sequential_preLN__sliding_local_dilated__geglu_ffn__prompt_kernel_sig3:
    s_waitcnt vmcnt(0)
    s_barrier
    s_cmp_eq_u32 s26, 4
    s_cbranch_scc1 L_sequential_preLN__sliding_local_dilated__geglu_ffn__prompt_kernel_nolate
    s_add_u32 s48, s46, 136192
    s_sub_u32 s49, s48, 163840
    s_min_u32 m0, s48, s49
    s_add_u32 s47, s45, 1089536
    buffer_load_dwordx4 v33, s[12:15], s47 offen lds
    s_add_u32 s48, s46, 137216
    s_sub_u32 s49, s48, 163840
    s_min_u32 m0, s48, s49
    s_add_u32 s47, s45, 1093632
    buffer_load_dwordx4 v32, s[12:15], s47 offen lds
    s_add_u32 s48, s46, 138240
    s_sub_u32 s49, s48, 163840
    s_min_u32 m0, s48, s49
    s_add_u32 s47, s45, 1097728
    buffer_load_dwordx4 v33, s[12:15], s47 offen lds
    s_add_u32 s48, s46, 139264
    s_sub_u32 s49, s48, 163840
    s_min_u32 m0, s48, s49
    s_add_u32 s47, s45, 1101824
    buffer_load_dwordx4 v32, s[12:15], s47 offen lds
    s_add_u32 s48, s46, 140288
    s_sub_u32 s49, s48, 163840
    s_min_u32 m0, s48, s49
    s_add_u32 s47, s45, 1122304
    buffer_load_dwordx4 v35, s[12:15], s47 offen lds
    s_add_u32 s48, s46, 141312
    s_sub_u32 s49, s48, 163840
    s_min_u32 m0, s48, s49
    s_add_u32 s47, s45, 1126400
    buffer_load_dwordx4 v34, s[12:15], s47 offen lds
    s_add_u32 s48, s46, 142336
    s_sub_u32 s49, s48, 163840
    s_min_u32 m0, s48, s49
    s_add_u32 s47, s45, 1138688
    buffer_load_dwordx4 v37, s[12:15], s47 offen lds
    s_add_u32 m0, s46, -6144
    s_add_u32 s47, s45, 1261568
    buffer_load_dwordx4 v32, s[12:15], s47 offen lds
    s_add_u32 m0, s46, -5120
    s_add_u32 s47, s45, 1265664
    buffer_load_dwordx4 v33, s[12:15], s47 offen lds
    s_add_u32 m0, s46, -4096
    s_add_u32 s47, s45, 1269760
    buffer_load_dwordx4 v32, s[12:15], s47 offen lds
    s_add_u32 m0, s46, -3072
    s_add_u32 s47, s45, 1273856
    buffer_load_dwordx4 v33, s[12:15], s47 offen lds
    s_add_u32 m0, s46, -2048
    s_add_u32 s47, s45, 1294336
    buffer_load_dwordx4 v34, s[12:15], s47 offen lds
    s_add_u32 m0, s46, -1024
    s_add_u32 s47, s45, 1298432
    buffer_load_dwordx4 v35, s[12:15], s47 offen lds
    s_add_u32 m0, s46, 0
    s_add_u32 s47, s45, 1310720
    buffer_load_dwordx4 v36, s[12:15], s47 offen lds
    s_add_u32 m0, s46, 15360
    s_add_u32 s47, s45, 1433600
    buffer_load_dwordx4 v33, s[12:15], s47 offen lds
    s_add_u32 m0, s46, 16384
    s_add_u32 s47, s45, 1437696
    buffer_load_dwordx4 v32, s[12:15], s47 offen lds
    s_add_u32 m0, s46, 17408
    s_add_u32 s47, s45, 1441792
    buffer_load_dwordx4 v33, s[12:15], s47 offen lds
    s_add_u32 m0, s46, 18432
    s_add_u32 s47, s45, 1445888
    buffer_load_dwordx4 v32, s[12:15], s47 offen lds
    s_add_u32 m0, s46, 19456
    s_add_u32 s47, s45, 1466368
    buffer_load_dwordx4 v35, s[12:15], s47 offen lds
    s_add_u32 m0, s46, 20480
    s_add_u32 s47, s45, 1470464
    buffer_load_dwordx4 v34, s[12:15], s47 offen lds
    s_add_u32 m0, s46, 21504
    s_add_u32 s47, s45, 1482752
    buffer_load_dwordx4 v37, s[12:15], s47 offen lds
    s_add_u32 m0, s46, 36864
    s_add_u32 s47, s45, 1605632
    buffer_load_dwordx4 v32, s[12:15], s47 offen lds
    s_add_u32 m0, s46, 37888
    s_add_u32 s47, s45, 1609728
    buffer_load_dwordx4 v33, s[12:15], s47 offen lds
    s_add_u32 m0, s46, 38912
    s_add_u32 s47, s45, 1613824
    buffer_load_dwordx4 v32, s[12:15], s47 offen lds
    s_add_u32 m0, s46, 39936
    s_add_u32 s47, s45, 1617920
    buffer_load_dwordx4 v33, s[12:15], s47 offen lds
    s_add_u32 m0, s46, 40960
    s_add_u32 s47, s45, 1638400
    buffer_load_dwordx4 v34, s[12:15], s47 offen lds
    s_add_u32 m0, s46, 41984
    s_add_u32 s47, s45, 1642496
    buffer_load_dwordx4 v35, s[12:15], s47 offen lds
    s_add_u32 m0, s46, 43008
    s_add_u32 s47, s45, 1654784
    buffer_load_dwordx4 v36, s[12:15], s47 offen lds
L_sequential_preLN__sliding_local_dilated__geglu_ffn__prompt_kernel_nolate:
    s_lshr_b32 s89, s92, 2
    s_lshl_b32 s89, s89, 5
    s_cmp_lg_u32 s26, 4
    s_cbranch_scc1 L_sequential_preLN__sliding_local_dilated__geglu_ffn__prompt_kernel_wt3
    s_mov_b32 s40, 0
    v_lshlrev_b32 v8, 7, v4
    s_lshl_b32 s41, s89, 7
    s_add_u32 s41, s41, 13697024
    s_mov_b64 exec, 0xffffffff
L_sequential_preLN__sliding_local_dilated__geglu_ffn__prompt_kernel_pl3:
    s_sleep 8
    buffer_load_dword v9, v8, s[4:7], s41 offen sc1
    s_add_u32 s40, s40, 1
    s_waitcnt vmcnt(0)
    v_cmp_ne_u32 vcc, s88, v9
    s_nop 4
    s_cbranch_vccz L_sequential_preLN__sliding_local_dilated__geglu_ffn__prompt_kernel_px3
    s_mov_b64 exec, vcc
    s_cmp_gt_u32 s40, 0x40000
    s_cbranch_scc1 L_sequential_preLN__sliding_local_dilated__geglu_ffn__prompt_kernel_px3
    s_cbranch_vccnz L_sequential_preLN__sliding_local_dilated__geglu_ffn__prompt_kernel_pl3
L_sequential_preLN__sliding_local_dilated__geglu_ffn__prompt_kernel_px3:
    s_mov_b64 exec, -1
L_sequential_preLN__sliding_local_dilated__geglu_ffn__prompt_kernel_wt3:
    s_barrier
    s_waitcnt vmcnt(0)
    s_barrier
    s_barrier
    s_barrier
    s_endpgm
.section .rodata,"a"
.p2align 6
.amdhsa_kernel sequential_preLN__sliding_local_dilated__geglu_ffn__prompt_kernel
  .amdhsa_next_free_vgpr 256
  .amdhsa_next_free_sgpr 102
  .amdhsa_accum_offset 256
  .amdhsa_group_segment_fixed_size 0
  .amdhsa_kernarg_size 80
  .amdhsa_user_sgpr_count 2
  .amdhsa_user_sgpr_kernarg_segment_ptr 1
  .amdhsa_system_sgpr_workgroup_id_x 1
.end_amdhsa_kernel
```
